```python
import torch

def _softmax(x, axis=-1):
    return torch.softmax(x, dim=axis)

def _gelu(x):
    return torch.nn.functional.gelu(x, approximate='tanh')

def _silu(x):
    return torch.nn.functional.silu(x)

def _sigmoid(x):
    return torch.sigmoid(x)

def _layernorm(x, axis=-1, eps=1e-05):
    m = x.mean(dim=axis, keepdim=True)
    v = x.var(dim=axis, keepdim=True, unbiased=False)
    return (x - m) / torch.sqrt(v + eps)

def _scatter_add(tgt, idx, src, axis=0):
    return tgt.clone().index_add_(axis, idx, src)

def _segment_sum(src, seg, n):
    out = torch.zeros((n,) + src.shape[1:], dtype=src.dtype)
    return out.index_add_(0, seg, src)

def _pad(x, pw):
    flat = tuple((v for pair in reversed(pw) for v in pair))
    return torch.nn.functional.pad(x, flat)
kernel_name = 'adaLN_cond__softmax_full_mha__swiglu_ffn__prompt'

def setup_inputs():

    _w = lambda a: (lambda t: t.to(torch.bfloat16) if t.is_floating_point() else t)(torch.as_tensor(a))

    def _A_setup():
        B, S, D = (1, 2048, 512)
        return {'x': _w((lambda *s: torch.randn(*s, dtype=torch.bfloat16) * 0.05)(B, S, D)), 'wqkv': _w((lambda *s: torch.randn(*s, dtype=torch.bfloat16) * 0.05)(D, 3 * D)), 'wo': _w((lambda *s: torch.randn(*s, dtype=torch.bfloat16) * 0.05)(D, D))}
    _A_in = _A_setup()

    def _B_setup():
        B, S, D, F = (1, 2048, 512, 1792)
        return {'x': _w((lambda *s: torch.randn(*s, dtype=torch.bfloat16) * 0.05)(B, S, D)), 'w_gate': _w((lambda *s: torch.randn(*s, dtype=torch.bfloat16) * 0.05)(D, F)), 'w_up': _w((lambda *s: torch.randn(*s, dtype=torch.bfloat16) * 0.05)(D, F)), 'w_down': _w((lambda *s: torch.randn(*s, dtype=torch.bfloat16) * 0.05)(F, D))}
    _B_in = _B_setup()
    return {'A_x': _A_in['x'], 'A_wqkv': _A_in['wqkv'], 'A_wo': _A_in['wo'], 'B_x': _B_in['x'], 'B_w_gate': _B_in['w_gate'], 'B_w_up': _B_in['w_up'], 'B_w_down': _B_in['w_down'], 'c': _w((lambda *s: torch.randn(*s, dtype=torch.bfloat16) * 0.1)(1, 512) * 8.0), 'w_mod': _w((lambda *s: torch.randn(*s, dtype=torch.bfloat16) * 0.1)(512, 6 * 512) * 512 ** (-0.5) * 8.0)}

def reference(A_x, A_wqkv, A_wo, B_x, B_w_gate, B_w_up, B_w_down, c, w_mod):

    def _A_ref(x, wqkv, wo):
        B, S, D = x.shape
        H = 32
        Dh = D // H
        qkv = (lambda x, *d: x.permute(*d))((x @ wqkv).reshape(B, S, 3, H, Dh), 2, 0, 3, 1, 4)
        q, k, v = (qkv[0], qkv[1], qkv[2])
        scale = Dh ** (-0.5)
        scores = torch.einsum('bhqd,bhkd->bhqk', q, k) * scale
        p = _softmax(scores, axis=-1)
        o = torch.einsum('bhqk,bhkd->bhqd', p, v)
        return (lambda x, *d: x.permute(*d))(o, 0, 2, 1, 3).reshape(B, S, D) @ wo

    def _B_ref(x, w_gate, w_up, w_down):
        g = _silu(x @ w_gate)
        u = x @ w_up
        return g * u @ w_down
    x = A_x
    mod = (_silu(c) @ w_mod).reshape(c.shape[0], 6, 1, -1)
    sa, ca, ga, sb, cb, gb = (mod[:, 0].clone(), mod[:, 1].clone(), mod[:, 2].clone(), mod[:, 3].clone(), mod[:, 4].clone(), mod[:, 5].clone())
    h = _layernorm(x, axis=-1) * (1 + ca) + sa
    x = x + ga * _A_ref(h, A_wqkv, A_wo)
    h = _layernorm(x, axis=-1) * (1 + cb) + sb
    x = x + gb * _B_ref(h, B_w_gate, B_w_up, B_w_down)
    return x
```

```asm
; @launch grid=(256,1,1) block=(512,1,1) lds=163840
.amdgcn_target "amdgcn-amd-amdhsa--gfx950"
.text
.globl adaLN_cond__softmax_full_mha__swiglu_ffn__prompt_kernel
.p2align 12
.type adaLN_cond__softmax_full_mha__swiglu_ffn__prompt_kernel,@function
adaLN_cond__softmax_full_mha__swiglu_ffn__prompt_kernel:
  s_cmp_ge_u32 s2, 256
  s_cbranch_scc1 KF_END
  s_load_dwordx4 s[4:7], s[0:1], 0
  s_load_dwordx4 s[8:11], s[0:1], 56
  s_load_dwordx4 s[44:47], s[0:1], 80
  s_getpc_b64 s[98:99]
K12_PC:
  v_lshlrev_b32 v7, 7, v0
  v_min_u32 v7, adaLN_cond__softmax_full_mha__swiglu_ffn__prompt_kernel_end-K12_PC-4, v7
  s_lshr_b32 s3, s2, 6
  s_cmp_eq_u32 s3, 2
  s_cselect_b32 s3, 128, 0
  v_cmp_gt_u32 vcc, s3, v0
  s_nop 0
  s_mov_b64 exec, vcc
  global_load_dword v7, v7, s[98:99]
  s_mov_b64 exec, -1
  v_lshrrev_b32 v1, 6, v0
  s_nop 0
  v_readfirstlane_b32 s30, v1
  v_and_b32 v1, 63, v0
  s_mov_b32 s31, 0xffff0000
  s_and_b32 s3, s2, 7
  s_lshr_b32 s28, s2, 3
  s_lshr_b32 s33, s28, 3
  s_lshl_b32 s63, s33, 1
  s_add_u32 s63, s63, s30
  s_and_b32 s63, s63, 7
  s_and_b32 s29, s3, 1
  s_lshl_b32 s29, s29, 2
  s_add_u32 s33, s33, s29
  s_and_b32 s29, s28, 7
  s_lshr_b32 s35, s3, 1
  s_lshl_b32 s35, s35, 3
  s_add_u32 s35, s35, s29
  s_and_b32 s36, s30, 1
  s_bfe_u32 s37, s30, 0x10001
  s_lshl_b32 s34, s35, 1
  s_add_u32 s34, s34, s36
  v_lshlrev_b32 v2, 4, v1
  s_and_b32 s40, s28, 3
  s_lshl_b32 s41, s3, 2
  s_add_u32 s40, s40, s41
  s_and_b32 s40, s40, 15
  s_bfe_u32 s38, s28, 0x20002
  s_mul_i32 s41, s38, 786432
  s_lshl_b32 s29, s40, 7
  s_add_u32 s41, s41, s29
  s_lshl_b32 s39, s38, 8
  v_and_b32 v3, 7, v0
  v_lshrrev_b32 v4, 3, v0
  v_mul_u32_u24 v5, 6144, v4
  v_lshl_add_u32 v5, v3, 4, v5
  v_lshlrev_b32 v6, 1, v4
  v_mov_b32 v8, 0
  v_mov_b32 v9, 0
  v_mov_b32 v10, 0
  v_mov_b32 v11, 153600
  ds_write_b32 v11, v8
  s_lshl_b32 s42, s35, 16
  s_lshl_b32 s29, s63, 13
  s_add_u32 s42, s42, s29
  s_add_u32 s43, s42, 4096
  s_lshl_b32 s60, s30, 1
  s_lshl_b32 s29, s3, 1
  s_or_b32 s60, s60, s29
  s_lshr_b32 s29, s28, 1
  s_or_b32 s60, s60, s29
  s_waitcnt lgkmcnt(0)
  s_load_dword s100, s[46:47], 0x18000
  s_mov_b32 s16, s8
  s_mov_b32 s17, s9
  s_mov_b32 s18, 0x400
  s_mov_b32 s19, 0x20000
  s_mov_b32 s20, s10
  s_mov_b32 s21, s11
  s_mov_b32 s22, 0x300000
  s_mov_b32 s23, 0x20000
  s_mov_b32 s24, s46
  s_mov_b32 s25, s47
  s_mov_b32 s26, 0x1700000
  s_mov_b32 s27, 0x20000
  s_cmp_ge_u32 s60, 8
  s_cbranch_scc1 K12_NOMODL
  buffer_load_ushort v160, v6, s[16:19], s39 offen offset:0
  buffer_load_ushort v161, v6, s[16:19], s39 offen offset:64
  buffer_load_ushort v162, v6, s[16:19], s39 offen offset:128
  buffer_load_ushort v163, v6, s[16:19], s39 offen offset:192
  buffer_load_dwordx4 v[144:147], v5, s[20:23], s41 offen
  s_add_u32 s41, s41, 196608
  buffer_load_dwordx4 v[148:151], v5, s[20:23], s41 offen
  s_add_u32 s41, s41, 196608
  buffer_load_dwordx4 v[152:155], v5, s[20:23], s41 offen
  s_add_u32 s41, s41, 196608
  buffer_load_dwordx4 v[156:159], v5, s[20:23], s41 offen
  s_add_u32 s41, s41, 196608
K12_NOMODL:
  s_mov_b32 s48, s4
  s_mov_b32 s49, s5
  s_mov_b32 s50, 0x200000
  s_mov_b32 s51, 0x20000
  s_mov_b32 s12, s6
  s_mov_b32 s13, s7
  s_mov_b32 s14, 0x180000
  s_mov_b32 s15, 0x20000
  s_mov_b32 s4, s40
  s_mov_b32 s5, s38
  s_barrier
K12_NOT:
  s_cmp_ge_u32 s60, 8
  s_cbranch_scc1 K12_REST
  s_waitcnt vmcnt(4)
  v_lshlrev_b32 v160, 16, v160
  v_lshlrev_b32 v161, 16, v161
  v_lshlrev_b32 v162, 16, v162
  v_lshlrev_b32 v163, 16, v163
  v_mul_f32 v164, 0xbfb8aa3b, v160
  v_mul_f32 v165, 0xbfb8aa3b, v161
  v_mul_f32 v166, 0xbfb8aa3b, v162
  v_mul_f32 v167, 0xbfb8aa3b, v163
  v_exp_f32 v164, v164
  v_exp_f32 v165, v165
  v_exp_f32 v166, v166
  v_exp_f32 v167, v167
  v_add_f32 v164, 1.0, v164
  v_add_f32 v165, 1.0, v165
  v_add_f32 v166, 1.0, v166
  v_add_f32 v167, 1.0, v167
  v_rcp_f32 v164, v164
  v_rcp_f32 v165, v165
  v_rcp_f32 v166, v166
  v_rcp_f32 v167, v167
  v_mul_f32 v164, v160, v164
  v_mul_f32 v165, v161, v165
  v_mul_f32 v166, v162, v166
  v_mul_f32 v167, v163, v167
  v_cvt_pk_bf16_f32 v164, v164, v164
  v_cvt_pk_bf16_f32 v165, v165, v165
  v_cvt_pk_bf16_f32 v166, v166, v166
  v_cvt_pk_bf16_f32 v167, v167, v167
  v_lshlrev_b32 v164, 16, v164
  v_lshlrev_b32 v165, 16, v165
  v_lshlrev_b32 v166, 16, v166
  v_lshlrev_b32 v167, 16, v167
  v_lshrrev_b32 v46, 5, v1
  v_bfe_u32 v47, v1, 4, 1
  v_lshl_add_u32 v46, v47, 1, v46
  v_lshl_add_u32 v46, v3, 3, v46
  s_lshl_b32 s29, s30, 6
  v_add_u32 v46, s29, v46
  v_lshlrev_b32 v46, 2, v46
  v_add_u32 v46, 81920, v46
  v_mov_b32 v11, 153600
  v_mov_b32 v12, 1
  s_waitcnt vmcnt(0)
  v_lshlrev_b32 v40, 16, v144
  v_and_b32 v41, s31, v144
  v_pk_mul_f32 v[32:33], v[40:41], v[164:165] op_sel:[0,0] op_sel_hi:[1,0]
  v_lshlrev_b32 v42, 16, v145
  v_and_b32 v43, s31, v145
  v_pk_mul_f32 v[34:35], v[42:43], v[164:165] op_sel:[0,0] op_sel_hi:[1,0]
  v_lshlrev_b32 v40, 16, v146
  v_and_b32 v41, s31, v146
  v_pk_mul_f32 v[36:37], v[40:41], v[164:165] op_sel:[0,0] op_sel_hi:[1,0]
  v_lshlrev_b32 v42, 16, v147
  v_and_b32 v43, s31, v147
  v_pk_mul_f32 v[38:39], v[42:43], v[164:165] op_sel:[0,0] op_sel_hi:[1,0]
  v_lshlrev_b32 v40, 16, v148
  v_and_b32 v41, s31, v148
  v_pk_fma_f32 v[32:33], v[164:165], v[40:41], v[32:33] op_sel:[1,0,0] op_sel_hi:[1,1,1]
  v_lshlrev_b32 v42, 16, v149
  v_and_b32 v43, s31, v149
  v_pk_fma_f32 v[34:35], v[164:165], v[42:43], v[34:35] op_sel:[1,0,0] op_sel_hi:[1,1,1]
  v_lshlrev_b32 v40, 16, v150
  v_and_b32 v41, s31, v150
  v_pk_fma_f32 v[36:37], v[164:165], v[40:41], v[36:37] op_sel:[1,0,0] op_sel_hi:[1,1,1]
  v_lshlrev_b32 v42, 16, v151
  v_and_b32 v43, s31, v151
  v_pk_fma_f32 v[38:39], v[164:165], v[42:43], v[38:39] op_sel:[1,0,0] op_sel_hi:[1,1,1]
  v_lshlrev_b32 v40, 16, v152
  v_and_b32 v41, s31, v152
  v_pk_fma_f32 v[32:33], v[40:41], v[166:167], v[32:33] op_sel:[0,0,0] op_sel_hi:[1,0,1]
  v_lshlrev_b32 v42, 16, v153
  v_and_b32 v43, s31, v153
  v_pk_fma_f32 v[34:35], v[42:43], v[166:167], v[34:35] op_sel:[0,0,0] op_sel_hi:[1,0,1]
  v_lshlrev_b32 v40, 16, v154
  v_and_b32 v41, s31, v154
  v_pk_fma_f32 v[36:37], v[40:41], v[166:167], v[36:37] op_sel:[0,0,0] op_sel_hi:[1,0,1]
  v_lshlrev_b32 v42, 16, v155
  v_and_b32 v43, s31, v155
  v_pk_fma_f32 v[38:39], v[42:43], v[166:167], v[38:39] op_sel:[0,0,0] op_sel_hi:[1,0,1]
  v_lshlrev_b32 v40, 16, v156
  v_and_b32 v41, s31, v156
  v_pk_fma_f32 v[32:33], v[166:167], v[40:41], v[32:33] op_sel:[1,0,0] op_sel_hi:[1,1,1]
  v_lshlrev_b32 v42, 16, v157
  v_and_b32 v43, s31, v157
  v_pk_fma_f32 v[34:35], v[166:167], v[42:43], v[34:35] op_sel:[1,0,0] op_sel_hi:[1,1,1]
  v_lshlrev_b32 v40, 16, v158
  v_and_b32 v41, s31, v158
  v_pk_fma_f32 v[36:37], v[166:167], v[40:41], v[36:37] op_sel:[1,0,0] op_sel_hi:[1,1,1]
  v_lshlrev_b32 v42, 16, v159
  v_and_b32 v43, s31, v159
  v_pk_fma_f32 v[38:39], v[166:167], v[42:43], v[38:39] op_sel:[1,0,0] op_sel_hi:[1,1,1]
  v_permlane32_swap_b32 v32, v33
  v_permlane32_swap_b32 v34, v35
  v_permlane32_swap_b32 v36, v37
  v_permlane32_swap_b32 v38, v39
  v_add_f32 v40, v32, v33
  v_add_f32 v41, v34, v35
  v_add_f32 v42, v36, v37
  v_add_f32 v43, v38, v39
  v_permlane16_swap_b32 v40, v41
  s_nop 0
  v_permlane16_swap_b32 v42, v43
  v_add_f32 v44, v40, v41
  v_add_f32 v45, v42, v43
  s_nop 0
  v_add_f32_dpp v44, v44, v44 row_ror:8 row_mask:0xf bank_mask:0xf
  v_add_f32_dpp v45, v45, v45 row_ror:8 row_mask:0xf bank_mask:0xf
  ds_write_b32 v46, v44
  ds_write_b32 v46, v45 offset:16
  v_lshlrev_b32 v46, 2, v1
  v_add_u32 v47, 81920, v46
  s_waitcnt lgkmcnt(0)
  s_mov_b64 exec, 1
  ds_add_rtn_u32 v12, v11, v12
  s_mov_b64 exec, -1
  ds_read_b32 v144, v47 offset:0
  ds_read_b32 v145, v47 offset:256
  ds_read_b32 v146, v47 offset:512
  ds_read_b32 v147, v47 offset:768
  s_lshl_b32 s29, s4, 9
  s_lshl_b32 s47, s5, 13
  s_add_u32 s29, s29, s47
  s_add_u32 s29, s29, 0x80000
  v_lshlrev_b32 v46, 3, v1
  s_waitcnt lgkmcnt(0)
  v_readfirstlane_b32 s47, v12
  s_nop 0
  s_cmp_lg_u32 s47, 3
  s_cbranch_scc1 K12_LN
  s_add_u32 s47, s100, 0x9e3779b9
  v_add_f32 v144, v144, v146
  v_add_f32 v145, v145, v147
  v_add_f32 v144, v144, v145
  v_mov_b32 v145, s47
  buffer_store_dwordx2 v[144:145], v46, s[24:27], s29 offen sc1
  s_add_u32 s29, s29, 32768
  buffer_store_dwordx2 v[144:145], v46, s[24:27], s29 offen sc1
  s_add_u32 s29, s29, 32768
  buffer_store_dwordx2 v[144:145], v46, s[24:27], s29 offen sc1
  s_add_u32 s29, s29, 32768
  buffer_store_dwordx2 v[144:145], v46, s[24:27], s29 offen sc1
  s_add_u32 s29, s29, 32768
  buffer_store_dwordx2 v[144:145], v46, s[24:27], s29 offen sc1
  s_add_u32 s29, s29, 32768
  buffer_store_dwordx2 v[144:145], v46, s[24:27], s29 offen sc1
  s_add_u32 s29, s29, 32768
  buffer_store_dwordx2 v[144:145], v46, s[24:27], s29 offen sc1
  s_add_u32 s29, s29, 32768
  buffer_store_dwordx2 v[144:145], v46, s[24:27], s29 offen sc1
  s_add_u32 s29, s29, 32768
  s_branch K12_LN
K12_REST:
  buffer_load_dwordx4 v[48:51], v2, s[48:51], s42 offen offset:0
  buffer_load_dwordx4 v[52:55], v2, s[48:51], s42 offen offset:1024
  buffer_load_dwordx4 v[56:59], v2, s[48:51], s42 offen offset:2048
  buffer_load_dwordx4 v[60:63], v2, s[48:51], s42 offen offset:3072
  buffer_load_dwordx4 v[64:67], v2, s[48:51], s43 offen offset:0
  buffer_load_dwordx4 v[68:71], v2, s[48:51], s43 offen offset:1024
  buffer_load_dwordx4 v[72:75], v2, s[48:51], s43 offen offset:2048
  buffer_load_dwordx4 v[76:79], v2, s[48:51], s43 offen offset:3072
  s_cmp_eq_u32 s30, 5
  s_cbranch_scc1 ST_P1
WR_x:
  s_cmp_lt_u32 s30, 7
  s_cbranch_scc1 K12_LN
  s_bitset1_b32 s60, 8
  s_lshl_b32 s29, s28, 6
  s_lshr_b32 s46, s29, 7
  s_and_b32 s46, s46, 0x3c
  s_mov_b32 s4, 0x76543210
  s_mov_b32 s5, 0xba98
  s_lshr_b64 s[4:5], s[4:5], s46
  v_add_u32 v11, s29, v1
  v_bfe_u32 v12, v11, 2, 7
  v_and_b32 v11, 3, v11
  v_mul_u32_u24 v12, 24, v12
  s_and_b32 s46, s4, 3
  s_mul_i32 s46, s46, 3072
  s_and_b32 s47, s4, 12
  s_lshl_b32 s47, s47, 1
  s_add_u32 s46, s46, s47
  s_and_b32 s47, s3, 1
  s_lshl_b32 s47, s47, 2
  s_add_u32 s46, s46, s47
  v_add3_u32 v11, v12, v11, s46
  v_lshlrev_b32 v11, 7, v11
  buffer_load_dword v7, v11, s[12:15], 0 offen
K12_LN:
  s_and_b32 s38, s30, 3
  v_lshrrev_b32 v3, 3, v1
  v_and_b32 v4, 7, v1
  v_bfe_u32 v5, v1, 4, 1
  v_lshlrev_b32 v5, 2, v5
  v_xor_b32 v4, v4, v5
  v_mul_u32_u24 v3, 3072, v3
  v_lshl_add_u32 v8, v4, 4, v3
  v_add_u32 v9, 23552, v8
  s_mul_i32 s39, s38, 49152
  s_lshl_b32 s29, s33, 7
  s_add_u32 s52, s39, s29
  s_add_u32 s53, s52, s39
  s_lshl_b32 s40, s38, 12
  s_lshr_b32 s29, s30, 2
  s_mul_i32 s44, s29, 16384
  s_add_u32 s44, s44, s40
  s_cmp_eq_u32 s29, 0
  s_cselect_b32 s45, 0, 393216
  s_mov_b32 s52, 1179648
  s_cselect_b32 s52, 786432, s52
  s_add_u32 s45, s45, s53
  s_add_u32 s52, s52, s53
  v_lshrrev_b32 v13, 1, v1
  v_mul_u32_u24 v13, 1056, v13
  v_and_b32 v14, 1, v1
  v_mul_u32_u24 v14, 528, v14
  v_add_u32 v13, v13, v14
  s_lshr_b32 s29, s63, 2
  s_mul_i32 s29, s29, 33792
  s_and_b32 s41, s63, 3
  s_lshl_b32 s41, s41, 7
  s_add_u32 s29, s29, s41
  s_add_u32 s29, s29, 81920
  v_add_u32 v13, s29, v13
  s_lshl_b32 s32, s33, 1
  s_add_u32 s32, s32, s37
  v_bfe_u32 v3, v1, 2, 2
  v_lshrrev_b32 v5, 5, v1
  v_lshl_add_u32 v3, v5, 3, v3
  v_lshlrev_b32 v3, 7, v3
  v_and_b32 v5, 1, v1
  v_lshl_add_u32 v3, v5, 4, v3
  v_bfe_u32 v5, v1, 1, 1
  v_lshl_add_u32 v3, v5, 3, v3
  v_bfe_u32 v5, v1, 4, 1
  v_lshl_add_u32 v3, v5, 5, v3
  v_bfe_u32 v5, v1, 3, 1
  v_xor_b32 v5, s37, v5
  v_lshl_add_u32 v10, v5, 6, v3
  v_add_u32 v11, 49152, v10
  v_and_b32 v3, 31, v1
  v_lshlrev_b32 v3, 4, v3
  v_lshrrev_b32 v5, 5, v1
  v_mul_u32_u24 v5, 528, v5
  v_add_u32 v3, v3, v5
  s_mul_i32 s29, s36, 33792
  s_add_u32 s29, s29, 81920
  v_add_u32 v12, s29, v3
  v_lshlrev_b32 v14, 5, v1
  v_add_u32 v14, 149504, v14
  v_mov_b32 v15, 0x3f803f80
  v_mov_b32 v159, s31
  v_lshrrev_b32 v210, 2, v1
  v_mul_u32_u24 v210, 6144, v210
  v_and_b32 v211, 3, v1
  v_lshl_add_u32 v210, v211, 7, v210
  s_mul_i32 s55, s28, 98304
  s_lshl_b32 s47, s3, 9
  s_add_u32 s55, s55, s47
  v_and_b32 v211, 7, v1
  s_lshl_b32 s47, s28, 10
  s_add_u32 s47, s47, 16384
  v_lshlrev_b32 v211, 7, v211
  v_add_u32 v211, s47, v211
  v_min_u32 v211, adaLN_cond__softmax_full_mha__swiglu_ffn__prompt_kernel_end-K12_PC-4, v211
  s_and_b32 s29, s30, 1
  s_lshl_b32 s29, s29, 5
  s_add_u32 s29, s29, s28
  s_lshl_b32 s29, s29, 6
  s_add_u32 s29, s29, 2048
  s_lshr_b32 s46, s29, 7
  s_and_b32 s46, s46, 0x3c
  s_mov_b32 s4, 0x76543210
  s_mov_b32 s5, 0xba98
  s_lshr_b64 s[4:5], s[4:5], s46
  v_add_u32 v212, s29, v1
  v_bfe_u32 v213, v212, 2, 7
  v_and_b32 v212, 3, v212
  v_mul_u32_u24 v213, 24, v213
  s_and_b32 s46, s4, 3
  s_mul_i32 s46, s46, 3072
  s_and_b32 s47, s4, 12
  s_lshl_b32 s47, s47, 1
  s_add_u32 s46, s46, s47
  s_and_b32 s47, s3, 1
  s_lshl_b32 s47, s47, 2
  s_add_u32 s46, s46, s47
  v_add3_u32 v212, v213, v212, s46
  v_lshlrev_b32 v212, 7, v212
  v_lshlrev_b32 v208, 4, v0
  v_add_u32 v209, 8192, v208
  s_and_b32 s61, s3, 7
  s_lshl_b32 s61, s61, 15
  s_add_u32 s61, s61, 0x80000
  s_add_u32 s62, s61, 16384
  s_add_u32 s6, s61, 4096
  s_add_u32 s7, s62, 4096
  s_waitcnt lgkmcnt(0)
  s_add_u32 s101, s100, 0x9e3779b9
  s_cmp_ge_u32 s60, 8
  s_cbranch_scc1 K12_XD
  buffer_load_dwordx4 v[48:51], v2, s[48:51], s42 offen offset:0
  buffer_load_dwordx4 v[52:55], v2, s[48:51], s42 offen offset:1024
  buffer_load_dwordx4 v[56:59], v2, s[48:51], s42 offen offset:2048
  buffer_load_dwordx4 v[60:63], v2, s[48:51], s42 offen offset:3072
  buffer_load_dwordx4 v[64:67], v2, s[48:51], s43 offen offset:0
  buffer_load_dwordx4 v[68:71], v2, s[48:51], s43 offen offset:1024
  buffer_load_dwordx4 v[72:75], v2, s[48:51], s43 offen offset:2048
  buffer_load_dwordx4 v[76:79], v2, s[48:51], s43 offen offset:3072
K12_XD:
  s_bitcmp1_b32 s60, 8
  s_cbranch_scc1 K12_XW
  s_waitcnt vmcnt(4)
K12_XW:
  s_waitcnt vmcnt(5)
  v_dot2_f32_bf16 v16, v48, v15, 0
  v_dot2_f32_bf16 v24, v48, v48, 0
  v_dot2_f32_bf16 v17, v52, v15, 0
  v_dot2_f32_bf16 v25, v52, v52, 0
  v_dot2_f32_bf16 v18, v56, v15, 0
  v_dot2_f32_bf16 v26, v56, v56, 0
  v_dot2_f32_bf16 v19, v60, v15, 0
  v_dot2_f32_bf16 v27, v60, v60, 0
  v_dot2_f32_bf16 v16, v49, v15, v16
  v_dot2_f32_bf16 v24, v49, v49, v24
  v_dot2_f32_bf16 v17, v53, v15, v17
  v_dot2_f32_bf16 v25, v53, v53, v25
  v_dot2_f32_bf16 v18, v57, v15, v18
  v_dot2_f32_bf16 v26, v57, v57, v26
  v_dot2_f32_bf16 v19, v61, v15, v19
  v_dot2_f32_bf16 v27, v61, v61, v27
  v_dot2_f32_bf16 v16, v50, v15, v16
  v_dot2_f32_bf16 v24, v50, v50, v24
  v_dot2_f32_bf16 v17, v54, v15, v17
  v_dot2_f32_bf16 v25, v54, v54, v25
  v_dot2_f32_bf16 v18, v58, v15, v18
  v_dot2_f32_bf16 v26, v58, v58, v26
  v_dot2_f32_bf16 v19, v62, v15, v19
  v_dot2_f32_bf16 v27, v62, v62, v27
  v_dot2_f32_bf16 v16, v51, v15, v16
  v_dot2_f32_bf16 v24, v51, v51, v24
  v_dot2_f32_bf16 v17, v55, v15, v17
  v_dot2_f32_bf16 v25, v55, v55, v25
  v_dot2_f32_bf16 v18, v59, v15, v18
  v_dot2_f32_bf16 v26, v59, v59, v26
  v_dot2_f32_bf16 v19, v63, v15, v19
  v_dot2_f32_bf16 v27, v63, v63, v27
  s_cbranch_scc1 K12_XW3
  s_waitcnt vmcnt(0)
K12_XW3:
  s_waitcnt vmcnt(1)
  v_dot2_f32_bf16 v20, v64, v15, 0
  v_dot2_f32_bf16 v28, v64, v64, 0
  v_dot2_f32_bf16 v21, v68, v15, 0
  v_dot2_f32_bf16 v29, v68, v68, 0
  v_dot2_f32_bf16 v22, v72, v15, 0
  v_dot2_f32_bf16 v30, v72, v72, 0
  v_dot2_f32_bf16 v23, v76, v15, 0
  v_dot2_f32_bf16 v31, v76, v76, 0
  v_dot2_f32_bf16 v20, v65, v15, v20
  v_dot2_f32_bf16 v28, v65, v65, v28
  s_add_u32 m0, s44, 0
  s_add_u32 s54, s45, 0
  buffer_load_dwordx4 v8, s[12:15], s54 offen offset:0 lds
  v_dot2_f32_bf16 v21, v69, v15, v21
  v_dot2_f32_bf16 v29, v69, v69, v29
  v_dot2_f32_bf16 v22, v73, v15, v22
  v_dot2_f32_bf16 v30, v73, v73, v30
  v_dot2_f32_bf16 v23, v77, v15, v23
  v_dot2_f32_bf16 v31, v77, v77, v31
  v_dot2_f32_bf16 v20, v66, v15, v20
  v_dot2_f32_bf16 v28, v66, v66, v28
  v_dot2_f32_bf16 v21, v70, v15, v21
  v_dot2_f32_bf16 v29, v70, v70, v29
  v_dot2_f32_bf16 v22, v74, v15, v22
  v_dot2_f32_bf16 v30, v74, v74, v30
  v_dot2_f32_bf16 v23, v78, v15, v23
  v_dot2_f32_bf16 v31, v78, v78, v31
  v_dot2_f32_bf16 v20, v67, v15, v20
  v_dot2_f32_bf16 v28, v67, v67, v28
  v_dot2_f32_bf16 v21, v71, v15, v21
  v_dot2_f32_bf16 v29, v71, v71, v29
  v_dot2_f32_bf16 v22, v75, v15, v22
  v_dot2_f32_bf16 v30, v75, v75, v30
  buffer_load_dwordx4 v9, s[12:15], s54 offen offset:1024 lds
  v_dot2_f32_bf16 v23, v79, v15, v23
  v_dot2_f32_bf16 v31, v79, v79, v31
  v_permlane32_swap_b32 v16, v17
  v_permlane32_swap_b32 v18, v19
  v_permlane32_swap_b32 v20, v21
  v_permlane32_swap_b32 v22, v23
  v_permlane32_swap_b32 v24, v25
  v_permlane32_swap_b32 v26, v27
  v_permlane32_swap_b32 v28, v29
  v_permlane32_swap_b32 v30, v31
  v_lshlrev_b32 v80, 16, v48
  v_and_b32 v81, v159, v48
  v_lshlrev_b32 v82, 16, v49
  v_and_b32 v83, v159, v49
  v_add_f32 v32, v16, v17
  v_add_f32 v33, v18, v19
  v_add_f32 v34, v20, v21
  v_add_f32 v35, v22, v23
  v_add_f32 v36, v24, v25
  v_add_f32 v37, v26, v27
  s_add_u32 s54, s45, 47104
  buffer_load_dwordx4 v8, s[12:15], s54 offen offset:2048 lds
  v_add_f32 v38, v28, v29
  v_add_f32 v39, v30, v31
  v_lshlrev_b32 v84, 16, v50
  v_and_b32 v85, v159, v50
  v_lshlrev_b32 v86, 16, v51
  v_and_b32 v87, v159, v51
  v_permlane16_swap_b32 v32, v33
  v_permlane16_swap_b32 v34, v35
  v_permlane16_swap_b32 v36, v37
  v_permlane16_swap_b32 v38, v39
  v_lshlrev_b32 v88, 16, v52
  v_and_b32 v89, v159, v52
  v_lshlrev_b32 v90, 16, v53
  v_and_b32 v91, v159, v53
  v_add_f32 v40, v32, v33
  v_add_f32 v41, v34, v35
  v_add_f32 v42, v36, v37
  v_add_f32 v43, v38, v39
  v_lshlrev_b32 v92, 16, v54
  v_and_b32 v93, v159, v54
  buffer_load_dwordx4 v9, s[12:15], s54 offen offset:3072 lds
  v_lshlrev_b32 v94, 16, v55
  v_and_b32 v95, v159, v55
  v_add_f32_dpp v44, v40, v40 row_ror:8 row_mask:0xf bank_mask:0x3
  v_add_f32_dpp v45, v42, v42 row_ror:8 row_mask:0xf bank_mask:0x3
  v_lshlrev_b32 v96, 16, v56
  v_and_b32 v97, v159, v56
  v_lshlrev_b32 v98, 16, v57
  v_and_b32 v99, v159, v57
  v_add_f32_dpp v44, v41, v41 row_ror:8 row_mask:0xf bank_mask:0xc
  v_add_f32_dpp v45, v43, v43 row_ror:8 row_mask:0xf bank_mask:0xc
  v_lshlrev_b32 v100, 16, v58
  v_and_b32 v101, v159, v58
  v_lshlrev_b32 v102, 16, v59
  v_and_b32 v103, v159, v59
  v_add_f32_dpp v44, v44, v44 row_half_mirror row_mask:0xf bank_mask:0xf
  v_add_f32_dpp v45, v45, v45 row_half_mirror row_mask:0xf bank_mask:0xf
  v_lshlrev_b32 v104, 16, v60
  v_and_b32 v105, v159, v60
  v_lshlrev_b32 v106, 16, v61
  v_and_b32 v107, v159, v61
  s_add_u32 m0, s44, 32768
  s_add_u32 s54, s52, 0
  buffer_load_dwordx4 v8, s[12:15], s54 offen offset:0 lds
  v_add_f32_dpp v44, v44, v44 quad_perm:[1,0,3,2] row_mask:0xf bank_mask:0xf
  v_add_f32_dpp v45, v45, v45 quad_perm:[1,0,3,2] row_mask:0xf bank_mask:0xf
  v_lshlrev_b32 v108, 16, v62
  v_and_b32 v109, v159, v62
  v_lshlrev_b32 v110, 16, v63
  v_and_b32 v111, v159, v63
  v_add_f32_dpp v44, v44, v44 quad_perm:[2,3,0,1] row_mask:0xf bank_mask:0xf
  v_add_f32_dpp v45, v45, v45 quad_perm:[2,3,0,1] row_mask:0xf bank_mask:0xf
  v_lshlrev_b32 v112, 16, v64
  v_and_b32 v113, v159, v64
  v_lshlrev_b32 v114, 16, v65
  v_and_b32 v115, v159, v65
  v_mul_f32 v44, 0x3b000000, v44
  v_mul_f32 v45, 0x3b000000, v45
  v_lshlrev_b32 v116, 16, v66
  v_and_b32 v117, v159, v66
  v_lshlrev_b32 v118, 16, v67
  v_and_b32 v119, v159, v67
  v_fma_f32 v45, -v44, v44, v45
  v_lshlrev_b32 v120, 16, v68
  buffer_load_dwordx4 v9, s[12:15], s54 offen offset:1024 lds
  v_and_b32 v121, v159, v68
  v_lshlrev_b32 v122, 16, v69
  v_and_b32 v123, v159, v69
  v_max_f32 v45, 0, v45
  v_lshlrev_b32 v124, 16, v70
  v_and_b32 v125, v159, v70
  v_lshlrev_b32 v126, 16, v71
  v_and_b32 v127, v159, v71
  v_add_f32 v45, 0x3727c5ac, v45
  v_lshlrev_b32 v128, 16, v72
  v_and_b32 v129, v159, v72
  v_lshlrev_b32 v130, 16, v73
  v_and_b32 v131, v159, v73
  v_rsq_f32 v45, v45
  v_lshlrev_b32 v132, 16, v74
  v_and_b32 v133, v159, v74
  v_lshlrev_b32 v134, 16, v75
  v_and_b32 v135, v159, v75
  v_mul_f32 v44, -v44, v45
  v_lshlrev_b32 v136, 16, v76
  s_add_u32 s54, s52, 47104
  buffer_load_dwordx4 v8, s[12:15], s54 offen offset:2048 lds
  v_and_b32 v137, v159, v76
  v_lshlrev_b32 v138, 16, v77
  v_and_b32 v139, v159, v77
  v_readlane_b32 s84, v45, 0
  v_readlane_b32 s85, v44, 0
  v_readlane_b32 s86, v45, 32
  v_readlane_b32 s87, v44, 32
  v_readlane_b32 s88, v45, 16
  v_readlane_b32 s89, v44, 16
  v_readlane_b32 s90, v45, 48
  v_readlane_b32 s91, v44, 48
  v_readlane_b32 s92, v45, 8
  v_readlane_b32 s93, v44, 8
  v_readlane_b32 s94, v45, 40
  v_readlane_b32 s95, v44, 40
  v_readlane_b32 s56, v45, 24
  v_readlane_b32 s57, v44, 24
  v_readlane_b32 s58, v45, 56
  v_readlane_b32 s59, v44, 56
  v_lshlrev_b32 v140, 16, v78
  buffer_load_dwordx4 v9, s[12:15], s54 offen offset:3072 lds
  v_and_b32 v141, v159, v78
  v_lshlrev_b32 v142, 16, v79
  v_and_b32 v143, v159, v79
  v_pk_fma_f32 v[80:81], v[80:81], s[84:85], s[84:85] op_sel:[0,0,1] op_sel_hi:[1,0,1]
  v_pk_fma_f32 v[82:83], v[82:83], s[84:85], s[84:85] op_sel:[0,0,1] op_sel_hi:[1,0,1]
  v_pk_fma_f32 v[84:85], v[84:85], s[84:85], s[84:85] op_sel:[0,0,1] op_sel_hi:[1,0,1]
  v_pk_fma_f32 v[86:87], v[86:87], s[84:85], s[84:85] op_sel:[0,0,1] op_sel_hi:[1,0,1]
  v_pk_fma_f32 v[88:89], v[88:89], s[86:87], s[86:87] op_sel:[0,0,1] op_sel_hi:[1,0,1]
  v_pk_fma_f32 v[90:91], v[90:91], s[86:87], s[86:87] op_sel:[0,0,1] op_sel_hi:[1,0,1]
  v_pk_fma_f32 v[92:93], v[92:93], s[86:87], s[86:87] op_sel:[0,0,1] op_sel_hi:[1,0,1]
  v_pk_fma_f32 v[94:95], v[94:95], s[86:87], s[86:87] op_sel:[0,0,1] op_sel_hi:[1,0,1]
  v_pk_fma_f32 v[96:97], v[96:97], s[88:89], s[88:89] op_sel:[0,0,1] op_sel_hi:[1,0,1]
  v_pk_fma_f32 v[98:99], v[98:99], s[88:89], s[88:89] op_sel:[0,0,1] op_sel_hi:[1,0,1]
  v_pk_fma_f32 v[100:101], v[100:101], s[88:89], s[88:89] op_sel:[0,0,1] op_sel_hi:[1,0,1]
  v_pk_fma_f32 v[102:103], v[102:103], s[88:89], s[88:89] op_sel:[0,0,1] op_sel_hi:[1,0,1]
  v_pk_fma_f32 v[104:105], v[104:105], s[90:91], s[90:91] op_sel:[0,0,1] op_sel_hi:[1,0,1]
  v_pk_fma_f32 v[106:107], v[106:107], s[90:91], s[90:91] op_sel:[0,0,1] op_sel_hi:[1,0,1]
  v_pk_fma_f32 v[108:109], v[108:109], s[90:91], s[90:91] op_sel:[0,0,1] op_sel_hi:[1,0,1]
  v_pk_fma_f32 v[110:111], v[110:111], s[90:91], s[90:91] op_sel:[0,0,1] op_sel_hi:[1,0,1]
  v_pk_fma_f32 v[112:113], v[112:113], s[92:93], s[92:93] op_sel:[0,0,1] op_sel_hi:[1,0,1]
  v_pk_fma_f32 v[114:115], v[114:115], s[92:93], s[92:93] op_sel:[0,0,1] op_sel_hi:[1,0,1]
  v_pk_fma_f32 v[116:117], v[116:117], s[92:93], s[92:93] op_sel:[0,0,1] op_sel_hi:[1,0,1]
  v_pk_fma_f32 v[118:119], v[118:119], s[92:93], s[92:93] op_sel:[0,0,1] op_sel_hi:[1,0,1]
  v_pk_fma_f32 v[120:121], v[120:121], s[94:95], s[94:95] op_sel:[0,0,1] op_sel_hi:[1,0,1]
  v_pk_fma_f32 v[122:123], v[122:123], s[94:95], s[94:95] op_sel:[0,0,1] op_sel_hi:[1,0,1]
  v_pk_fma_f32 v[124:125], v[124:125], s[94:95], s[94:95] op_sel:[0,0,1] op_sel_hi:[1,0,1]
  v_pk_fma_f32 v[126:127], v[126:127], s[94:95], s[94:95] op_sel:[0,0,1] op_sel_hi:[1,0,1]
  v_pk_fma_f32 v[128:129], v[128:129], s[56:57], s[56:57] op_sel:[0,0,1] op_sel_hi:[1,0,1]
  v_pk_fma_f32 v[130:131], v[130:131], s[56:57], s[56:57] op_sel:[0,0,1] op_sel_hi:[1,0,1]
  v_pk_fma_f32 v[132:133], v[132:133], s[56:57], s[56:57] op_sel:[0,0,1] op_sel_hi:[1,0,1]
  v_pk_fma_f32 v[134:135], v[134:135], s[56:57], s[56:57] op_sel:[0,0,1] op_sel_hi:[1,0,1]
  v_pk_fma_f32 v[136:137], v[136:137], s[58:59], s[58:59] op_sel:[0,0,1] op_sel_hi:[1,0,1]
  v_pk_fma_f32 v[138:139], v[138:139], s[58:59], s[58:59] op_sel:[0,0,1] op_sel_hi:[1,0,1]
  v_pk_fma_f32 v[140:141], v[140:141], s[58:59], s[58:59] op_sel:[0,0,1] op_sel_hi:[1,0,1]
  v_pk_fma_f32 v[142:143], v[142:143], s[58:59], s[58:59] op_sel:[0,0,1] op_sel_hi:[1,0,1]
  s_mov_b32 s41, 400000
  s_cmp_ge_u32 s30, 4
  s_cbranch_scc0 K12_LOP
  s_cmp_eq_u32 s30, 5
  s_cbranch_scc1 ST_P2
WR_b:
  s_branch K12_BAR
K12_LOP:
  v_lshlrev_b32 v46, 3, v0
  v_add_u32 v46, 149504, v46
K12_POLL:
  buffer_load_dwordx4 v[216:219], v208, s[24:27], s61 offen sc1
  buffer_load_dwordx4 v[220:223], v209, s[24:27], s61 offen sc1
  buffer_load_dwordx4 v[224:227], v208, s[24:27], s62 offen sc1
  buffer_load_dwordx4 v[228:231], v209, s[24:27], s62 offen sc1
  buffer_load_dwordx4 v[232:235], v208, s[24:27], s6 offen sc1
  buffer_load_dwordx4 v[236:239], v209, s[24:27], s6 offen sc1
  buffer_load_dwordx4 v[240:243], v208, s[24:27], s7 offen sc1
  buffer_load_dwordx4 v[244:247], v209, s[24:27], s7 offen sc1
K12_POLLW:
  s_waitcnt vmcnt(4)
  v_xor_b32 v217, s101, v217
  v_xor_b32 v219, s101, v219
  v_xor_b32 v221, s101, v221
  v_xor_b32 v223, s101, v223
  v_xor_b32 v225, s101, v225
  v_xor_b32 v227, s101, v227
  v_xor_b32 v229, s101, v229
  v_xor_b32 v231, s101, v231
  v_or3_b32 v217, v217, v219, v221
  v_or3_b32 v223, v223, v225, v227
  v_or3_b32 v217, v217, v229, v231
  v_or_b32 v217, v217, v223
  v_add_f32 v32, v216, v220
  v_add_f32 v33, v218, v222
  v_add_f32 v40, v224, v228
  v_add_f32 v41, v226, v230
  v_add_f32 v32, v32, v40
  v_add_f32 v33, v33, v41
  s_waitcnt vmcnt(0)
  v_xor_b32 v233, s101, v233
  v_xor_b32 v235, s101, v235
  v_xor_b32 v237, s101, v237
  v_xor_b32 v239, s101, v239
  v_xor_b32 v241, s101, v241
  v_xor_b32 v243, s101, v243
  v_xor_b32 v245, s101, v245
  v_xor_b32 v247, s101, v247
  v_or3_b32 v233, v233, v235, v237
  v_or3_b32 v239, v239, v241, v243
  v_or3_b32 v233, v233, v245, v247
  v_or3_b32 v217, v217, v233, v239
  v_add_f32 v34, v232, v236
  v_add_f32 v35, v234, v238
  v_add_f32 v40, v240, v244
  v_add_f32 v41, v242, v246
  v_add_f32 v34, v34, v40
  s_branch SK_P1
ST_P1:
  s_branch WR_x
SK_P1:
  v_add_f32 v35, v35, v41
  v_cmp_ne_u32 vcc, 0, v217
  s_cbranch_vccz K12_POLLD
  s_mov_b64 exec, vcc
  s_sub_u32 s41, s41, 1
  s_cmp_lg_u32 s41, 0
  s_cbranch_scc1 K12_POLL
K12_POLLD:
  s_mov_b64 exec, -1
  ds_write_b64 v46, v[32:33]
  v_add_f32 v34, 1.0, v34
  v_add_f32 v35, 1.0, v35
  ds_write_b64 v46, v[34:35] offset:2048
K12_BAR:
  s_waitcnt lgkmcnt(0)
  s_barrier
  ds_read_b128 v[16:19], v14 offset:2048
  ds_read_b128 v[24:27], v14
  ds_read_b128 v[20:23], v14 offset:2064
  ds_read_b128 v[28:31], v14 offset:16
  s_cmp_ge_u32 s30, 2
  s_cbranch_scc1 K12_NOT5
  buffer_load_dword v7, v212, s[12:15], 0 offen
K12_NOT5:
  s_cmp_lg_u32 s30, 3
  s_cbranch_scc1 K12_NOT3
  buffer_load_dword v7, v210, s[20:23], s55 offen offset:2048
  global_load_dword v15, v211, s[98:99]
K12_NOT3:
  s_waitcnt lgkmcnt(0)
  v_pk_fma_f32 v[80:81], v[80:81], v[16:17], v[24:25]
  v_pk_fma_f32 v[82:83], v[82:83], v[18:19], v[26:27]
  v_pk_fma_f32 v[84:85], v[84:85], v[20:21], v[28:29]
  v_pk_fma_f32 v[86:87], v[86:87], v[22:23], v[30:31]
  v_cvt_pk_bf16_f32 v160, v80, v81
  v_cvt_pk_bf16_f32 v161, v82, v83
  v_cvt_pk_bf16_f32 v162, v84, v85
  v_cvt_pk_bf16_f32 v163, v86, v87
  ds_write_b128 v13, v[160:163] offset:0
  v_pk_fma_f32 v[88:89], v[88:89], v[16:17], v[24:25]
  v_pk_fma_f32 v[90:91], v[90:91], v[18:19], v[26:27]
  v_pk_fma_f32 v[92:93], v[92:93], v[20:21], v[28:29]
  v_pk_fma_f32 v[94:95], v[94:95], v[22:23], v[30:31]
  v_cvt_pk_bf16_f32 v164, v88, v89
  v_cvt_pk_bf16_f32 v165, v90, v91
  v_cvt_pk_bf16_f32 v166, v92, v93
  v_cvt_pk_bf16_f32 v167, v94, v95
  ds_write_b128 v13, v[164:167] offset:16
  v_pk_fma_f32 v[96:97], v[96:97], v[16:17], v[24:25]
  v_pk_fma_f32 v[98:99], v[98:99], v[18:19], v[26:27]
  v_pk_fma_f32 v[100:101], v[100:101], v[20:21], v[28:29]
  v_pk_fma_f32 v[102:103], v[102:103], v[22:23], v[30:31]
  v_cvt_pk_bf16_f32 v168, v96, v97
  v_cvt_pk_bf16_f32 v169, v98, v99
  v_cvt_pk_bf16_f32 v170, v100, v101
  v_cvt_pk_bf16_f32 v171, v102, v103
  ds_write_b128 v13, v[168:171] offset:32
  v_pk_fma_f32 v[104:105], v[104:105], v[16:17], v[24:25]
  v_pk_fma_f32 v[106:107], v[106:107], v[18:19], v[26:27]
  v_pk_fma_f32 v[108:109], v[108:109], v[20:21], v[28:29]
  v_pk_fma_f32 v[110:111], v[110:111], v[22:23], v[30:31]
  v_cvt_pk_bf16_f32 v172, v104, v105
  v_cvt_pk_bf16_f32 v173, v106, v107
  v_cvt_pk_bf16_f32 v174, v108, v109
  v_cvt_pk_bf16_f32 v175, v110, v111
  ds_write_b128 v13, v[172:175] offset:48
  v_pk_fma_f32 v[112:113], v[112:113], v[16:17], v[24:25]
  v_pk_fma_f32 v[114:115], v[114:115], v[18:19], v[26:27]
  v_pk_fma_f32 v[116:117], v[116:117], v[20:21], v[28:29]
  v_pk_fma_f32 v[118:119], v[118:119], v[22:23], v[30:31]
  v_cvt_pk_bf16_f32 v176, v112, v113
  v_cvt_pk_bf16_f32 v177, v114, v115
  v_cvt_pk_bf16_f32 v178, v116, v117
  v_cvt_pk_bf16_f32 v179, v118, v119
  ds_write_b128 v13, v[176:179] offset:64
  v_pk_fma_f32 v[120:121], v[120:121], v[16:17], v[24:25]
  v_pk_fma_f32 v[122:123], v[122:123], v[18:19], v[26:27]
  v_pk_fma_f32 v[124:125], v[124:125], v[20:21], v[28:29]
  v_pk_fma_f32 v[126:127], v[126:127], v[22:23], v[30:31]
  v_cvt_pk_bf16_f32 v180, v120, v121
  v_cvt_pk_bf16_f32 v181, v122, v123
  v_cvt_pk_bf16_f32 v182, v124, v125
  v_cvt_pk_bf16_f32 v183, v126, v127
  ds_write_b128 v13, v[180:183] offset:80
  v_pk_fma_f32 v[128:129], v[128:129], v[16:17], v[24:25]
  v_pk_fma_f32 v[130:131], v[130:131], v[18:19], v[26:27]
  v_pk_fma_f32 v[132:133], v[132:133], v[20:21], v[28:29]
  v_pk_fma_f32 v[134:135], v[134:135], v[22:23], v[30:31]
  v_cvt_pk_bf16_f32 v184, v128, v129
  v_cvt_pk_bf16_f32 v185, v130, v131
  v_cvt_pk_bf16_f32 v186, v132, v133
  v_cvt_pk_bf16_f32 v187, v134, v135
  ds_write_b128 v13, v[184:187] offset:96
  v_pk_fma_f32 v[136:137], v[136:137], v[16:17], v[24:25]
  v_pk_fma_f32 v[138:139], v[138:139], v[18:19], v[26:27]
  v_pk_fma_f32 v[140:141], v[140:141], v[20:21], v[28:29]
  v_pk_fma_f32 v[142:143], v[142:143], v[22:23], v[30:31]
  v_cvt_pk_bf16_f32 v188, v136, v137
  v_cvt_pk_bf16_f32 v189, v138, v139
  v_cvt_pk_bf16_f32 v190, v140, v141
  v_cvt_pk_bf16_f32 v191, v142, v143
  ds_write_b128 v13, v[188:191] offset:112
  s_cmp_ge_u32 s30, 4
  s_cbranch_scc1 K12_LOADER
  s_setprio 1
  s_lshl_b32 s38, s32, 17
  s_lshl_b32 s29, s34, 10
  s_add_u32 s38, s38, s29
  s_add_u32 s39, s38, 0x300000
  s_add_u32 s40, s39, 0x10000
  s_add_u32 s41, s38, 0x500000
  s_add_u32 s42, s41, 0x10000
  s_add_u32 s43, s38, 0x700000
  s_mov_b32 s44, 0x3eb8aa3b
  s_lshl_b32 s29, s32, 6
  s_add_u32 s29, s29, s34
  s_lshl_b32 s29, s29, 7
  s_add_u32 s100, s29, 0xc0000
  s_mov_b32 s46, 0xff
  s_mov_b32 s47, 0xff
  s_waitcnt lgkmcnt(0)
  s_barrier
  ds_read_b128 v[128:131], v12 offset:0
  ds_read_b64_tr_b16 v[96:97], v10 offset:0
  ds_read_b64_tr_b16 v[98:99], v10 offset:512
  ds_read_b128 v[132:135], v12 offset:1056
  ds_read_b64_tr_b16 v[100:101], v10 offset:2048
  ds_read_b64_tr_b16 v[102:103], v10 offset:2560
  ds_read_b128 v[136:139], v12 offset:2112
  ds_read_b64_tr_b16 v[104:105], v10 offset:4096
  ds_read_b64_tr_b16 v[106:107], v10 offset:4608
  ds_read_b128 v[140:143], v12 offset:3168
  ds_read_b64_tr_b16 v[108:109], v10 offset:6144
  ds_read_b64_tr_b16 v[110:111], v10 offset:6656
  s_waitcnt lgkmcnt(9)
  v_mfma_f32_32x32x16_bf16 v[80:95], v[96:99], v[128:131], 0
  ds_read_b128 v[144:147], v12 offset:4224
  ds_read_b64_tr_b16 v[112:113], v10 offset:8192
  ds_read_b64_tr_b16 v[114:115], v10 offset:8704
  ds_read_b64_tr_b16 v[116:117], v10 offset:10240
  ds_read_b64_tr_b16 v[118:119], v10 offset:10752
  s_waitcnt lgkmcnt(11)
  v_mfma_f32_32x32x16_bf16 v[80:95], v[100:103], v[132:135], v[80:95]
  ds_read_b128 v[148:151], v12 offset:5280
  ds_read_b64_tr_b16 v[120:121], v10 offset:12288
  ds_read_b64_tr_b16 v[122:123], v10 offset:12800
  s_waitcnt lgkmcnt(11)
  v_mfma_f32_32x32x16_bf16 v[80:95], v[104:107], v[136:139], v[80:95]
  ds_read_b128 v[152:155], v12 offset:6336
  ds_read_b64_tr_b16 v[124:125], v10 offset:14336
  ds_read_b64_tr_b16 v[126:127], v10 offset:14848
  s_waitcnt lgkmcnt(11)
  v_mfma_f32_32x32x16_bf16 v[80:95], v[108:111], v[140:143], v[80:95]
  ds_read_b128 v[156:159], v12 offset:7392
  s_barrier
  ds_read_b64_tr_b16 v[96:97], v10 offset:16384
  ds_read_b64_tr_b16 v[98:99], v10 offset:16896
  s_waitcnt lgkmcnt(11)
  v_mfma_f32_32x32x16_bf16 v[80:95], v[112:115], v[144:147], v[80:95]
  ds_read_b128 v[160:163], v12 offset:8448
  ds_read_b64_tr_b16 v[100:101], v10 offset:18432
  ds_read_b64_tr_b16 v[102:103], v10 offset:18944
  s_waitcnt lgkmcnt(11)
  v_mfma_f32_32x32x16_bf16 v[80:95], v[116:119], v[148:151], v[80:95]
  ds_read_b128 v[164:167], v12 offset:9504
  ds_read_b64_tr_b16 v[104:105], v10 offset:20480
  ds_read_b64_tr_b16 v[106:107], v10 offset:20992
  s_waitcnt lgkmcnt(11)
  v_mfma_f32_32x32x16_bf16 v[80:95], v[120:123], v[152:155], v[80:95]
  ds_read_b128 v[168:171], v12 offset:10560
  ds_read_b64_tr_b16 v[108:109], v10 offset:22528
  ds_read_b64_tr_b16 v[110:111], v10 offset:23040
  s_waitcnt lgkmcnt(11)
  v_mfma_f32_32x32x16_bf16 v[80:95], v[124:127], v[156:159], v[80:95]
  ds_read_b128 v[172:175], v12 offset:11616
  ds_read_b64_tr_b16 v[112:113], v10 offset:24576
  ds_read_b64_tr_b16 v[114:115], v10 offset:25088
  s_waitcnt lgkmcnt(11)
  v_mfma_f32_32x32x16_bf16 v[80:95], v[96:99], v[160:163], v[80:95]
  ds_read_b128 v[176:179], v12 offset:12672
  ds_read_b64_tr_b16 v[116:117], v10 offset:26624
  ds_read_b64_tr_b16 v[118:119], v10 offset:27136
  v_and_b32 v14, 15, v1
  s_waitcnt lgkmcnt(11)
  v_mfma_f32_32x32x16_bf16 v[80:95], v[100:103], v[164:167], v[80:95]
  ds_read_b128 v[180:183], v12 offset:13728
  ds_read_b64_tr_b16 v[120:121], v10 offset:28672
  ds_read_b64_tr_b16 v[122:123], v10 offset:29184
  v_lshlrev_b32 v14, 4, v14
  s_waitcnt lgkmcnt(11)
  v_mfma_f32_32x32x16_bf16 v[80:95], v[104:107], v[168:171], v[80:95]
  ds_read_b128 v[184:187], v12 offset:14784
  ds_read_b64_tr_b16 v[124:125], v10 offset:30720
  ds_read_b64_tr_b16 v[126:127], v10 offset:31232
  v_lshrrev_b32 v6, 5, v1
  s_waitcnt lgkmcnt(11)
  v_mfma_f32_32x32x16_bf16 v[80:95], v[108:111], v[172:175], v[80:95]
  ds_read_b128 v[188:191], v12 offset:15840
  s_barrier
  ds_read_b64_tr_b16 v[96:97], v10 offset:32768
  ds_read_b64_tr_b16 v[98:99], v10 offset:33280
  v_lshl_add_u32 v14, v6, 8, v14
  s_waitcnt lgkmcnt(11)
  v_mfma_f32_32x32x16_bf16 v[80:95], v[112:115], v[176:179], v[80:95]
  ds_read_b128 v[192:195], v12 offset:16896
  ds_read_b64_tr_b16 v[100:101], v10 offset:34816
  ds_read_b64_tr_b16 v[102:103], v10 offset:35328
  v_bfe_u32 v5, v1, 4, 1
  s_waitcnt lgkmcnt(11)
  v_mfma_f32_32x32x16_bf16 v[80:95], v[116:119], v[180:183], v[80:95]
  ds_read_b128 v[196:199], v12 offset:17952
  ds_read_b64_tr_b16 v[104:105], v10 offset:36864
  ds_read_b64_tr_b16 v[106:107], v10 offset:37376
  v_lshl_add_u32 v14, v5, 16, v14
  s_waitcnt lgkmcnt(11)
  v_mfma_f32_32x32x16_bf16 v[80:95], v[120:123], v[184:187], v[80:95]
  ds_read_b128 v[200:203], v12 offset:19008
  ds_read_b64_tr_b16 v[108:109], v10 offset:38912
  ds_read_b64_tr_b16 v[110:111], v10 offset:39424
  s_waitcnt lgkmcnt(11)
  v_mfma_f32_32x32x16_bf16 v[80:95], v[124:127], v[188:191], v[80:95]
  ds_read_b128 v[204:207], v12 offset:20064
  ds_read_b64_tr_b16 v[112:113], v10 offset:40960
  ds_read_b64_tr_b16 v[114:115], v10 offset:41472
  s_waitcnt lgkmcnt(11)
  v_mfma_f32_32x32x16_bf16 v[80:95], v[96:99], v[192:195], v[80:95]
  ds_read_b128 v[208:211], v12 offset:21120
  ds_read_b64_tr_b16 v[116:117], v10 offset:43008
  ds_read_b64_tr_b16 v[118:119], v10 offset:43520
  s_waitcnt lgkmcnt(11)
  v_mfma_f32_32x32x16_bf16 v[80:95], v[100:103], v[196:199], v[80:95]
  ds_read_b128 v[212:215], v12 offset:22176
  ds_read_b64_tr_b16 v[120:121], v10 offset:45056
  ds_read_b64_tr_b16 v[122:123], v10 offset:45568
  s_waitcnt lgkmcnt(11)
  v_mfma_f32_32x32x16_bf16 v[80:95], v[104:107], v[200:203], v[80:95]
  ds_read_b128 v[216:219], v12 offset:23232
  ds_read_b64_tr_b16 v[124:125], v10 offset:47104
  ds_read_b64_tr_b16 v[126:127], v10 offset:47616
  s_waitcnt lgkmcnt(11)
  v_mfma_f32_32x32x16_bf16 v[80:95], v[108:111], v[204:207], v[80:95]
  ds_read_b128 v[220:223], v12 offset:24288
  s_barrier
  ds_read_b64_tr_b16 v[96:97], v11 offset:0
  ds_read_b64_tr_b16 v[98:99], v11 offset:512
  s_waitcnt lgkmcnt(11)
  v_mfma_f32_32x32x16_bf16 v[80:95], v[112:115], v[208:211], v[80:95]
  ds_read_b128 v[224:227], v12 offset:25344
  ds_read_b64_tr_b16 v[100:101], v11 offset:2048
  ds_read_b64_tr_b16 v[102:103], v11 offset:2560
  s_waitcnt lgkmcnt(11)
  v_mfma_f32_32x32x16_bf16 v[80:95], v[116:119], v[212:215], v[80:95]
  ds_read_b128 v[228:231], v12 offset:26400
  ds_read_b64_tr_b16 v[104:105], v11 offset:4096
  ds_read_b64_tr_b16 v[106:107], v11 offset:4608
  s_waitcnt lgkmcnt(11)
  v_mfma_f32_32x32x16_bf16 v[80:95], v[120:123], v[216:219], v[80:95]
  ds_read_b128 v[232:235], v12 offset:27456
  ds_read_b64_tr_b16 v[108:109], v11 offset:6144
  ds_read_b64_tr_b16 v[110:111], v11 offset:6656
  s_waitcnt lgkmcnt(11)
  v_mfma_f32_32x32x16_bf16 v[80:95], v[124:127], v[220:223], v[80:95]
  ds_read_b128 v[236:239], v12 offset:28512
  ds_read_b64_tr_b16 v[112:113], v11 offset:8192
  ds_read_b64_tr_b16 v[114:115], v11 offset:8704
  s_waitcnt lgkmcnt(11)
  v_mfma_f32_32x32x16_bf16 v[80:95], v[96:99], v[224:227], v[80:95]
  ds_read_b128 v[240:243], v12 offset:29568
  ds_read_b64_tr_b16 v[116:117], v11 offset:10240
  ds_read_b64_tr_b16 v[118:119], v11 offset:10752
  s_waitcnt lgkmcnt(11)
  v_mfma_f32_32x32x16_bf16 v[80:95], v[100:103], v[228:231], v[80:95]
  ds_read_b128 v[244:247], v12 offset:30624
  ds_read_b64_tr_b16 v[120:121], v11 offset:12288
  ds_read_b64_tr_b16 v[122:123], v11 offset:12800
  s_waitcnt lgkmcnt(11)
  v_mfma_f32_32x32x16_bf16 v[80:95], v[104:107], v[232:235], v[80:95]
  ds_read_b128 v[248:251], v12 offset:31680
  ds_read_b64_tr_b16 v[124:125], v11 offset:14336
  ds_read_b64_tr_b16 v[126:127], v11 offset:14848
  s_waitcnt lgkmcnt(11)
  v_mfma_f32_32x32x16_bf16 v[80:95], v[108:111], v[236:239], v[80:95]
  ds_read_b128 v[252:255], v12 offset:32736
  s_barrier
  ds_read_b64_tr_b16 v[96:97], v11 offset:16384
  ds_read_b64_tr_b16 v[98:99], v11 offset:16896
  ds_read_b64_tr_b16 v[100:101], v11 offset:18432
  ds_read_b64_tr_b16 v[102:103], v11 offset:18944
  s_waitcnt lgkmcnt(13)
  v_mfma_f32_32x32x16_bf16 v[80:95], v[112:115], v[240:243], v[80:95]
  ds_read_b64_tr_b16 v[104:105], v11 offset:20480
  ds_read_b64_tr_b16 v[106:107], v11 offset:20992
  s_waitcnt lgkmcnt(12)
  v_mfma_f32_32x32x16_bf16 v[80:95], v[116:119], v[244:247], v[80:95]
  ds_read_b64_tr_b16 v[108:109], v11 offset:22528
  ds_read_b64_tr_b16 v[110:111], v11 offset:23040
  s_waitcnt lgkmcnt(11)
  v_mfma_f32_32x32x16_bf16 v[80:95], v[120:123], v[248:251], v[80:95]
  ds_read_b64_tr_b16 v[112:113], v11 offset:24576
  ds_read_b64_tr_b16 v[114:115], v11 offset:25088
  s_waitcnt lgkmcnt(10)
  v_mfma_f32_32x32x16_bf16 v[80:95], v[124:127], v[252:255], v[80:95]
  ds_read_b64_tr_b16 v[116:117], v11 offset:26624
  ds_read_b64_tr_b16 v[118:119], v11 offset:27136
  s_waitcnt lgkmcnt(10)
  v_mfma_f32_32x32x16_bf16 v[48:63], v[96:99], v[128:131], 0
  ds_read_b64_tr_b16 v[120:121], v11 offset:28672
  ds_read_b64_tr_b16 v[122:123], v11 offset:29184
  s_waitcnt lgkmcnt(10)
  v_mfma_f32_32x32x16_bf16 v[48:63], v[100:103], v[132:135], v[48:63]
  ds_read_b64_tr_b16 v[124:125], v11 offset:30720
  ds_read_b64_tr_b16 v[126:127], v11 offset:31232
  s_waitcnt lgkmcnt(10)
  v_mfma_f32_32x32x16_bf16 v[48:63], v[104:107], v[136:139], v[48:63]
  s_barrier
  ds_read_b64_tr_b16 v[96:97], v10 offset:0
  ds_read_b64_tr_b16 v[98:99], v10 offset:512
  v_pk_mul_f32 v[80:81], v[80:81], s[44:45] op_sel:[0,0] op_sel_hi:[1,0]
  v_pk_mul_f32 v[82:83], v[82:83], s[44:45] op_sel:[0,0] op_sel_hi:[1,0]
  v_pk_mul_f32 v[84:85], v[84:85], s[44:45] op_sel:[0,0] op_sel_hi:[1,0]
  s_waitcnt lgkmcnt(10)
  v_mfma_f32_32x32x16_bf16 v[48:63], v[108:111], v[140:143], v[48:63]
  ds_read_b64_tr_b16 v[100:101], v10 offset:2048
  ds_read_b64_tr_b16 v[102:103], v10 offset:2560
  v_pk_mul_f32 v[86:87], v[86:87], s[44:45] op_sel:[0,0] op_sel_hi:[1,0]
  v_pk_mul_f32 v[88:89], v[88:89], s[44:45] op_sel:[0,0] op_sel_hi:[1,0]
  v_pk_mul_f32 v[90:91], v[90:91], s[44:45] op_sel:[0,0] op_sel_hi:[1,0]
  s_waitcnt lgkmcnt(10)
  v_mfma_f32_32x32x16_bf16 v[48:63], v[112:115], v[144:147], v[48:63]
  ds_read_b64_tr_b16 v[104:105], v10 offset:4096
  ds_read_b64_tr_b16 v[106:107], v10 offset:4608
  v_pk_mul_f32 v[92:93], v[92:93], s[44:45] op_sel:[0,0] op_sel_hi:[1,0]
  v_pk_mul_f32 v[94:95], v[94:95], s[44:45] op_sel:[0,0] op_sel_hi:[1,0]
  v_cvt_pk_bf16_f32 v32, v80, v81
  s_waitcnt lgkmcnt(10)
  v_mfma_f32_32x32x16_bf16 v[48:63], v[116:119], v[148:151], v[48:63]
  ds_read_b64_tr_b16 v[108:109], v10 offset:6144
  ds_read_b64_tr_b16 v[110:111], v10 offset:6656
  v_cvt_pk_bf16_f32 v33, v82, v83
  v_cvt_pk_bf16_f32 v34, v84, v85
  v_cvt_pk_bf16_f32 v35, v86, v87
  s_waitcnt lgkmcnt(10)
  v_mfma_f32_32x32x16_bf16 v[48:63], v[120:123], v[152:155], v[48:63]
  ds_read_b64_tr_b16 v[112:113], v10 offset:8192
  ds_read_b64_tr_b16 v[114:115], v10 offset:8704
  buffer_store_dwordx4 v[32:35], v2, s[24:27], s39 offen sc1
  v_cvt_pk_bf16_f32 v36, v88, v89
  v_cvt_pk_bf16_f32 v37, v90, v91
  s_waitcnt lgkmcnt(10)
  v_mfma_f32_32x32x16_bf16 v[48:63], v[124:127], v[156:159], v[48:63]
  ds_read_b64_tr_b16 v[116:117], v10 offset:10240
  ds_read_b64_tr_b16 v[118:119], v10 offset:10752
  v_cvt_pk_bf16_f32 v38, v92, v93
  v_cvt_pk_bf16_f32 v39, v94, v95
  buffer_store_dwordx4 v[36:39], v2, s[24:27], s40 offen sc1
  s_waitcnt lgkmcnt(10)
  v_mfma_f32_32x32x16_bf16 v[48:63], v[96:99], v[160:163], v[48:63]
  ds_read_b64_tr_b16 v[120:121], v10 offset:12288
  ds_read_b64_tr_b16 v[122:123], v10 offset:12800
  v_mov_b32 v40, s101
  v_mov_b32 v41, s101
  v_mov_b32 v42, s101
  s_waitcnt lgkmcnt(10)
  v_mfma_f32_32x32x16_bf16 v[48:63], v[100:103], v[164:167], v[48:63]
  ds_read_b64_tr_b16 v[124:125], v10 offset:14336
  ds_read_b64_tr_b16 v[126:127], v10 offset:14848
  v_mov_b32 v43, s101
  s_add_u32 s29, s100, 0x20000
  s_waitcnt lgkmcnt(10)
  v_mfma_f32_32x32x16_bf16 v[48:63], v[104:107], v[168:171], v[48:63]
  s_barrier
  ds_read_b64_tr_b16 v[96:97], v10 offset:16384
  ds_read_b64_tr_b16 v[98:99], v10 offset:16896
  s_waitcnt lgkmcnt(10)
  v_mfma_f32_32x32x16_bf16 v[48:63], v[108:111], v[172:175], v[48:63]
  ds_read_b64_tr_b16 v[100:101], v10 offset:18432
  ds_read_b64_tr_b16 v[102:103], v10 offset:18944
  s_waitcnt lgkmcnt(10)
  v_mfma_f32_32x32x16_bf16 v[48:63], v[112:115], v[176:179], v[48:63]
  ds_read_b64_tr_b16 v[104:105], v10 offset:20480
  ds_read_b64_tr_b16 v[106:107], v10 offset:20992
  s_waitcnt lgkmcnt(10)
  v_mfma_f32_32x32x16_bf16 v[48:63], v[116:119], v[180:183], v[48:63]
  ds_read_b64_tr_b16 v[108:109], v10 offset:22528
  ds_read_b64_tr_b16 v[110:111], v10 offset:23040
  s_waitcnt lgkmcnt(10)
  v_mfma_f32_32x32x16_bf16 v[48:63], v[120:123], v[184:187], v[48:63]
  ds_read_b64_tr_b16 v[112:113], v10 offset:24576
  ds_read_b64_tr_b16 v[114:115], v10 offset:25088
  s_waitcnt lgkmcnt(10)
  v_mfma_f32_32x32x16_bf16 v[48:63], v[124:127], v[188:191], v[48:63]
  ds_read_b64_tr_b16 v[116:117], v10 offset:26624
  ds_read_b64_tr_b16 v[118:119], v10 offset:27136
  s_waitcnt lgkmcnt(10)
  v_mfma_f32_32x32x16_bf16 v[48:63], v[96:99], v[192:195], v[48:63]
  ds_read_b64_tr_b16 v[120:121], v10 offset:28672
  ds_read_b64_tr_b16 v[122:123], v10 offset:29184
  s_waitcnt lgkmcnt(10)
  v_mfma_f32_32x32x16_bf16 v[48:63], v[100:103], v[196:199], v[48:63]
  ds_read_b64_tr_b16 v[124:125], v10 offset:30720
  ds_read_b64_tr_b16 v[126:127], v10 offset:31232
  s_waitcnt lgkmcnt(10)
  v_mfma_f32_32x32x16_bf16 v[48:63], v[104:107], v[200:203], v[48:63]
  s_barrier
  ds_read_b64_tr_b16 v[96:97], v10 offset:32768
  ds_read_b64_tr_b16 v[98:99], v10 offset:33280
  s_waitcnt lgkmcnt(10)
  v_mfma_f32_32x32x16_bf16 v[48:63], v[108:111], v[204:207], v[48:63]
  ds_read_b64_tr_b16 v[100:101], v10 offset:34816
  ds_read_b64_tr_b16 v[102:103], v10 offset:35328
  s_waitcnt lgkmcnt(10)
  v_mfma_f32_32x32x16_bf16 v[48:63], v[112:115], v[208:211], v[48:63]
  ds_read_b64_tr_b16 v[104:105], v10 offset:36864
  ds_read_b64_tr_b16 v[106:107], v10 offset:37376
  s_waitcnt lgkmcnt(10)
  v_mfma_f32_32x32x16_bf16 v[48:63], v[116:119], v[212:215], v[48:63]
  ds_read_b64_tr_b16 v[108:109], v10 offset:38912
  ds_read_b64_tr_b16 v[110:111], v10 offset:39424
  s_waitcnt lgkmcnt(10)
  v_mfma_f32_32x32x16_bf16 v[48:63], v[120:123], v[216:219], v[48:63]
  ds_read_b64_tr_b16 v[112:113], v10 offset:40960
  ds_read_b64_tr_b16 v[114:115], v10 offset:41472
  s_waitcnt lgkmcnt(10)
  v_mfma_f32_32x32x16_bf16 v[48:63], v[124:127], v[220:223], v[48:63]
  ds_read_b64_tr_b16 v[116:117], v10 offset:43008
  ds_read_b64_tr_b16 v[118:119], v10 offset:43520
  s_waitcnt lgkmcnt(10)
  v_mfma_f32_32x32x16_bf16 v[48:63], v[96:99], v[224:227], v[48:63]
  ds_read_b64_tr_b16 v[120:121], v10 offset:45056
  ds_read_b64_tr_b16 v[122:123], v10 offset:45568
  s_waitcnt lgkmcnt(10)
  v_mfma_f32_32x32x16_bf16 v[48:63], v[100:103], v[228:231], v[48:63]
  ds_read_b64_tr_b16 v[124:125], v10 offset:47104
  ds_read_b64_tr_b16 v[126:127], v10 offset:47616
  s_waitcnt lgkmcnt(10)
  v_mfma_f32_32x32x16_bf16 v[48:63], v[104:107], v[232:235], v[48:63]
  s_barrier
  ds_read_b64_tr_b16 v[96:97], v11 offset:0
  ds_read_b64_tr_b16 v[98:99], v11 offset:512
  s_waitcnt lgkmcnt(10)
  v_mfma_f32_32x32x16_bf16 v[48:63], v[108:111], v[236:239], v[48:63]
  ds_read_b64_tr_b16 v[100:101], v11 offset:2048
  ds_read_b64_tr_b16 v[102:103], v11 offset:2560
  s_waitcnt lgkmcnt(10)
  v_mfma_f32_32x32x16_bf16 v[48:63], v[112:115], v[240:243], v[48:63]
  ds_read_b64_tr_b16 v[104:105], v11 offset:4096
  ds_read_b64_tr_b16 v[106:107], v11 offset:4608
  s_waitcnt lgkmcnt(10)
  v_mfma_f32_32x32x16_bf16 v[48:63], v[116:119], v[244:247], v[48:63]
  ds_read_b64_tr_b16 v[108:109], v11 offset:6144
  ds_read_b64_tr_b16 v[110:111], v11 offset:6656
  s_waitcnt lgkmcnt(10)
  v_mfma_f32_32x32x16_bf16 v[48:63], v[120:123], v[248:251], v[48:63]
  ds_read_b64_tr_b16 v[112:113], v11 offset:8192
  ds_read_b64_tr_b16 v[114:115], v11 offset:8704
  s_waitcnt lgkmcnt(10)
  v_mfma_f32_32x32x16_bf16 v[48:63], v[124:127], v[252:255], v[48:63]
  ds_read_b64_tr_b16 v[116:117], v11 offset:10240
  ds_read_b64_tr_b16 v[118:119], v11 offset:10752
  s_waitcnt lgkmcnt(10)
  v_mfma_f32_32x32x16_bf16 v[64:79], v[128:131], v[96:99], 0
  ds_read_b64_tr_b16 v[120:121], v11 offset:12288
  ds_read_b64_tr_b16 v[122:123], v11 offset:12800
  s_waitcnt lgkmcnt(10)
  v_mfma_f32_32x32x16_bf16 v[64:79], v[132:135], v[100:103], v[64:79]
  ds_read_b64_tr_b16 v[124:125], v11 offset:14336
  ds_read_b64_tr_b16 v[126:127], v11 offset:14848
  s_waitcnt lgkmcnt(10)
  v_mfma_f32_32x32x16_bf16 v[64:79], v[136:139], v[104:107], v[64:79]
  s_barrier
  ds_read_b64_tr_b16 v[96:97], v11 offset:16384
  ds_read_b64_tr_b16 v[98:99], v11 offset:16896
  v_cvt_pk_bf16_f32 v16, v48, v49
  v_cvt_pk_bf16_f32 v17, v50, v51
  v_cvt_pk_bf16_f32 v18, v52, v53
  s_waitcnt lgkmcnt(10)
  v_mfma_f32_32x32x16_bf16 v[64:79], v[140:143], v[108:111], v[64:79]
  ds_read_b64_tr_b16 v[100:101], v11 offset:18432
  ds_read_b64_tr_b16 v[102:103], v11 offset:18944
  v_cvt_pk_bf16_f32 v19, v54, v55
  buffer_store_dwordx4 v[16:19], v2, s[24:27], s41 offen sc1
  v_cvt_pk_bf16_f32 v20, v56, v57
  s_waitcnt lgkmcnt(10)
  v_mfma_f32_32x32x16_bf16 v[64:79], v[144:147], v[112:115], v[64:79]
  ds_read_b64_tr_b16 v[104:105], v11 offset:20480
  ds_read_b64_tr_b16 v[106:107], v11 offset:20992
  v_cvt_pk_bf16_f32 v21, v58, v59
  v_cvt_pk_bf16_f32 v22, v60, v61
  v_cvt_pk_bf16_f32 v23, v62, v63
  s_waitcnt lgkmcnt(10)
  v_mfma_f32_32x32x16_bf16 v[64:79], v[148:151], v[116:119], v[64:79]
  ds_read_b64_tr_b16 v[108:109], v11 offset:22528
  ds_read_b64_tr_b16 v[110:111], v11 offset:23040
  buffer_store_dwordx4 v[20:23], v2, s[24:27], s42 offen sc1
  s_waitcnt lgkmcnt(10)
  v_mfma_f32_32x32x16_bf16 v[64:79], v[152:155], v[120:123], v[64:79]
  ds_read_b64_tr_b16 v[112:113], v11 offset:24576
  ds_read_b64_tr_b16 v[114:115], v11 offset:25088
  s_waitcnt lgkmcnt(10)
  v_mfma_f32_32x32x16_bf16 v[64:79], v[156:159], v[124:127], v[64:79]
  ds_read_b64_tr_b16 v[116:117], v11 offset:26624
  ds_read_b64_tr_b16 v[118:119], v11 offset:27136
  s_waitcnt lgkmcnt(10)
  v_mfma_f32_32x32x16_bf16 v[64:79], v[160:163], v[96:99], v[64:79]
  ds_read_b64_tr_b16 v[120:121], v11 offset:28672
  ds_read_b64_tr_b16 v[122:123], v11 offset:29184
  s_waitcnt lgkmcnt(10)
  v_mfma_f32_32x32x16_bf16 v[64:79], v[164:167], v[100:103], v[64:79]
  ds_read_b64_tr_b16 v[124:125], v11 offset:30720
  ds_read_b64_tr_b16 v[126:127], v11 offset:31232
  s_waitcnt lgkmcnt(10)
  v_mfma_f32_32x32x16_bf16 v[64:79], v[168:171], v[104:107], v[64:79]
  s_barrier
  ds_read_b64_tr_b16 v[96:97], v10 offset:0
  ds_read_b64_tr_b16 v[98:99], v10 offset:512
  s_waitcnt lgkmcnt(10)
  v_mfma_f32_32x32x16_bf16 v[64:79], v[172:175], v[108:111], v[64:79]
  ds_read_b64_tr_b16 v[100:101], v10 offset:2048
  ds_read_b64_tr_b16 v[102:103], v10 offset:2560
  s_waitcnt lgkmcnt(10)
  v_mfma_f32_32x32x16_bf16 v[64:79], v[176:179], v[112:115], v[64:79]
  ds_read_b64_tr_b16 v[104:105], v10 offset:4096
  ds_read_b64_tr_b16 v[106:107], v10 offset:4608
  s_waitcnt lgkmcnt(10)
  v_mfma_f32_32x32x16_bf16 v[64:79], v[180:183], v[116:119], v[64:79]
  ds_read_b64_tr_b16 v[108:109], v10 offset:6144
  ds_read_b64_tr_b16 v[110:111], v10 offset:6656
  s_waitcnt lgkmcnt(10)
  v_mfma_f32_32x32x16_bf16 v[64:79], v[184:187], v[120:123], v[64:79]
  ds_read_b64_tr_b16 v[112:113], v10 offset:8192
  ds_read_b64_tr_b16 v[114:115], v10 offset:8704
  s_waitcnt lgkmcnt(10)
  v_mfma_f32_32x32x16_bf16 v[64:79], v[188:191], v[124:127], v[64:79]
  ds_read_b64_tr_b16 v[116:117], v10 offset:10240
  ds_read_b64_tr_b16 v[118:119], v10 offset:10752
  s_waitcnt lgkmcnt(10)
  v_mfma_f32_32x32x16_bf16 v[64:79], v[192:195], v[96:99], v[64:79]
  ds_read_b64_tr_b16 v[120:121], v10 offset:12288
  ds_read_b64_tr_b16 v[122:123], v10 offset:12800
  s_waitcnt lgkmcnt(10)
  v_mfma_f32_32x32x16_bf16 v[64:79], v[196:199], v[100:103], v[64:79]
  ds_read_b64_tr_b16 v[124:125], v10 offset:14336
  ds_read_b64_tr_b16 v[126:127], v10 offset:14848
  s_waitcnt lgkmcnt(10)
  v_mfma_f32_32x32x16_bf16 v[64:79], v[200:203], v[104:107], v[64:79]
  s_barrier
  ds_read_b64_tr_b16 v[96:97], v10 offset:16384
  ds_read_b64_tr_b16 v[98:99], v10 offset:16896
  s_waitcnt lgkmcnt(10)
  v_mfma_f32_32x32x16_bf16 v[64:79], v[204:207], v[108:111], v[64:79]
  ds_read_b64_tr_b16 v[100:101], v10 offset:18432
  ds_read_b64_tr_b16 v[102:103], v10 offset:18944
  s_waitcnt lgkmcnt(10)
  v_mfma_f32_32x32x16_bf16 v[64:79], v[208:211], v[112:115], v[64:79]
  ds_read_b64_tr_b16 v[104:105], v10 offset:20480
  ds_read_b64_tr_b16 v[106:107], v10 offset:20992
  s_waitcnt lgkmcnt(10)
  v_mfma_f32_32x32x16_bf16 v[64:79], v[212:215], v[116:119], v[64:79]
  ds_read_b64_tr_b16 v[108:109], v10 offset:22528
  ds_read_b64_tr_b16 v[110:111], v10 offset:23040
  s_waitcnt lgkmcnt(10)
  v_mfma_f32_32x32x16_bf16 v[64:79], v[216:219], v[120:123], v[64:79]
  ds_read_b64_tr_b16 v[112:113], v10 offset:24576
  ds_read_b64_tr_b16 v[114:115], v10 offset:25088
  s_waitcnt lgkmcnt(10)
  v_mfma_f32_32x32x16_bf16 v[64:79], v[220:223], v[124:127], v[64:79]
  ds_read_b64_tr_b16 v[116:117], v10 offset:26624
  ds_read_b64_tr_b16 v[118:119], v10 offset:27136
  s_waitcnt lgkmcnt(10)
  v_mfma_f32_32x32x16_bf16 v[64:79], v[224:227], v[96:99], v[64:79]
  ds_read_b64_tr_b16 v[120:121], v10 offset:28672
  ds_read_b64_tr_b16 v[122:123], v10 offset:29184
  s_waitcnt lgkmcnt(10)
  v_mfma_f32_32x32x16_bf16 v[64:79], v[228:231], v[100:103], v[64:79]
  ds_read_b64_tr_b16 v[124:125], v10 offset:30720
  ds_read_b64_tr_b16 v[126:127], v10 offset:31232
  s_waitcnt lgkmcnt(10)
  v_mfma_f32_32x32x16_bf16 v[64:79], v[232:235], v[104:107], v[64:79]
  s_waitcnt lgkmcnt(8)
  v_mfma_f32_32x32x16_bf16 v[64:79], v[236:239], v[108:111], v[64:79]
  s_mov_b64 exec, 0xff
  s_waitcnt vmcnt(0)
  buffer_store_dwordx4 v[40:43], v2, s[24:27], s29 offen sc1
  s_mov_b64 exec, -1
  s_waitcnt lgkmcnt(6)
  v_mfma_f32_32x32x16_bf16 v[64:79], v[240:243], v[112:115], v[64:79]
  s_branch SK_P2
ST_P2:
  s_branch ST_LD
SK_P2:
  s_waitcnt lgkmcnt(4)
  v_mfma_f32_32x32x16_bf16 v[64:79], v[244:247], v[116:119], v[64:79]
  s_waitcnt lgkmcnt(2)
  v_mfma_f32_32x32x16_bf16 v[64:79], v[248:251], v[120:123], v[64:79]
  s_waitcnt lgkmcnt(0)
  v_mfma_f32_32x32x16_bf16 v[64:79], v[252:255], v[124:127], v[64:79]
  s_nop 11
  v_cvt_pk_bf16_f32 v24, v64, v65
  v_cvt_pk_bf16_f32 v25, v66, v67
  v_cvt_pk_bf16_f32 v26, v68, v69
  v_cvt_pk_bf16_f32 v27, v70, v71
  v_cvt_pk_bf16_f32 v28, v72, v73
  v_cvt_pk_bf16_f32 v29, v74, v75
  v_cvt_pk_bf16_f32 v30, v76, v77
  v_cvt_pk_bf16_f32 v31, v78, v79
  s_branch KF_START
ST_LD:
  s_branch ST_P3
K12_LOADER:
  s_waitcnt lgkmcnt(0)
  s_add_u32 m0, s40, 65536
  s_add_u32 s54, s53, 1024
  buffer_load_dwordx4 v8, s[12:15], s54 offen offset:0 lds
  buffer_load_dwordx4 v9, s[12:15], s54 offen offset:1024 lds
  s_add_u32 s54, s53, 48128
  buffer_load_dwordx4 v8, s[12:15], s54 offen offset:2048 lds
  buffer_load_dwordx4 v9, s[12:15], s54 offen offset:3072 lds
  s_barrier
  s_sub_u32 s4, s28, 8
  s_lshl_b32 s5, s3, 4
  s_add_u32 s5, s5, s4
  s_cmp_lt_u32 s4, 16
  s_cselect_b32 s6, -1, 0
  s_lshl_b32 s8, s5, 5
  s_add_u32 s8, s8, 2048
  s_and_b32 s8, s8, s6
  s_and_b32 s9, s6, 786432
  v_bfe_u32 v3, v0, 1, 7
  v_mul_u32_u24 v4, 6144, v3
  v_and_b32 v5, 1, v0
  v_lshl_add_u32 v4, v5, 4, v4
  v_and_b32 v4, s6, v4
  v_lshlrev_b32 v3, 1, v3
  v_lshrrev_b32 v46, 5, v1
  v_bfe_u32 v47, v1, 4, 1
  v_lshl_add_u32 v46, v47, 1, v46
  v_lshl_add_u32 v46, v5, 3, v46
  s_lshl_b32 s29, s38, 4
  v_add_u32 v46, s29, v46
  v_lshlrev_b32 v46, 2, v46
  v_add_u32 v136, 150528, v46
  buffer_load_ushort v128, v3, s[16:19], 0 offen offset:0
  buffer_load_ushort v129, v3, s[16:19], 0 offen offset:256
  buffer_load_ushort v130, v3, s[16:19], 0 offen offset:512
  buffer_load_ushort v131, v3, s[16:19], 0 offen offset:768
  s_waitcnt vmcnt(12)
  s_barrier
  s_barrier
  s_add_u32 m0, s40, 0
  s_add_u32 s54, s53, 394240
  buffer_load_dwordx4 v8, s[12:15], s54 offen offset:0 lds
  buffer_load_dwordx4 v9, s[12:15], s54 offen offset:1024 lds
  s_add_u32 s54, s53, 441344
  buffer_load_dwordx4 v8, s[12:15], s54 offen offset:2048 lds
  buffer_load_dwordx4 v9, s[12:15], s54 offen offset:3072 lds
  s_waitcnt vmcnt(12)
  s_barrier
  s_add_u32 m0, s40, 16384
  s_add_u32 s54, s53, 787456
  buffer_load_dwordx4 v8, s[12:15], s54 offen offset:0 lds
  buffer_load_dwordx4 v9, s[12:15], s54 offen offset:1024 lds
  s_add_u32 s54, s53, 834560
  buffer_load_dwordx4 v8, s[12:15], s54 offen offset:2048 lds
  buffer_load_dwordx4 v9, s[12:15], s54 offen offset:3072 lds
  s_waitcnt vmcnt(12)
  s_barrier
  s_add_u32 m0, s40, 32768
  s_add_u32 s54, s53, 1180672
  buffer_load_dwordx4 v8, s[12:15], s54 offen offset:0 lds
  buffer_load_dwordx4 v9, s[12:15], s54 offen offset:1024 lds
  s_add_u32 s54, s53, 1227776
  buffer_load_dwordx4 v8, s[12:15], s54 offen offset:2048 lds
  buffer_load_dwordx4 v9, s[12:15], s54 offen offset:3072 lds
  s_waitcnt vmcnt(8)
  s_barrier
  s_add_u32 m0, s40, 49152
  s_add_u32 s54, s53, 2048
  buffer_load_dwordx4 v8, s[12:15], s54 offen offset:0 lds
  buffer_load_dwordx4 v9, s[12:15], s54 offen offset:1024 lds
  s_add_u32 s54, s53, 49152
  buffer_load_dwordx4 v8, s[12:15], s54 offen offset:2048 lds
  buffer_load_dwordx4 v9, s[12:15], s54 offen offset:3072 lds
  s_waitcnt vmcnt(8)
  s_barrier
  s_add_u32 m0, s40, 65536
  s_add_u32 s54, s53, 395264
  buffer_load_dwordx4 v8, s[12:15], s54 offen offset:0 lds
  buffer_load_dwordx4 v9, s[12:15], s54 offen offset:1024 lds
  s_add_u32 s54, s53, 442368
  buffer_load_dwordx4 v8, s[12:15], s54 offen offset:2048 lds
  buffer_load_dwordx4 v9, s[12:15], s54 offen offset:3072 lds
  s_waitcnt vmcnt(8)
  s_barrier
  s_add_u32 m0, s40, 0
  s_add_u32 s54, s53, 788480
  buffer_load_dwordx4 v8, s[12:15], s54 offen offset:0 lds
  buffer_load_dwordx4 v9, s[12:15], s54 offen offset:1024 lds
  s_add_u32 s54, s53, 835584
  buffer_load_dwordx4 v8, s[12:15], s54 offen offset:2048 lds
  buffer_load_dwordx4 v9, s[12:15], s54 offen offset:3072 lds
  s_waitcnt vmcnt(8)
  s_barrier
  s_add_u32 m0, s40, 16384
  s_add_u32 s54, s53, 1181696
  buffer_load_dwordx4 v8, s[12:15], s54 offen offset:0 lds
  buffer_load_dwordx4 v9, s[12:15], s54 offen offset:1024 lds
  s_add_u32 s54, s53, 1228800
  buffer_load_dwordx4 v8, s[12:15], s54 offen offset:2048 lds
  buffer_load_dwordx4 v9, s[12:15], s54 offen offset:3072 lds
  s_waitcnt vmcnt(8)
  s_barrier
  s_cmp_eq_u32 s30, 4
  s_cbranch_scc1 ST_P4
WR_g:
  s_waitcnt vmcnt(4)
  s_barrier
  buffer_load_dwordx4 v[112:115], v4, s[20:23], s8 offen
  s_add_u32 s8, s8, s9
  buffer_load_dwordx4 v[116:119], v4, s[20:23], s8 offen
  s_add_u32 s8, s8, s9
  s_waitcnt vmcnt(2)
  s_barrier
  buffer_load_dwordx4 v[120:123], v4, s[20:23], s8 offen
  s_add_u32 s8, s8, s9
  buffer_load_dwordx4 v[124:127], v4, s[20:23], s8 offen
  s_add_u32 s8, s8, s9
KF_START:
  s_load_dwordx2 s[4:5], s[0:1], 16
  s_load_dwordx4 s[12:15], s[0:1], 32
  s_load_dwordx2 s[6:7], s[0:1], 48
  s_load_dwordx2 s[8:9], s[0:1], 0
  s_load_dwordx2 s[44:45], s[0:1], 72
  s_and_b32 s32, s30, 1
  s_lshr_b32 s33, s30, 1
  s_lshl_b32 s34, s3, 3
  s_lshl_b32 s29, s32, 2
  s_add_u32 s34, s34, s29
  v_and_b32 v3, 15, v1
  v_lshlrev_b32 v3, 4, v3
  v_lshrrev_b32 v4, 5, v1
  v_lshl_add_u32 v222, v4, 8, v3
  s_lshl_b32 s35, s28, 16
  s_lshl_b32 s36, s30, 10
  s_add_u32 s37, s35, s36
  s_add_u32 s37, s37, 0x500000
  s_and_b32 s29, s36, 4096
  s_add_u32 s36, s36, s29
  s_lshl_b32 s29, s33, 10
  v_add_u32 v220, s29, v2
  v_add_u32 v221, s29, v222
  v_add_u32 v221, 4096, v221
  s_cmp_eq_u32 s33, 3
  s_cselect_b32 s29, 2, 0
  s_add_u32 s34, s34, s29
  s_lshl_b32 s29, s34, 10
  s_add_u32 s38, s35, s29
  s_add_u32 s38, s38, 0x300000
  s_xor_b32 s42, s38, 2048
  s_lshr_b32 s39, s28, 1
  s_lshl_b32 s39, s39, 13
  s_and_b32 s29, s28, 1
  s_lshl_b32 s29, s29, 6
  s_add_u32 s39, s39, s29
  s_add_u32 s39, s39, 0xc0000
  v_lshlrev_b32 v5, 2, v1
  v_lshlrev_b32 v218, 7, v1
  v_and_b32 v4, 27, v1
  v_cmp_eq_u32 vcc, 16, v4
  v_mov_b32 v6, 0x3f803f80
  s_nop 0
  v_cndmask_b32 v6, 0, v6, vcc
  v_mov_b32 v7, v6
  v_mov_b64 v[32:33], v[6:7]
  v_mov_b64 v[34:35], v[6:7]
  v_mov_b64 v[36:37], v[6:7]
  v_mov_b64 v[38:39], v[6:7]
  v_mov_b64 v[40:41], v[6:7]
  v_mov_b64 v[42:43], v[6:7]
  v_mov_b64 v[44:45], v[6:7]
  v_mov_b64 v[46:47], v[6:7]
  v_mov_b64 v[232:233], v[6:7]
  v_mov_b64 v[234:235], v[6:7]
  v_mov_b64 v[236:237], v[6:7]
  v_mov_b64 v[238:239], v[6:7]
  s_mov_b32 s40, 0x0000ffff
  s_mov_b32 s41, 0x0000ffff
  s_waitcnt lgkmcnt(0)
  s_mov_b32 s48, s4
  s_mov_b32 s49, s5
  s_mov_b32 s50, 0x80000
  s_mov_b32 s51, 0x20000
  s_mov_b32 s52, s12
  s_mov_b32 s53, s13
  s_mov_b32 s54, 0x1c0000
  s_mov_b32 s55, 0x20000
  s_mov_b32 s56, s14
  s_mov_b32 s57, s15
  s_mov_b32 s58, 0x1c0000
  s_mov_b32 s59, 0x20000
  s_mov_b32 s60, s6
  s_mov_b32 s61, s7
  s_mov_b32 s62, 0x1c0000
  s_mov_b32 s63, 0x20000
  s_mov_b32 s16, s8
  s_mov_b32 s17, s9
  s_mov_b32 s18, 0x200000
  s_mov_b32 s19, 0x20000
  s_mov_b32 s20, s44
  s_mov_b32 s21, s45
  s_mov_b32 s22, 0x200000
  s_mov_b32 s23, 0x20000
  s_lshl_b32 s45, s3, 12
  s_add_u32 s45, s45, 0x10000
  s_getreg_b32 s44, hwreg(HW_REG_XCC_ID, 0, 4)
  s_mov_b32 s11, 0
  v_mov_b32 v48, 0
  v_mov_b32 v49, 0
  v_mov_b32 v50, 0
  v_mov_b32 v51, 0
  v_mov_b32 v52, 0
  v_mov_b32 v53, 0
  v_mov_b32 v54, 0
  v_mov_b32 v55, 0
  v_mfma_f32_32x32x16_bf16 v[152:167], v[48:51], v[48:51], 0
  v_mfma_f32_32x32x16_bf16 v[168:183], v[48:51], v[48:51], 0
  v_mfma_f32_32x32x16_bf16 v[184:199], v[48:51], v[48:51], 0
  v_mfma_f32_32x32x16_bf16 v[200:215], v[48:51], v[48:51], 0
  v_mov_b32 v223, 149504
  v_mov_b32 v151, 0xdddd
  v_mov_b32 v149, 0x07060302
  v_lshrrev_b32 v150, 1, v1
  v_xor_b32 v150, v150, v1
  v_and_b32 v150, 4, v150
  v_mul_u32_u24 v150, 48, v150
  s_add_u32 s44, s44, s101
  s_setprio 1
  s_cmp_ge_u32 s30, 4
  s_cbranch_scc1 P3_NOPRIO
  s_setprio 2
  v_mov_b32 v56, s101
  v_mov_b32 v57, s101
  v_mov_b32 v58, s101
  v_mov_b32 v59, s101
  s_waitcnt vmcnt(0)
  s_barrier
  buffer_store_dwordx4 v[24:27], v14, s[24:27], s43 offen sc1
  buffer_store_dwordx4 v[28:31], v14, s[24:27], s43 offen offset:512 sc1
  s_mov_b64 exec, 0xff
  s_waitcnt vmcnt(0)
  buffer_store_dwordx4 v[56:59], v2, s[24:27], s100 offen sc1
  s_mov_b64 exec, -1
  s_cmp_lg_u32 s30, 1
  s_cbranch_scc1 P3_NOXID
  s_lshl_b32 s29, s28, 2
  v_mov_b32 v216, s29
  v_mov_b32 v217, s44
  s_mov_b64 exec, 1
  buffer_store_dword v217, v216, s[24:27], s45 offen offset:2048 sc1
  s_mov_b64 exec, -1
P3_NOXID:
P3_NOPRIO:
  s_mov_b32 s10, 99
  s_mov_b32 s43, 0
  v_mov_b32 v249, 0
  v_mov_b32 v251, 0
  s_and_b32 s46, s38, 0x1fff
  s_lshl_b32 s47, s30, 9
  s_and_b32 s47, s47, 2048
  s_xor_b32 s46, s46, s47
  s_add_u32 s46, s46, 131072
  v_add_u32 v146, s46, v2
  v_xor_b32 v147, 2048, v146
  ds_write_b128 v223, v[48:51]
  s_cmp_lt_u32 s30, 4
  s_cbranch_scc1 P3_NOGV
  s_and_b32 s10, s30, 3
  s_lshl_b32 s10, s10, 1
  s_lshr_b32 s29, s28, 1
  s_lshl_b32 s29, s29, 3
  s_add_u32 s29, s29, s10
  s_lshl_b32 s10, s10, 10
  s_lshl_b32 s11, s3, 13
  s_add_u32 s11, s11, s35
  s_add_u32 s11, s11, s10
  s_add_u32 s11, s11, 0x300000
  s_lshr_b32 s47, s28, 1
  s_lshl_b32 s47, s47, 3
  s_add_u32 s47, s47, s3
  s_lshl_b32 s47, s47, 10
  s_lshr_b32 s29, s10, 3
  s_add_u32 s47, s47, s29
  s_add_u32 s47, s47, 0xe0000
  s_mov_b32 s46, 400000
  s_sub_u32 s29, s28, 8
  s_cmp_ge_u32 s29, 16
  s_cbranch_scc1 P3_NOGV1
  s_waitcnt vmcnt(0)
  v_lshlrev_b32 v128, 16, v128
  v_lshlrev_b32 v129, 16, v129
  v_lshlrev_b32 v130, 16, v130
  v_lshlrev_b32 v131, 16, v131
  v_mul_f32 v132, 0xbfb8aa3b, v128
  v_mul_f32 v133, 0xbfb8aa3b, v129
  v_mul_f32 v134, 0xbfb8aa3b, v130
  v_mul_f32 v135, 0xbfb8aa3b, v131
  v_exp_f32 v132, v132
  v_exp_f32 v133, v133
  v_exp_f32 v134, v134
  v_exp_f32 v135, v135
  v_add_f32 v132, 1.0, v132
  v_add_f32 v133, 1.0, v133
  v_add_f32 v134, 1.0, v134
  v_add_f32 v135, 1.0, v135
  v_rcp_f32 v132, v132
  v_rcp_f32 v133, v133
  v_rcp_f32 v134, v134
  v_rcp_f32 v135, v135
  v_mul_f32 v132, v128, v132
  v_mul_f32 v133, v129, v133
  v_mul_f32 v134, v130, v134
  v_mul_f32 v135, v131, v135
  v_cvt_pk_bf16_f32 v132, v132, v132
  v_cvt_pk_bf16_f32 v133, v133, v133
  v_cvt_pk_bf16_f32 v134, v134, v134
  v_cvt_pk_bf16_f32 v135, v135, v135
  v_lshlrev_b32 v132, 16, v132
  v_lshlrev_b32 v133, 16, v133
  v_lshlrev_b32 v134, 16, v134
  v_lshlrev_b32 v135, 16, v135
  v_lshlrev_b32 v64, 16, v112
  v_and_b32 v65, s31, v112
  v_pk_mul_f32 v[56:57], v[64:65], v[132:133] op_sel:[0,0] op_sel_hi:[1,0]
  v_lshlrev_b32 v66, 16, v113
  v_and_b32 v67, s31, v113
  v_pk_mul_f32 v[58:59], v[66:67], v[132:133] op_sel:[0,0] op_sel_hi:[1,0]
  v_lshlrev_b32 v64, 16, v114
  v_and_b32 v65, s31, v114
  v_pk_mul_f32 v[60:61], v[64:65], v[132:133] op_sel:[0,0] op_sel_hi:[1,0]
  v_lshlrev_b32 v66, 16, v115
  v_and_b32 v67, s31, v115
  v_pk_mul_f32 v[62:63], v[66:67], v[132:133] op_sel:[0,0] op_sel_hi:[1,0]
  v_lshlrev_b32 v64, 16, v116
  v_and_b32 v65, s31, v116
  v_pk_fma_f32 v[56:57], v[132:133], v[64:65], v[56:57] op_sel:[1,0,0] op_sel_hi:[1,1,1]
  v_lshlrev_b32 v66, 16, v117
  v_and_b32 v67, s31, v117
  v_pk_fma_f32 v[58:59], v[132:133], v[66:67], v[58:59] op_sel:[1,0,0] op_sel_hi:[1,1,1]
  v_lshlrev_b32 v64, 16, v118
  v_and_b32 v65, s31, v118
  v_pk_fma_f32 v[60:61], v[132:133], v[64:65], v[60:61] op_sel:[1,0,0] op_sel_hi:[1,1,1]
  v_lshlrev_b32 v66, 16, v119
  v_and_b32 v67, s31, v119
  v_pk_fma_f32 v[62:63], v[132:133], v[66:67], v[62:63] op_sel:[1,0,0] op_sel_hi:[1,1,1]
  v_lshlrev_b32 v64, 16, v120
  v_and_b32 v65, s31, v120
  v_pk_fma_f32 v[56:57], v[64:65], v[134:135], v[56:57] op_sel:[0,0,0] op_sel_hi:[1,0,1]
  v_lshlrev_b32 v66, 16, v121
  v_and_b32 v67, s31, v121
  v_pk_fma_f32 v[58:59], v[66:67], v[134:135], v[58:59] op_sel:[0,0,0] op_sel_hi:[1,0,1]
  v_lshlrev_b32 v64, 16, v122
  v_and_b32 v65, s31, v122
  v_pk_fma_f32 v[60:61], v[64:65], v[134:135], v[60:61] op_sel:[0,0,0] op_sel_hi:[1,0,1]
  v_lshlrev_b32 v66, 16, v123
  v_and_b32 v67, s31, v123
  v_pk_fma_f32 v[62:63], v[66:67], v[134:135], v[62:63] op_sel:[0,0,0] op_sel_hi:[1,0,1]
  v_lshlrev_b32 v64, 16, v124
  v_and_b32 v65, s31, v124
  v_pk_fma_f32 v[56:57], v[134:135], v[64:65], v[56:57] op_sel:[1,0,0] op_sel_hi:[1,1,1]
  v_lshlrev_b32 v66, 16, v125
  v_and_b32 v67, s31, v125
  v_pk_fma_f32 v[58:59], v[134:135], v[66:67], v[58:59] op_sel:[1,0,0] op_sel_hi:[1,1,1]
  v_lshlrev_b32 v64, 16, v126
  v_and_b32 v65, s31, v126
  v_pk_fma_f32 v[60:61], v[134:135], v[64:65], v[60:61] op_sel:[1,0,0] op_sel_hi:[1,1,1]
  v_lshlrev_b32 v66, 16, v127
  v_and_b32 v67, s31, v127
  v_pk_fma_f32 v[62:63], v[134:135], v[66:67], v[62:63] op_sel:[1,0,0] op_sel_hi:[1,1,1]
  v_permlane32_swap_b32 v56, v57
  v_permlane32_swap_b32 v58, v59
  v_permlane32_swap_b32 v60, v61
  v_permlane32_swap_b32 v62, v63
  v_add_f32 v64, v56, v57
  v_add_f32 v65, v58, v59
  v_add_f32 v66, v60, v61
  v_add_f32 v67, v62, v63
  v_permlane16_swap_b32 v64, v65
  s_nop 0
  v_permlane16_swap_b32 v66, v67
  v_add_f32 v68, v64, v65
  v_add_f32 v69, v66, v67
  s_nop 0
  v_add_f32_dpp v68, v68, v68 row_ror:8 row_mask:0xf bank_mask:0xf
  v_add_f32_dpp v69, v69, v69 row_ror:8 row_mask:0xf bank_mask:0xf
  s_nop 0
  v_add_f32_dpp v68, v68, v68 row_ror:4 row_mask:0xf bank_mask:0xf
  v_add_f32_dpp v69, v69, v69 row_ror:4 row_mask:0xf bank_mask:0xf
  s_nop 0
  v_add_f32_dpp v68, v68, v68 row_ror:2 row_mask:0xf bank_mask:0xf
  v_add_f32_dpp v69, v69, v69 row_ror:2 row_mask:0xf bank_mask:0xf
  ds_write_b32 v136, v68
  ds_write_b32 v136, v69 offset:16
P3_NOGV1:
  s_mov_b64 exec, 3
  s_barrier
KPQL:
  buffer_load_dword v216, v218, s[24:27], s47 offen sc1
  s_waitcnt vmcnt(0)
  v_cmp_ne_u32 vcc, s101, v216
  s_cbranch_vccz KPQD
  s_mov_b64 exec, vcc
  s_sleep 2
  s_sub_u32 s46, s46, 1
  s_cmp_lg_u32 s46, 0
  s_cbranch_scc1 KPQL
KPQD:
  s_mov_b64 exec, -1
  s_add_u32 m0, s10, 131072
  s_nop 0
  buffer_load_dwordx4 v2, s[24:27], s11 offen offset:0 sc1 lds
  buffer_load_dwordx4 v2, s[24:27], s11 offen offset:1024 sc1 lds
  s_and_b32 s29, s10, 4096
  s_add_u32 s10, s10, s29
  s_add_u32 s11, s11, 0x200000
  s_add_u32 m0, s10, 0
  s_nop 0
  buffer_load_dwordx4 v2, s[24:27], s11 offen offset:0 sc1 lds
  buffer_load_dwordx4 v2, s[24:27], s11 offen offset:1024 sc1 lds
P3_NOFE:
  s_branch P3_EVT2
P3_E2R:
  s_waitcnt vmcnt(2)
P3_NOGV:
  s_waitcnt lgkmcnt(0)
  s_mov_b32 s42, 0
  s_barrier
  ds_read_b128 v[24:27], v220
  ds_read_b128 v[8:11], v146 offset:0
  ds_read_b128 v[12:15], v146 offset:1024
  ds_read_b128 v[16:19], v147 offset:0
  ds_read_b128 v[20:23], v147 offset:1024
  s_cmp_ge_u32 s30, 4
  s_cbranch_scc1 P3_FLB
  s_lshl_b32 s6, 0x11111111, s30
  s_mov_b32 s7, s6
  s_lshl_b32 s46, s3, 3
  s_mov_b32 s4, 0xffffff
  s_mov_b32 s5, 0
  s_lshl_b64 s[8:9], s[4:5], s46
  s_sub_u32 s46, 63, s46
  s_lshr_b64 s[4:5], s[4:5], s46
  s_lshr_b64 s[4:5], s[4:5], 1
  s_or_b64 s[4:5], s[4:5], s[8:9]
  s_and_b64 s[4:5], s[4:5], s[6:7]
  s_xor_b64 s[6:7], s[6:7], s[4:5]
  s_mov_b64 exec, s[4:5]
  buffer_load_dwordx2 v[216:217], v218, s[24:27], s39 offen sc1
  s_mov_b64 exec, -1
P3_FLB:
  s_waitcnt lgkmcnt(0)
  v_mfma_f32_32x32x16_bf16 v[56:71], v[24:27], v[8:11], 0
P3_ENTER:
  v_mfma_f32_32x32x16_bf16 v[72:87], v[24:27], v[12:15], 0
  s_nop 10
  v_exp_f32 v56, v56
  v_exp_f32 v57, v57
  v_exp_f32 v58, v58
  v_exp_f32 v59, v59
  v_exp_f32 v60, v60
  v_exp_f32 v61, v61
  v_exp_f32 v62, v62
  v_exp_f32 v63, v63
  v_exp_f32 v64, v64
  v_exp_f32 v65, v65
  v_perm_b32 v88, v57, v56, v149
  v_perm_b32 v89, v59, v58, v149
  v_perm_b32 v90, v61, v60, v149
  v_perm_b32 v91, v63, v62, v149
  v_exp_f32 v66, v66
  v_exp_f32 v67, v67
  v_exp_f32 v68, v68
  v_exp_f32 v69, v69
  v_exp_f32 v70, v70
  v_exp_f32 v71, v71
  v_perm_b32 v92, v65, v64, v149
  v_perm_b32 v93, v67, v66, v149
  v_perm_b32 v94, v69, v68, v149
  v_perm_b32 v95, v71, v70, v149
  v_mfma_f32_32x32x16_bf16 v[56:71], v[24:27], v[16:19], 0
  v_exp_f32 v72, v72
  v_exp_f32 v73, v73
  v_exp_f32 v74, v74
  ds_read_b128 v[28:31], v220 offset:8192
  v_exp_f32 v75, v75
  v_exp_f32 v76, v76
  v_exp_f32 v77, v77
  v_exp_f32 v78, v78
  v_exp_f32 v79, v79
  v_exp_f32 v80, v80
  v_exp_f32 v81, v81
  v_perm_b32 v96, v73, v72, v149
  v_perm_b32 v97, v75, v74, v149
  v_perm_b32 v98, v77, v76, v149
  v_perm_b32 v99, v79, v78, v149
  v_exp_f32 v82, v82
  v_exp_f32 v83, v83
  v_exp_f32 v84, v84
  v_exp_f32 v85, v85
  v_exp_f32 v86, v86
  v_exp_f32 v87, v87
  v_perm_b32 v100, v81, v80, v149
  v_perm_b32 v101, v83, v82, v149
  v_perm_b32 v102, v85, v84, v149
  v_perm_b32 v103, v87, v86, v149
  v_mfma_f32_32x32x16_bf16 v[72:87], v[24:27], v[20:23], 0
  v_exp_f32 v56, v56
  v_exp_f32 v57, v57
  v_exp_f32 v58, v58
  v_exp_f32 v59, v59
  v_exp_f32 v60, v60
  v_exp_f32 v61, v61
  v_exp_f32 v62, v62
  v_exp_f32 v63, v63
  v_exp_f32 v64, v64
  v_exp_f32 v65, v65
  v_perm_b32 v104, v57, v56, v149
  v_perm_b32 v105, v59, v58, v149
  v_perm_b32 v106, v61, v60, v149
  v_perm_b32 v107, v63, v62, v149
  v_exp_f32 v66, v66
  v_exp_f32 v67, v67
  v_exp_f32 v68, v68
  v_exp_f32 v69, v69
  v_exp_f32 v70, v70
  v_exp_f32 v71, v71
  v_perm_b32 v108, v65, v64, v149
  v_perm_b32 v109, v67, v66, v149
  v_perm_b32 v110, v69, v68, v149
  v_perm_b32 v111, v71, v70, v149
  s_cmp_ge_u32 s30, 4
  s_cbranch_scc1 P3_FCB
  s_mov_b64 exec, s[4:5]
  s_mov_b32 s46, 400000
P3_KP:
  s_waitcnt vmcnt(0)
  v_cmp_ne_u32 vcc, s101, v217
  s_cbranch_vccz P3_KPD
  s_mov_b64 exec, vcc
  buffer_load_dwordx2 v[216:217], v218, s[24:27], s39 offen sc1
  s_sub_u32 s46, s46, 1
  s_cmp_lg_u32 s46, 0
  s_cbranch_scc1 P3_KP
P3_KPD:
  s_mov_b64 exec, -1
  s_add_u32 s46, s3, 1
  s_and_b32 s46, s46, 7
  s_lshl_b32 s46, s46, 13
  s_add_u32 s46, s46, s37
  s_add_u32 m0, s36, 16384
  s_nop 0
  buffer_load_dwordx4 v2, s[24:27], s46 offen sc1 lds
  s_add_u32 s46, s46, 2097152
  s_add_u32 m0, s36, 20480
  s_nop 0
  buffer_load_dwordx4 v2, s[24:27], s46 offen sc1 lds
  s_add_u32 s46, s3, 1
  s_and_b32 s46, s46, 7
  s_lshl_b32 s46, s46, 13
  s_add_u32 s46, s46, s37
  s_add_u32 s46, s46, 4096
  s_add_u32 m0, s36, 24576
  s_nop 0
  buffer_load_dwordx4 v2, s[24:27], s46 offen sc1 lds
  s_add_u32 s46, s46, 2097152
  s_add_u32 m0, s36, 28672
  s_nop 0
  buffer_load_dwordx4 v2, s[24:27], s46 offen sc1 lds
  s_lshl_b32 s46, s3, 13
  s_add_u32 s46, s46, s37
  s_add_u32 s46, s46, 2097152
  s_add_u32 m0, s36, 4096
  s_nop 0
  buffer_load_dwordx4 v2, s[24:27], s46 offen sc1 lds
  s_add_u32 s46, s46, 4096
  s_add_u32 m0, s36, 12288
  s_nop 0
  buffer_load_dwordx4 v2, s[24:27], s46 offen sc1 lds
  s_add_u32 s46, s3, 2
  s_and_b32 s46, s46, 7
  s_lshl_b32 s46, s46, 13
  s_add_u32 s46, s46, s37
  s_add_u32 m0, s36, 32768
  s_nop 0
  buffer_load_dwordx4 v2, s[24:27], s46 offen sc1 lds
  s_add_u32 s46, s46, 2097152
  s_add_u32 m0, s36, 36864
  s_nop 0
  buffer_load_dwordx4 v2, s[24:27], s46 offen sc1 lds
  s_add_u32 s46, s3, 2
  s_and_b32 s46, s46, 7
  s_lshl_b32 s46, s46, 13
  s_add_u32 s46, s46, s37
  s_add_u32 s46, s46, 4096
  s_add_u32 m0, s36, 40960
  s_nop 0
  buffer_load_dwordx4 v2, s[24:27], s46 offen sc1 lds
  s_add_u32 s46, s46, 2097152
  s_add_u32 m0, s36, 45056
  s_nop 0
  buffer_load_dwordx4 v2, s[24:27], s46 offen sc1 lds
P3_FCB:
  s_waitcnt lgkmcnt(0)
  v_mfma_f32_32x32x16_bf16 v[56:71], v[28:31], v[8:11], 0
  v_exp_f32 v72, v72
  v_exp_f32 v73, v73
  v_exp_f32 v74, v74
  v_exp_f32 v75, v75
  v_exp_f32 v76, v76
  v_exp_f32 v77, v77
  v_exp_f32 v78, v78
  v_exp_f32 v79, v79
  v_exp_f32 v80, v80
  v_exp_f32 v81, v81
  v_perm_b32 v112, v73, v72, v149
  v_perm_b32 v113, v75, v74, v149
  v_perm_b32 v114, v77, v76, v149
  v_perm_b32 v115, v79, v78, v149
  v_exp_f32 v82, v82
  v_exp_f32 v83, v83
  v_exp_f32 v84, v84
  v_exp_f32 v85, v85
  v_exp_f32 v86, v86
  v_exp_f32 v87, v87
  v_perm_b32 v116, v81, v80, v149
  v_perm_b32 v117, v83, v82, v149
  v_perm_b32 v118, v85, v84, v149
  v_perm_b32 v119, v87, v86, v149
  v_mfma_f32_32x32x16_bf16 v[72:87], v[28:31], v[12:15], 0
  v_exp_f32 v56, v56
  v_exp_f32 v57, v57
  v_exp_f32 v58, v58
  v_exp_f32 v59, v59
  v_exp_f32 v60, v60
  v_exp_f32 v61, v61
  v_exp_f32 v62, v62
  v_exp_f32 v63, v63
  v_exp_f32 v64, v64
  v_exp_f32 v65, v65
  v_perm_b32 v120, v57, v56, v149
  v_perm_b32 v121, v59, v58, v149
  v_perm_b32 v122, v61, v60, v149
  v_perm_b32 v123, v63, v62, v149
  v_exp_f32 v66, v66
  v_exp_f32 v67, v67
  v_exp_f32 v68, v68
  v_exp_f32 v69, v69
  v_exp_f32 v70, v70
  v_exp_f32 v71, v71
  v_perm_b32 v124, v65, v64, v149
  v_perm_b32 v125, v67, v66, v149
  v_perm_b32 v126, v69, v68, v149
  v_perm_b32 v127, v71, v70, v149
  v_mfma_f32_32x32x16_bf16 v[56:71], v[28:31], v[16:19], 0
  v_exp_f32 v72, v72
  v_exp_f32 v73, v73
  v_exp_f32 v74, v74
  v_exp_f32 v75, v75
  v_exp_f32 v76, v76
  v_exp_f32 v77, v77
  v_exp_f32 v78, v78
  v_exp_f32 v79, v79
  v_exp_f32 v80, v80
  v_exp_f32 v81, v81
  v_perm_b32 v128, v73, v72, v149
  v_perm_b32 v129, v75, v74, v149
  v_perm_b32 v130, v77, v76, v149
  v_perm_b32 v131, v79, v78, v149
  v_exp_f32 v82, v82
  v_exp_f32 v83, v83
  v_exp_f32 v84, v84
  v_exp_f32 v85, v85
  v_exp_f32 v86, v86
  v_exp_f32 v87, v87
  v_perm_b32 v132, v81, v80, v149
  v_perm_b32 v133, v83, v82, v149
  v_perm_b32 v134, v85, v84, v149
  v_perm_b32 v135, v87, v86, v149
  s_cmp_ge_u32 s30, 4
  s_cbranch_scc1 P3_FL2B
  s_mov_b64 exec, s[6:7]
  buffer_load_dwordx2 v[216:217], v218, s[24:27], s39 offen sc1
  s_mov_b64 exec, -1
P3_FL2B:
  v_mfma_f32_32x32x16_bf16 v[72:87], v[28:31], v[20:23], 0
  v_exp_f32 v56, v56
  v_exp_f32 v57, v57
  v_exp_f32 v58, v58
  v_exp_f32 v59, v59
  v_exp_f32 v60, v60
  v_exp_f32 v61, v61
  v_exp_f32 v62, v62
  v_exp_f32 v63, v63
  v_exp_f32 v64, v64
  v_exp_f32 v65, v65
  v_perm_b32 v224, v57, v56, v149
  v_perm_b32 v225, v59, v58, v149
  v_perm_b32 v226, v61, v60, v149
  v_perm_b32 v227, v63, v62, v149
  v_exp_f32 v66, v66
  v_exp_f32 v67, v67
  v_exp_f32 v68, v68
  v_exp_f32 v69, v69
  v_exp_f32 v70, v70
  v_exp_f32 v71, v71
  v_perm_b32 v228, v65, v64, v149
  v_perm_b32 v229, v67, v66, v149
  v_perm_b32 v230, v69, v68, v149
  v_perm_b32 v231, v71, v70, v149
  v_xor_b32 v220, v150, v220
  v_exp_f32 v72, v72
  v_exp_f32 v73, v73
  v_exp_f32 v74, v74
  v_exp_f32 v75, v75
  v_exp_f32 v76, v76
  v_exp_f32 v77, v77
  s_cmp_ge_u32 s30, 4
  s_cbranch_scc1 P3_SAL
  s_waitcnt vmcnt(5)
P3_SAL:
  s_barrier
  ds_read_b128 v[24:27], v220 offset:16384
  s_mov_b64 exec, s[40:41]
  ds_read_b128 v[40:43], v221 offset:8192
  ds_read_b128 v[44:47], v221 offset:8704
  ds_read_b128 v[32:35], v221 offset:16384
  ds_read_b128 v[36:39], v221 offset:16896
  ds_read_b128 v[232:235], v221 offset:0
  ds_read_b128 v[236:239], v221 offset:512
  s_mov_b64 exec, -1
  s_cbranch_scc1 P3_SBACKA
P3_SBACKA:
  v_exp_f32 v78, v78
  v_exp_f32 v79, v79
  v_exp_f32 v80, v80
  v_exp_f32 v81, v81
  v_perm_b32 v48, v73, v72, v149
  v_perm_b32 v49, v75, v74, v149
  v_perm_b32 v50, v77, v76, v149
  s_branch SK_P3
ST_P3:
  s_branch WR_b
SK_P3:
  v_perm_b32 v51, v79, v78, v149
  s_waitcnt lgkmcnt(6)
  v_mfma_f32_32x32x16_bf16 v[56:71], v[24:27], v[8:11], 0
  v_exp_f32 v82, v82
  v_exp_f32 v83, v83
  v_exp_f32 v84, v84
  v_exp_f32 v85, v85
  v_exp_f32 v86, v86
  v_exp_f32 v87, v87
  v_perm_b32 v52, v81, v80, v149
  v_perm_b32 v53, v83, v82, v149
  v_perm_b32 v54, v85, v84, v149
  v_perm_b32 v55, v87, v86, v149
  s_nop 1
  v_exp_f32 v56, v56
  v_exp_f32 v57, v57
  v_exp_f32 v58, v58
  v_exp_f32 v59, v59
  v_mfma_f32_32x32x16_bf16 v[72:87], v[24:27], v[12:15], 0
  v_exp_f32 v60, v60
  v_exp_f32 v61, v61
  v_exp_f32 v62, v62
  s_waitcnt lgkmcnt(0)
  v_mfma_f32_32x32x16_bf16 v[184:199], v[40:43], v[224:227], v[184:199]
  v_exp_f32 v63, v63
  v_exp_f32 v64, v64
  v_exp_f32 v65, v65
  v_smfmac_f32_32x32x32_bf16 v[152:167], v[32:35], v[56:63], v151
  v_exp_f32 v66, v66
  v_exp_f32 v67, v67
  v_exp_f32 v68, v68
  v_mfma_f32_32x32x16_bf16 v[184:199], v[44:47], v[228:231], v[184:199]
  v_exp_f32 v69, v69
  v_exp_f32 v70, v70
  v_exp_f32 v71, v71
  s_cmp_ge_u32 s30, 4
  s_cbranch_scc1 P3_DS9
  s_mov_b64 exec, s[6:7]
  s_mov_b32 s46, 400000
P3_KPL:
  s_waitcnt vmcnt(0)
  v_cmp_ne_u32 vcc, s101, v217
  s_cbranch_vccz P3_KPDL
  s_mov_b64 exec, vcc
  buffer_load_dwordx2 v[216:217], v218, s[24:27], s39 offen sc1
  s_sub_u32 s46, s46, 1
  s_cmp_lg_u32 s46, 0
  s_cbranch_scc1 P3_KPL
P3_KPDL:
  s_mov_b64 exec, -1
  s_add_u32 s46, s3, 3
  s_and_b32 s46, s46, 7
  s_lshl_b32 s46, s46, 13
  s_add_u32 s46, s46, s37
  s_add_u32 m0, s36, 49152
  s_nop 0
  buffer_load_dwordx4 v2, s[24:27], s46 offen sc1 lds
  s_add_u32 s46, s46, 2097152
  s_add_u32 m0, s36, 53248
  s_nop 0
  buffer_load_dwordx4 v2, s[24:27], s46 offen sc1 lds
  s_add_u32 s46, s3, 3
  s_and_b32 s46, s46, 7
  s_lshl_b32 s46, s46, 13
  s_add_u32 s46, s46, s37
  s_add_u32 s46, s46, 4096
  s_add_u32 m0, s36, 57344
  s_nop 0
  buffer_load_dwordx4 v2, s[24:27], s46 offen sc1 lds
  s_add_u32 s46, s46, 2097152
  s_add_u32 m0, s36, 61440
  s_nop 0
  buffer_load_dwordx4 v2, s[24:27], s46 offen sc1 lds
P3_DS9:
  v_exp_f32 v72, v72
  v_exp_f32 v73, v73
  v_smfmac_f32_32x32x32_bf16 v[152:167], v[36:39], v[64:71], v151
  v_exp_f32 v74, v74
  v_exp_f32 v75, v75
  v_mfma_f32_32x32x16_bf16 v[56:71], v[24:27], v[16:19], 0
  ds_read_b128 v[28:31], v220 offset:24576
  v_exp_f32 v76, v76
  v_exp_f32 v77, v77
  v_exp_f32 v78, v78
  v_mfma_f32_32x32x16_bf16 v[200:215], v[40:43], v[48:51], v[200:215]
  v_exp_f32 v79, v79
  v_exp_f32 v80, v80
  v_exp_f32 v81, v81
  v_smfmac_f32_32x32x32_bf16 v[168:183], v[32:35], v[72:79], v151
  v_exp_f32 v82, v82
  v_exp_f32 v83, v83
  v_exp_f32 v84, v84
  v_mfma_f32_32x32x16_bf16 v[200:215], v[44:47], v[52:55], v[200:215]
  v_exp_f32 v85, v85
  v_exp_f32 v86, v86
  v_exp_f32 v87, v87
  s_cmp_ge_u32 s30, 4
  s_cbranch_scc1 P3_DS10
  s_add_u32 s46, s3, 4
  s_and_b32 s46, s46, 7
  s_lshl_b32 s46, s46, 13
  s_add_u32 s46, s46, s37
  s_add_u32 m0, s36, 65536
  s_nop 0
  buffer_load_dwordx4 v2, s[24:27], s46 offen sc1 lds
  s_add_u32 s46, s46, 2097152
  s_add_u32 m0, s36, 69632
  s_nop 0
  buffer_load_dwordx4 v2, s[24:27], s46 offen sc1 lds
  s_add_u32 s46, s3, 4
  s_and_b32 s46, s46, 7
  s_lshl_b32 s46, s46, 13
  s_add_u32 s46, s46, s37
  s_add_u32 s46, s46, 4096
  s_add_u32 m0, s36, 73728
  s_nop 0
  buffer_load_dwordx4 v2, s[24:27], s46 offen sc1 lds
  s_add_u32 s46, s46, 2097152
  s_add_u32 m0, s36, 77824
  s_nop 0
  buffer_load_dwordx4 v2, s[24:27], s46 offen sc1 lds
P3_DS10:
  v_exp_f32 v56, v56
  v_exp_f32 v57, v57
  v_smfmac_f32_32x32x32_bf16 v[168:183], v[36:39], v[80:87], v151
  v_exp_f32 v58, v58
  v_exp_f32 v59, v59
  v_mfma_f32_32x32x16_bf16 v[72:87], v[24:27], v[20:23], 0
  v_exp_f32 v60, v60
  v_exp_f32 v61, v61
  v_exp_f32 v62, v62
  v_mfma_f32_32x32x16_bf16 v[152:167], v[40:43], v[120:123], v[152:167]
  v_exp_f32 v63, v63
  v_exp_f32 v64, v64
  v_exp_f32 v65, v65
  v_smfmac_f32_32x32x32_bf16 v[184:199], v[32:35], v[56:63], v151
  v_exp_f32 v66, v66
  v_exp_f32 v67, v67
  v_exp_f32 v68, v68
  v_mfma_f32_32x32x16_bf16 v[152:167], v[44:47], v[124:127], v[152:167]
  v_exp_f32 v69, v69
  v_exp_f32 v70, v70
  v_exp_f32 v71, v71
  v_exp_f32 v72, v72
  v_exp_f32 v73, v73
  v_smfmac_f32_32x32x32_bf16 v[184:199], v[36:39], v[64:71], v151
  v_exp_f32 v74, v74
  v_exp_f32 v75, v75
  s_waitcnt lgkmcnt(0)
  v_mfma_f32_32x32x16_bf16 v[56:71], v[28:31], v[8:11], 0
  v_exp_f32 v76, v76
  v_exp_f32 v77, v77
  v_exp_f32 v78, v78
  v_mfma_f32_32x32x16_bf16 v[168:183], v[40:43], v[128:131], v[168:183]
  v_exp_f32 v79, v79
  v_exp_f32 v80, v80
  v_exp_f32 v81, v81
  v_smfmac_f32_32x32x32_bf16 v[200:215], v[32:35], v[72:79], v151
  v_exp_f32 v82, v82
  v_exp_f32 v83, v83
  v_exp_f32 v84, v84
  v_mfma_f32_32x32x16_bf16 v[168:183], v[44:47], v[132:135], v[168:183]
  s_mov_b64 exec, s[40:41]
  ds_read_b128 v[40:43], v221 offset:24576
  ds_read_b128 v[44:47], v221 offset:25088
  s_mov_b64 exec, -1
  v_exp_f32 v85, v85
  v_exp_f32 v86, v86
  v_exp_f32 v87, v87
  s_waitcnt vmcnt(8)
  s_cmp_eq_u32 s30, 0
  s_cbranch_scc1 P3_MODS
P3_MODR:
  s_barrier
  v_and_b32 v219, 7, v1
  v_lshlrev_b32 v219, 7, v219
  s_lshl_b32 s46, s30, 10
  s_and_b32 s46, s46, 0xfff
  s_add_u32 s46, s46, P3_LOOP-K12_PC
  v_add_u32 v219, s46, v219
  global_load_dword v219, v219, s[98:99]
  s_cmp_ge_u32 s30, 4
  s_cbranch_scc1 P3_DS12
  s_add_u32 s46, s3, 5
  s_and_b32 s46, s46, 7
  s_lshl_b32 s46, s46, 13
  s_add_u32 s46, s46, s37
  s_add_u32 m0, s36, 81920
  s_nop 0
  buffer_load_dwordx4 v2, s[24:27], s46 offen sc1 lds
  s_add_u32 s46, s46, 2097152
  s_add_u32 m0, s36, 86016
  s_nop 0
  buffer_load_dwordx4 v2, s[24:27], s46 offen sc1 lds
  s_add_u32 s46, s3, 5
  s_and_b32 s46, s46, 7
  s_lshl_b32 s46, s46, 13
  s_add_u32 s46, s46, s37
  s_add_u32 s46, s46, 4096
  s_add_u32 m0, s36, 90112
  s_nop 0
  buffer_load_dwordx4 v2, s[24:27], s46 offen sc1 lds
  s_add_u32 s46, s46, 2097152
  s_add_u32 m0, s36, 94208
  s_nop 0
  buffer_load_dwordx4 v2, s[24:27], s46 offen sc1 lds
P3_DS12:
  v_exp_f32 v56, v56
  v_exp_f32 v57, v57
  v_smfmac_f32_32x32x32_bf16 v[200:215], v[36:39], v[80:87], v151
  v_exp_f32 v58, v58
  v_exp_f32 v59, v59
  v_mfma_f32_32x32x16_bf16 v[72:87], v[28:31], v[12:15], 0
  s_mov_b64 exec, s[40:41]
  ds_read_b128 v[32:35], v221 offset:32768
  ds_read_b128 v[36:39], v221 offset:33280
  s_mov_b64 exec, -1
  v_exp_f32 v60, v60
  v_exp_f32 v61, v61
  v_exp_f32 v62, v62
  v_mfma_f32_32x32x16_bf16 v[184:199], v[232:235], v[104:107], v[184:199]
  v_exp_f32 v63, v63
  v_exp_f32 v64, v64
  v_exp_f32 v65, v65
  s_waitcnt lgkmcnt(2)
  v_smfmac_f32_32x32x32_bf16 v[152:167], v[40:43], v[56:63], v151
  v_exp_f32 v66, v66
  v_exp_f32 v67, v67
  v_exp_f32 v68, v68
  v_mfma_f32_32x32x16_bf16 v[184:199], v[236:239], v[108:111], v[184:199]
  v_exp_f32 v69, v69
  v_exp_f32 v70, v70
  v_exp_f32 v71, v71
  s_cmp_ge_u32 s30, 4
  s_cbranch_scc1 P3_DS13
  s_add_u32 s46, s3, 6
  s_and_b32 s46, s46, 7
  s_lshl_b32 s46, s46, 13
  s_add_u32 s46, s46, s37
  s_add_u32 m0, s36, 98304
  s_nop 0
  buffer_load_dwordx4 v2, s[24:27], s46 offen sc1 lds
  s_add_u32 s46, s46, 2097152
  s_add_u32 m0, s36, 102400
  s_nop 0
  buffer_load_dwordx4 v2, s[24:27], s46 offen sc1 lds
  s_add_u32 s46, s3, 6
  s_and_b32 s46, s46, 7
  s_lshl_b32 s46, s46, 13
  s_add_u32 s46, s46, s37
  s_add_u32 s46, s46, 4096
  s_add_u32 m0, s36, 106496
  s_nop 0
  buffer_load_dwordx4 v2, s[24:27], s46 offen sc1 lds
  s_add_u32 s46, s46, 2097152
  s_add_u32 m0, s36, 110592
  s_nop 0
  buffer_load_dwordx4 v2, s[24:27], s46 offen sc1 lds
P3_DS13:
  v_exp_f32 v72, v72
  v_exp_f32 v73, v73
  v_smfmac_f32_32x32x32_bf16 v[152:167], v[44:47], v[64:71], v151
  v_exp_f32 v74, v74
  v_exp_f32 v75, v75
  v_mfma_f32_32x32x16_bf16 v[56:71], v[28:31], v[16:19], 0
  ds_read_b128 v[24:27], v220 offset:32768
  v_exp_f32 v76, v76
  v_exp_f32 v77, v77
  v_exp_f32 v78, v78
  v_mfma_f32_32x32x16_bf16 v[200:215], v[232:235], v[112:115], v[200:215]
  v_exp_f32 v79, v79
  v_exp_f32 v80, v80
  v_exp_f32 v81, v81
  v_smfmac_f32_32x32x32_bf16 v[168:183], v[40:43], v[72:79], v151
  v_exp_f32 v82, v82
  v_exp_f32 v83, v83
  v_exp_f32 v84, v84
  v_mfma_f32_32x32x16_bf16 v[200:215], v[236:239], v[116:119], v[200:215]
  v_exp_f32 v85, v85
  v_exp_f32 v86, v86
  v_exp_f32 v87, v87
  v_exp_f32 v56, v56
  v_exp_f32 v57, v57
  v_smfmac_f32_32x32x32_bf16 v[168:183], v[44:47], v[80:87], v151
  v_exp_f32 v58, v58
  v_exp_f32 v59, v59
  v_mfma_f32_32x32x16_bf16 v[72:87], v[28:31], v[20:23], 0
  v_exp_f32 v60, v60
  v_exp_f32 v61, v61
  v_exp_f32 v62, v62
  v_mfma_f32_32x32x16_bf16 v[152:167], v[232:235], v[88:91], v[152:167]
  v_exp_f32 v63, v63
  v_exp_f32 v64, v64
  v_exp_f32 v65, v65
  v_smfmac_f32_32x32x32_bf16 v[184:199], v[40:43], v[56:63], v151
  v_exp_f32 v66, v66
  v_exp_f32 v67, v67
  v_exp_f32 v68, v68
  v_mfma_f32_32x32x16_bf16 v[152:167], v[236:239], v[92:95], v[152:167]
  v_exp_f32 v69, v69
  v_exp_f32 v70, v70
  v_exp_f32 v71, v71
  s_cmp_ge_u32 s30, 4
  s_cbranch_scc1 P3_DS15
  s_add_u32 s46, s3, 7
  s_and_b32 s46, s46, 7
  s_lshl_b32 s46, s46, 13
  s_add_u32 s46, s46, s37
  s_add_u32 m0, s36, 114688
  s_nop 0
  buffer_load_dwordx4 v2, s[24:27], s46 offen sc1 lds
  s_add_u32 s46, s46, 2097152
  s_add_u32 m0, s36, 118784
  s_nop 0
  buffer_load_dwordx4 v2, s[24:27], s46 offen sc1 lds
  s_add_u32 s46, s3, 7
  s_and_b32 s46, s46, 7
  s_lshl_b32 s46, s46, 13
  s_add_u32 s46, s46, s37
  s_add_u32 s46, s46, 4096
  s_add_u32 m0, s36, 122880
  s_nop 0
  buffer_load_dwordx4 v2, s[24:27], s46 offen sc1 lds
  s_add_u32 s46, s46, 2097152
  s_add_u32 m0, s36, 126976
  s_nop 0
  buffer_load_dwordx4 v2, s[24:27], s46 offen sc1 lds
P3_DS15:
  v_exp_f32 v72, v72
  v_exp_f32 v73, v73
  v_smfmac_f32_32x32x32_bf16 v[184:199], v[44:47], v[64:71], v151
  v_exp_f32 v74, v74
  v_exp_f32 v75, v75
  s_waitcnt lgkmcnt(0)
  v_mfma_f32_32x32x16_bf16 v[56:71], v[24:27], v[8:11], 0
  v_exp_f32 v76, v76
  v_exp_f32 v77, v77
  v_exp_f32 v78, v78
  v_mfma_f32_32x32x16_bf16 v[168:183], v[232:235], v[96:99], v[168:183]
  v_exp_f32 v79, v79
  v_exp_f32 v80, v80
  v_exp_f32 v81, v81
  v_smfmac_f32_32x32x32_bf16 v[200:215], v[40:43], v[72:79], v151
  v_exp_f32 v82, v82
  v_exp_f32 v83, v83
  v_exp_f32 v84, v84
  v_mfma_f32_32x32x16_bf16 v[168:183], v[236:239], v[100:103], v[168:183]
  s_mov_b32 s43, 2
  s_mov_b32 s42, 2
  v_add_u32 v220, 32768, v220
  v_add_u32 v221, 32768, v221
  v_exp_f32 v85, v85
  v_exp_f32 v86, v86
  v_exp_f32 v87, v87
  .p2align 6
P3_LOOP:
  v_exp_f32 v56, v56
  v_exp_f32 v57, v57
  v_smfmac_f32_32x32x32_bf16 v[200:215], v[44:47], v[80:87], v151
  s_mov_b64 exec, s[40:41]
  ds_read_b128 v[40:43], v221 offset:8192
  ds_read_b128 v[44:47], v221 offset:8704
  s_mov_b64 exec, -1
  v_exp_f32 v58, v58
  v_exp_f32 v59, v59
  v_exp_f32 v60, v60
  v_mfma_f32_32x32x16_bf16 v[72:87], v[24:27], v[12:15], 0
  v_exp_f32 v61, v61
  v_exp_f32 v62, v62
  v_exp_f32 v63, v63
  v_exp_f32 v64, v64
  v_exp_f32 v65, v65
  v_smfmac_f32_32x32x32_bf16 v[152:167], v[32:35], v[56:63], v151
  v_exp_f32 v66, v66
  v_exp_f32 v67, v67
  v_exp_f32 v68, v68
  v_exp_f32 v69, v69
  v_exp_f32 v70, v70
  v_exp_f32 v71, v71
  v_exp_f32 v72, v72
  v_exp_f32 v73, v73
  v_smfmac_f32_32x32x32_bf16 v[152:167], v[36:39], v[64:71], v151
  v_exp_f32 v74, v74
  v_exp_f32 v75, v75
  v_exp_f32 v76, v76
  v_mfma_f32_32x32x16_bf16 v[56:71], v[24:27], v[16:19], 0
  ds_read_b128 v[28:31], v220 offset:8192
  v_exp_f32 v77, v77
  v_exp_f32 v78, v78
  v_exp_f32 v79, v79
  v_exp_f32 v80, v80
  v_exp_f32 v81, v81
  v_smfmac_f32_32x32x32_bf16 v[168:183], v[32:35], v[72:79], v151
  v_exp_f32 v82, v82
  v_exp_f32 v83, v83
  v_exp_f32 v84, v84
  v_exp_f32 v85, v85
  v_exp_f32 v86, v86
  v_exp_f32 v87, v87
  v_exp_f32 v56, v56
  v_exp_f32 v57, v57
  v_smfmac_f32_32x32x32_bf16 v[168:183], v[36:39], v[80:87], v151
  v_exp_f32 v58, v58
  v_exp_f32 v59, v59
  v_exp_f32 v60, v60
  v_mfma_f32_32x32x16_bf16 v[72:87], v[24:27], v[20:23], 0
  v_exp_f32 v61, v61
  v_exp_f32 v62, v62
  v_exp_f32 v63, v63
  v_exp_f32 v64, v64
  v_exp_f32 v65, v65
  v_smfmac_f32_32x32x32_bf16 v[184:199], v[32:35], v[56:63], v151
  v_exp_f32 v66, v66
  v_exp_f32 v67, v67
  v_exp_f32 v68, v68
  v_exp_f32 v69, v69
  v_exp_f32 v70, v70
  v_exp_f32 v71, v71
  v_exp_f32 v72, v72
  v_exp_f32 v73, v73
  v_smfmac_f32_32x32x32_bf16 v[184:199], v[36:39], v[64:71], v151
  v_exp_f32 v74, v74
  v_exp_f32 v75, v75
  v_exp_f32 v76, v76
  s_waitcnt lgkmcnt(0)
  v_mfma_f32_32x32x16_bf16 v[56:71], v[28:31], v[8:11], 0
  v_exp_f32 v77, v77
  v_exp_f32 v78, v78
  v_exp_f32 v79, v79
  v_exp_f32 v80, v80
  v_exp_f32 v81, v81
  v_smfmac_f32_32x32x32_bf16 v[200:215], v[32:35], v[72:79], v151
  v_exp_f32 v82, v82
  v_exp_f32 v83, v83
  v_exp_f32 v84, v84
  v_exp_f32 v85, v85
  v_exp_f32 v86, v86
  v_exp_f32 v87, v87
  s_cmp_eq_u32 s43, s42
  s_cbranch_scc1 P3_SYNC
P3_SBACK:
  v_exp_f32 v56, v56
  v_exp_f32 v57, v57
  v_smfmac_f32_32x32x32_bf16 v[200:215], v[36:39], v[80:87], v151
  s_mov_b64 exec, s[40:41]
  ds_read_b128 v[32:35], v221 offset:16384
  ds_read_b128 v[36:39], v221 offset:16896
  s_mov_b64 exec, -1
  v_exp_f32 v58, v58
  v_exp_f32 v59, v59
  v_exp_f32 v60, v60
  v_mfma_f32_32x32x16_bf16 v[72:87], v[28:31], v[12:15], 0
  v_exp_f32 v61, v61
  v_exp_f32 v62, v62
  v_exp_f32 v63, v63
  v_exp_f32 v64, v64
  v_exp_f32 v65, v65
  v_smfmac_f32_32x32x32_bf16 v[152:167], v[40:43], v[56:63], v151
  v_exp_f32 v66, v66
  v_exp_f32 v67, v67
  v_exp_f32 v68, v68
  v_exp_f32 v69, v69
  v_exp_f32 v70, v70
  v_exp_f32 v71, v71
  v_exp_f32 v72, v72
  v_exp_f32 v73, v73
  v_smfmac_f32_32x32x32_bf16 v[152:167], v[44:47], v[64:71], v151
  v_exp_f32 v74, v74
  v_exp_f32 v75, v75
  v_exp_f32 v76, v76
  v_mfma_f32_32x32x16_bf16 v[56:71], v[28:31], v[16:19], 0
  ds_read_b128 v[24:27], v220 offset:16384
  v_exp_f32 v77, v77
  v_exp_f32 v78, v78
  v_exp_f32 v79, v79
  v_exp_f32 v80, v80
  v_exp_f32 v81, v81
  v_smfmac_f32_32x32x32_bf16 v[168:183], v[40:43], v[72:79], v151
  v_exp_f32 v82, v82
  v_exp_f32 v83, v83
  v_exp_f32 v84, v84
  v_exp_f32 v85, v85
  v_exp_f32 v86, v86
  v_exp_f32 v87, v87
  v_exp_f32 v56, v56
  v_exp_f32 v57, v57
  v_smfmac_f32_32x32x32_bf16 v[168:183], v[44:47], v[80:87], v151
  v_exp_f32 v58, v58
  v_exp_f32 v59, v59
  v_exp_f32 v60, v60
  v_mfma_f32_32x32x16_bf16 v[72:87], v[28:31], v[20:23], 0
  v_exp_f32 v61, v61
  v_exp_f32 v62, v62
  v_exp_f32 v63, v63
  v_exp_f32 v64, v64
  v_exp_f32 v65, v65
  v_smfmac_f32_32x32x32_bf16 v[184:199], v[40:43], v[56:63], v151
  v_exp_f32 v66, v66
  v_exp_f32 v67, v67
  v_exp_f32 v68, v68
  v_exp_f32 v69, v69
  v_exp_f32 v70, v70
  v_exp_f32 v71, v71
  v_exp_f32 v72, v72
  v_exp_f32 v73, v73
  v_smfmac_f32_32x32x32_bf16 v[184:199], v[44:47], v[64:71], v151
  v_exp_f32 v74, v74
  v_exp_f32 v75, v75
  v_exp_f32 v76, v76
  s_waitcnt lgkmcnt(0)
  v_mfma_f32_32x32x16_bf16 v[56:71], v[24:27], v[8:11], 0
  v_exp_f32 v77, v77
  v_exp_f32 v78, v78
  v_exp_f32 v79, v79
  v_exp_f32 v80, v80
  v_exp_f32 v81, v81
  v_smfmac_f32_32x32x32_bf16 v[200:215], v[40:43], v[72:79], v151
  v_exp_f32 v82, v82
  v_exp_f32 v83, v83
  v_exp_f32 v84, v84
  v_exp_f32 v85, v85
  v_exp_f32 v86, v86
  v_exp_f32 v87, v87
P3_MID:
  v_exp_f32 v56, v56
  v_exp_f32 v57, v57
  v_smfmac_f32_32x32x32_bf16 v[200:215], v[44:47], v[80:87], v151
  s_mov_b64 exec, s[40:41]
  ds_read_b128 v[40:43], v221 offset:24576
  ds_read_b128 v[44:47], v221 offset:25088
  s_mov_b64 exec, -1
  v_exp_f32 v58, v58
  v_exp_f32 v59, v59
  v_exp_f32 v60, v60
  v_mfma_f32_32x32x16_bf16 v[72:87], v[24:27], v[12:15], 0
  v_exp_f32 v61, v61
  v_exp_f32 v62, v62
  v_exp_f32 v63, v63
  v_exp_f32 v64, v64
  v_exp_f32 v65, v65
  v_smfmac_f32_32x32x32_bf16 v[152:167], v[32:35], v[56:63], v151
  v_exp_f32 v66, v66
  v_exp_f32 v67, v67
  v_exp_f32 v68, v68
  v_exp_f32 v69, v69
  v_exp_f32 v70, v70
  v_exp_f32 v71, v71
  v_exp_f32 v72, v72
  v_exp_f32 v73, v73
  v_smfmac_f32_32x32x32_bf16 v[152:167], v[36:39], v[64:71], v151
  v_exp_f32 v74, v74
  v_exp_f32 v75, v75
  v_exp_f32 v76, v76
  v_mfma_f32_32x32x16_bf16 v[56:71], v[24:27], v[16:19], 0
  ds_read_b128 v[28:31], v220 offset:24576
  v_exp_f32 v77, v77
  v_exp_f32 v78, v78
  v_exp_f32 v79, v79
  v_exp_f32 v80, v80
  v_exp_f32 v81, v81
  v_smfmac_f32_32x32x32_bf16 v[168:183], v[32:35], v[72:79], v151
  v_exp_f32 v82, v82
  v_exp_f32 v83, v83
  v_exp_f32 v84, v84
  v_exp_f32 v85, v85
  v_exp_f32 v86, v86
  v_exp_f32 v87, v87
  v_exp_f32 v56, v56
  v_exp_f32 v57, v57
  v_smfmac_f32_32x32x32_bf16 v[168:183], v[36:39], v[80:87], v151
  v_exp_f32 v58, v58
  v_exp_f32 v59, v59
  v_exp_f32 v60, v60
  v_mfma_f32_32x32x16_bf16 v[72:87], v[24:27], v[20:23], 0
  v_exp_f32 v61, v61
  v_exp_f32 v62, v62
  v_exp_f32 v63, v63
  v_exp_f32 v64, v64
  v_exp_f32 v65, v65
  v_smfmac_f32_32x32x32_bf16 v[184:199], v[32:35], v[56:63], v151
  v_exp_f32 v66, v66
  v_exp_f32 v67, v67
  v_exp_f32 v68, v68
  v_exp_f32 v69, v69
  v_exp_f32 v70, v70
  v_exp_f32 v71, v71
  v_exp_f32 v72, v72
  v_exp_f32 v73, v73
  v_smfmac_f32_32x32x32_bf16 v[184:199], v[36:39], v[64:71], v151
  v_exp_f32 v74, v74
  v_exp_f32 v75, v75
  v_exp_f32 v76, v76
  s_waitcnt lgkmcnt(0)
  v_mfma_f32_32x32x16_bf16 v[56:71], v[28:31], v[8:11], 0
  v_exp_f32 v77, v77
  v_exp_f32 v78, v78
  v_exp_f32 v79, v79
  v_exp_f32 v80, v80
  v_exp_f32 v81, v81
  v_smfmac_f32_32x32x32_bf16 v[200:215], v[32:35], v[72:79], v151
  v_exp_f32 v82, v82
  v_exp_f32 v83, v83
  v_exp_f32 v84, v84
  v_exp_f32 v85, v85
  v_exp_f32 v86, v86
  v_exp_f32 v87, v87
  v_exp_f32 v56, v56
  v_exp_f32 v57, v57
  v_smfmac_f32_32x32x32_bf16 v[200:215], v[36:39], v[80:87], v151
  s_mov_b64 exec, s[40:41]
  ds_read_b128 v[32:35], v221 offset:32768
  ds_read_b128 v[36:39], v221 offset:33280
  s_mov_b64 exec, -1
  v_exp_f32 v58, v58
  v_exp_f32 v59, v59
  v_exp_f32 v60, v60
  v_mfma_f32_32x32x16_bf16 v[72:87], v[28:31], v[12:15], 0
  v_exp_f32 v61, v61
  v_exp_f32 v62, v62
  v_exp_f32 v63, v63
  v_exp_f32 v64, v64
  v_exp_f32 v65, v65
  v_smfmac_f32_32x32x32_bf16 v[152:167], v[40:43], v[56:63], v151
  v_exp_f32 v66, v66
  v_exp_f32 v67, v67
  v_exp_f32 v68, v68
  v_exp_f32 v69, v69
  v_exp_f32 v70, v70
  v_exp_f32 v71, v71
  v_exp_f32 v72, v72
  v_exp_f32 v73, v73
  v_smfmac_f32_32x32x32_bf16 v[152:167], v[44:47], v[64:71], v151
  v_exp_f32 v74, v74
  v_exp_f32 v75, v75
  v_exp_f32 v76, v76
  v_mfma_f32_32x32x16_bf16 v[56:71], v[28:31], v[16:19], 0
  ds_read_b128 v[24:27], v220 offset:32768
  v_exp_f32 v77, v77
  v_exp_f32 v78, v78
  v_exp_f32 v79, v79
  v_exp_f32 v80, v80
  v_exp_f32 v81, v81
  v_smfmac_f32_32x32x32_bf16 v[168:183], v[40:43], v[72:79], v151
  v_exp_f32 v82, v82
  v_exp_f32 v83, v83
  v_exp_f32 v84, v84
  v_exp_f32 v85, v85
  v_exp_f32 v86, v86
  v_exp_f32 v87, v87
  v_exp_f32 v56, v56
  v_exp_f32 v57, v57
  v_smfmac_f32_32x32x32_bf16 v[168:183], v[44:47], v[80:87], v151
  v_exp_f32 v58, v58
  v_exp_f32 v59, v59
  v_exp_f32 v60, v60
  v_mfma_f32_32x32x16_bf16 v[72:87], v[28:31], v[20:23], 0
  v_exp_f32 v61, v61
  v_exp_f32 v62, v62
  v_exp_f32 v63, v63
  v_exp_f32 v64, v64
  v_exp_f32 v65, v65
  v_smfmac_f32_32x32x32_bf16 v[184:199], v[40:43], v[56:63], v151
  v_exp_f32 v66, v66
  v_exp_f32 v67, v67
  v_exp_f32 v68, v68
  v_exp_f32 v69, v69
  v_exp_f32 v70, v70
  v_exp_f32 v71, v71
  s_cmp_eq_u32 s43, s10
  s_cbranch_scc1 P3_PUT
  v_exp_f32 v72, v72
  v_exp_f32 v73, v73
  v_smfmac_f32_32x32x32_bf16 v[184:199], v[44:47], v[64:71], v151
  v_exp_f32 v74, v74
  v_exp_f32 v75, v75
  v_exp_f32 v76, v76
  s_waitcnt lgkmcnt(0)
  v_mfma_f32_32x32x16_bf16 v[56:71], v[24:27], v[8:11], 0
  v_exp_f32 v77, v77
  v_exp_f32 v78, v78
  v_exp_f32 v79, v79
  v_exp_f32 v80, v80
  v_exp_f32 v81, v81
  v_smfmac_f32_32x32x32_bf16 v[200:215], v[40:43], v[72:79], v151
  s_add_u32 s43, s43, 2
  v_add_u32 v220, 32768, v220
  v_add_u32 v221, 32768, v221
  v_exp_f32 v82, v82
  v_exp_f32 v83, v83
  v_exp_f32 v84, v84
  v_exp_f32 v85, v85
  v_exp_f32 v86, v86
  v_exp_f32 v87, v87
  s_cmp_lt_u32 s43, 8
  s_cbranch_scc1 P3_LOOP
  v_smfmac_f32_32x32x32_bf16 v[200:215], v[44:47], v[80:87], v151
  v_mov_b32 v218, 1
  s_branch P3_EVT
P3_PUT:
  s_setprio 2
  v_exp_f32 v72, v72
  v_exp_f32 v73, v73
  v_smfmac_f32_32x32x32_bf16 v[184:199], v[44:47], v[64:71], v151
  ds_write_b128 v4, v[152:155] offset:0
  v_exp_f32 v74, v74
  ds_write_b128 v4, v[156:159] offset:1024
  v_exp_f32 v75, v75
  ds_write_b32 v6, v160 offset:2048
  v_exp_f32 v76, v76
  ds_write_b128 v4, v[168:171] offset:2304
  v_exp_f32 v77, v77
  ds_write_b128 v4, v[172:175] offset:3328
  v_exp_f32 v78, v78
  ds_write_b32 v6, v176 offset:4352
  v_exp_f32 v79, v79
  s_mov_b64 exec, 2
  ds_add_u32 v223, v1
  s_mov_b64 exec, -1
  v_exp_f32 v80, v80
  v_exp_f32 v81, v81
  v_smfmac_f32_32x32x32_bf16 v[200:215], v[40:43], v[72:79], v151
  v_exp_f32 v82, v82
  v_exp_f32 v83, v83
  v_exp_f32 v84, v84
  v_exp_f32 v85, v85
  v_exp_f32 v86, v86
  v_exp_f32 v87, v87
  s_nop 1
  v_smfmac_f32_32x32x32_bf16 v[200:215], v[44:47], v[80:87], v151
P3_SPIN:
  ds_read_b32 v3, v223
  ds_read_b128 v[56:59], v142 offset:0
  ds_read_b128 v[60:63], v142 offset:1024
  ds_read_b32 v64, v143 offset:2048
  ds_read_b128 v[68:71], v140 offset:0
  ds_read_b128 v[72:75], v140 offset:1024
  ds_read_b32 v76, v141 offset:2048
  ds_read_b128 v[80:83], v140 offset:18432
  ds_read_b128 v[84:87], v140 offset:19456
  ds_read_b32 v88, v141 offset:20480
  ds_read_b128 v[92:95], v142 offset:2304
  ds_read_b128 v[96:99], v142 offset:3328
  ds_read_b32 v100, v143 offset:4352
  ds_read_b128 v[104:107], v140 offset:2304
  ds_read_b128 v[108:111], v140 offset:3328
  ds_read_b32 v112, v141 offset:4352
  ds_read_b128 v[116:119], v140 offset:20736
  ds_read_b128 v[120:123], v140 offset:21760
  ds_read_b32 v124, v141 offset:22784
  s_sub_u32 s6, s6, 1
  s_waitcnt lgkmcnt(14)
  v_readfirstlane_b32 s47, v3
  s_cmp_eq_u32 s6, 0
  s_cselect_b32 s47, 8, s47
  s_cmp_lt_u32 s47, 8
  s_cbranch_scc1 P3_SPIN
  v_pk_add_f32 v[184:185], v[184:185], v[56:57]
  v_pk_add_f32 v[186:187], v[186:187], v[58:59]
  v_pk_add_f32 v[188:189], v[188:189], v[60:61]
  v_pk_add_f32 v[190:191], v[190:191], v[62:63]
  v_add_f32 v192, v192, v64
  s_waitcnt lgkmcnt(9)
  v_pk_add_f32 v[68:69], v[68:69], v[80:81]
  v_pk_add_f32 v[70:71], v[70:71], v[82:83]
  v_pk_add_f32 v[72:73], v[72:73], v[84:85]
  v_pk_add_f32 v[74:75], v[74:75], v[86:87]
  v_add_f32 v76, v76, v88
  v_pk_add_f32 v[184:185], v[184:185], v[68:69]
  v_pk_add_f32 v[186:187], v[186:187], v[70:71]
  v_pk_add_f32 v[188:189], v[188:189], v[72:73]
  v_pk_add_f32 v[190:191], v[190:191], v[74:75]
  v_add_f32 v192, v192, v76
  v_pk_fma_f32 v[146:147], v[184:185], 0, 0
  v_pk_fma_f32 v[146:147], v[186:187], 0, v[146:147]
  v_pk_fma_f32 v[146:147], v[188:189], 0, v[146:147]
  v_pk_fma_f32 v[146:147], v[190:191], 0, v[146:147]
  s_waitcnt lgkmcnt(6)
  v_pk_add_f32 v[200:201], v[200:201], v[92:93]
  v_pk_add_f32 v[202:203], v[202:203], v[94:95]
  v_pk_add_f32 v[204:205], v[204:205], v[96:97]
  v_pk_add_f32 v[206:207], v[206:207], v[98:99]
  v_add_f32 v208, v208, v100
  s_waitcnt lgkmcnt(0)
  v_pk_add_f32 v[104:105], v[104:105], v[116:117]
  v_pk_add_f32 v[106:107], v[106:107], v[118:119]
  v_pk_add_f32 v[108:109], v[108:109], v[120:121]
  v_pk_add_f32 v[110:111], v[110:111], v[122:123]
  v_add_f32 v112, v112, v124
  v_pk_add_f32 v[200:201], v[200:201], v[104:105]
  v_pk_add_f32 v[202:203], v[202:203], v[106:107]
  v_pk_add_f32 v[204:205], v[204:205], v[108:109]
  v_pk_add_f32 v[206:207], v[206:207], v[110:111]
  v_add_f32 v208, v208, v112
  v_pk_fma_f32 v[146:147], v[200:201], 0, v[146:147]
  v_pk_fma_f32 v[146:147], v[202:203], 0, v[146:147]
  v_pk_fma_f32 v[146:147], v[204:205], 0, v[146:147]
  s_branch SK_P4
ST_P4:
  s_branch ST_SY
SK_P4:
  v_pk_fma_f32 v[146:147], v[206:207], 0, v[146:147]
  v_min_f32 v3, v192, v208
  v_add_f32 v4, v192, v208
  v_add_f32 v146, v146, v147
  v_add_f32 v4, v4, v146
  v_cmp_nge_f32 vcc, v3, v144
  v_cmp_nle_f32 s[46:47], v4, v145
  s_nop 0
  s_or_b64 vcc, vcc, s[46:47]
  s_cbranch_vccnz P3_SLOW
P3_FIN:
  v_rcp_f32 v6, v192
  v_rcp_f32 v7, v208
  s_nop 0
  v_pk_mul_f32 v[184:185], v[184:185], v[6:7] op_sel:[0,0] op_sel_hi:[1,0]
  v_pk_mul_f32 v[186:187], v[186:187], v[6:7] op_sel:[0,0] op_sel_hi:[1,0]
  v_pk_mul_f32 v[188:189], v[188:189], v[6:7] op_sel:[0,0] op_sel_hi:[1,0]
  v_pk_mul_f32 v[190:191], v[190:191], v[6:7] op_sel:[0,0] op_sel_hi:[1,0]
  v_cvt_pk_bf16_f32 v48, v184, v185
  v_cvt_pk_bf16_f32 v49, v186, v187
  v_cvt_pk_bf16_f32 v50, v188, v189
  v_cvt_pk_bf16_f32 v51, v190, v191
  buffer_store_dwordx4 v[48:51], v2, s[24:27], s38 offen
  v_pk_mul_f32 v[200:201], v[6:7], v[200:201] op_sel:[1,0] op_sel_hi:[1,1]
  v_pk_mul_f32 v[202:203], v[6:7], v[202:203] op_sel:[1,0] op_sel_hi:[1,1]
  v_pk_mul_f32 v[204:205], v[6:7], v[204:205] op_sel:[1,0] op_sel_hi:[1,1]
  v_pk_mul_f32 v[206:207], v[6:7], v[206:207] op_sel:[1,0] op_sel_hi:[1,1]
  v_cvt_pk_bf16_f32 v52, v200, v201
  v_cvt_pk_bf16_f32 v53, v202, v203
  v_cvt_pk_bf16_f32 v54, v204, v205
  v_cvt_pk_bf16_f32 v55, v206, v207
  buffer_store_dwordx4 v[52:55], v2, s[24:27], s39 offen
  s_waitcnt vmcnt(2)
  v_cmp_ne_u32 vcc, s44, v254
  s_mov_b32 s44, 0
  s_cmp_eq_u64 vcc, 0
  s_cselect_b32 s44, 1, 0
  s_lshl_b32 s32, s3, 2
  s_lshr_b32 s29, s28, 3
  s_add_u32 s32, s32, s29
  s_and_b32 s33, s28, 7
  s_and_b32 s34, s30, 3
  s_xor_b32 s30, s30, 4
  v_xor_b32 v0, 256, v0
  v_lshrrev_b32 v3, 3, v1
  v_and_b32 v10, 7, v1
  v_bfe_u32 v11, v1, 4, 1
  v_lshlrev_b32 v11, 2, v11
  v_xor_b32 v10, v10, v11
  v_lshlrev_b32 v3, 10, v3
  v_lshl_add_u32 v4, v10, 4, v3
  v_add_u32 v5, 7168, v4
  s_mul_i32 s35, s34, 131072
  s_lshl_b32 s29, s33, 7
  s_add_u32 s35, s35, s29
  s_mul_i32 s36, s34, 16384
  s_add_u32 s36, s36, 36864
  v_bfe_u32 v3, v1, 2, 2
  v_lshrrev_b32 v10, 5, v1
  v_lshl_add_u32 v3, v10, 3, v3
  v_lshlrev_b32 v3, 7, v3
  v_and_b32 v10, 1, v1
  v_lshl_add_u32 v3, v10, 4, v3
  v_bfe_u32 v10, v1, 1, 1
  v_lshl_add_u32 v3, v10, 3, v3
  v_bfe_u32 v10, v1, 4, 1
  v_lshl_add_u32 v3, v10, 5, v3
  v_bfe_u32 v10, v1, 3, 1
  v_lshl_add_u32 v3, v10, 6, v3
  s_lshl_b32 s29, s34, 5
  s_and_b32 s29, s29, 64
  v_xor_b32 v3, s29, v3
  s_and_b32 s46, s34, 2
  s_mul_i32 s47, s46, 16384
  s_add_u32 s47, s47, 36864
  v_add_u32 v6, s47, v3
  v_xor_b32 v3, 64, v3
  v_add_u32 v7, s47, v3
  s_and_b32 s29, s34, 1
  s_mul_i32 s29, s29, 32768
  v_add_u32 v8, s29, v2
  s_mul_i32 s37, s32, 65536
  s_mul_i32 s29, s46, 8192
  s_add_u32 s37, s37, s29
  s_add_u32 s37, s37, 0x900000
  s_add_u32 s38, s35, 0
  s_add_u32 m0, s36, 0
  s_nop 0
  buffer_load_dwordx4 v4, s[48:51], s38 offen lds
  buffer_load_dwordx4 v5, s[48:51], s38 offen offset:1024 lds
  s_add_u32 s38, s35, 16384
  s_add_u32 m0, s36, 2048
  s_nop 0
  buffer_load_dwordx4 v4, s[48:51], s38 offen lds
  buffer_load_dwordx4 v5, s[48:51], s38 offen offset:1024 lds
  s_waitcnt vmcnt(4)
  s_mov_b64 exec, 1
  v_mov_b32 v220, s101
  v_mov_b32 v221, s4
  v_lshlrev_b32 v221, 2, v221
  s_cmp_eq_u32 s44, 1
  s_cbranch_scc0 SIGS_p3
  buffer_store_dword v220, v221, s[24:27], s45 offen offset:0
SIGD_p3:
  s_mov_b64 exec, -1
  s_add_u32 s38, s35, 32768
  s_add_u32 m0, s36, 4096
  s_nop 0
  buffer_load_dwordx4 v4, s[48:51], s38 offen lds
  buffer_load_dwordx4 v5, s[48:51], s38 offen offset:1024 lds
  s_add_u32 s38, s35, 49152
  s_add_u32 m0, s36, 6144
  s_nop 0
  buffer_load_dwordx4 v4, s[48:51], s38 offen lds
  buffer_load_dwordx4 v5, s[48:51], s38 offen offset:1024 lds
  s_add_u32 s38, s35, 65536
  s_add_u32 m0, s36, 8192
  s_nop 0
  buffer_load_dwordx4 v4, s[48:51], s38 offen lds
  buffer_load_dwordx4 v5, s[48:51], s38 offen offset:1024 lds
  s_add_u32 s38, s35, 81920
  s_add_u32 m0, s36, 10240
  s_nop 0
  buffer_load_dwordx4 v4, s[48:51], s38 offen lds
  buffer_load_dwordx4 v5, s[48:51], s38 offen offset:1024 lds
  s_add_u32 s38, s35, 98304
  s_add_u32 m0, s36, 12288
  s_nop 0
  buffer_load_dwordx4 v4, s[48:51], s38 offen lds
  buffer_load_dwordx4 v5, s[48:51], s38 offen offset:1024 lds
  s_add_u32 s38, s35, 114688
  s_add_u32 m0, s36, 14336
  s_nop 0
  buffer_load_dwordx4 v4, s[48:51], s38 offen lds
  buffer_load_dwordx4 v5, s[48:51], s38 offen offset:1024 lds
  s_and_b32 s29, s34, 1
  s_lshl_b32 s40, s32, 1
  s_add_u32 s40, s40, s29
  s_lshr_b32 s29, s34, 1
  s_lshl_b32 s41, s33, 1
  s_add_u32 s41, s41, s29
  s_lshl_b32 s42, s40, 15
  s_lshl_b32 s29, s41, 6
  s_add_u32 s42, s42, s29
  v_lshrrev_b32 v218, 5, v1
  v_lshlrev_b32 v219, 5, v218
  s_lshl_b32 s29, s41, 7
  s_add_u32 s29, s29, 4096
  buffer_load_dwordx4 v[224:227], v219, s[24:27], s29 offen offset:0 sc1
  buffer_load_dwordx4 v[228:231], v219, s[24:27], s29 offen offset:16 sc1
  buffer_load_dwordx4 v[232:235], v219, s[24:27], s29 offen offset:64 sc1
  buffer_load_dwordx4 v[236:239], v219, s[24:27], s29 offen offset:80 sc1
  s_add_u32 s29, s29, 4096
  buffer_load_dwordx4 v[136:139], v219, s[24:27], s29 offen offset:0 sc1
  buffer_load_dwordx4 v[140:143], v219, s[24:27], s29 offen offset:16 sc1
  buffer_load_dwordx4 v[144:147], v219, s[24:27], s29 offen offset:64 sc1
  buffer_load_dwordx4 v[148:151], v219, s[24:27], s29 offen offset:80 sc1
  v_and_b32 v219, 31, v1
  v_lshlrev_b32 v219, 10, v219
  v_lshl_add_u32 v218, v218, 4, v219
  v_lshlrev_b32 v184, 16, v240
  v_and_b32 v185, s31, v240
  v_lshlrev_b32 v186, 16, v241
  v_and_b32 v187, s31, v241
  v_lshlrev_b32 v188, 16, v242
  v_and_b32 v189, s31, v242
  v_lshlrev_b32 v190, 16, v243
  v_and_b32 v191, s31, v243
  v_lshlrev_b32 v192, 16, v244
  v_and_b32 v193, s31, v244
  v_lshlrev_b32 v194, 16, v245
  v_and_b32 v195, s31, v245
  v_lshlrev_b32 v196, 16, v246
  v_and_b32 v197, s31, v246
  v_lshlrev_b32 v198, 16, v247
  v_and_b32 v199, s31, v247
  s_lshl_b32 s29, s34, 12
  v_add_u32 v3, s29, v2
  v_xor_b32 v9, 0x2000, v3
  s_lshr_b32 s29, s28, 3
  s_lshl_b32 s29, s29, 5
  s_and_b32 s46, s34, 2
  s_lshl_b32 s46, s46, 3
  s_add_u32 s29, s29, s46
  v_add_lshl_u32 v221, v1, s29, 2
  s_mov_b32 s46, 0xffff
  s_mov_b32 s47, 0
  s_mov_b64 exec, s[46:47]
  s_mov_b32 s46, 400000
POLL_p4:
  buffer_load_dword v220, v221, s[24:27], s45 offen offset:0 sc1
  s_waitcnt vmcnt(0)
  v_cmp_ne_u32 vcc, s101, v220
  s_cbranch_vccz POLLD_p4
  s_sub_u32 s46, s46, 1
  s_cmp_lg_u32 s46, 0
  s_cbranch_scc1 POLL_p4
POLLD_p4:
  s_mov_b64 exec, -1
  s_cmp_eq_u32 s44, 1
  s_cbranch_scc0 POLLS_p4
POLLF_p4:
  s_add_u32 s39, s37, 0
  buffer_load_dwordx4 v[64:67], v8, s[24:27], s39 offen offset:0 sc1
  buffer_load_dwordx4 v[68:71], v8, s[24:27], s39 offen offset:1024 sc1
  buffer_load_dwordx4 v[72:75], v8, s[24:27], s39 offen offset:2048 sc1
  buffer_load_dwordx4 v[76:79], v8, s[24:27], s39 offen offset:3072 sc1
  s_add_u32 s39, s37, 4096
  buffer_load_dwordx4 v[80:83], v8, s[24:27], s39 offen offset:0 sc1
  buffer_load_dwordx4 v[84:87], v8, s[24:27], s39 offen offset:1024 sc1
  buffer_load_dwordx4 v[88:91], v8, s[24:27], s39 offen offset:2048 sc1
  buffer_load_dwordx4 v[92:95], v8, s[24:27], s39 offen offset:3072 sc1
  s_add_u32 s39, s37, 8192
  buffer_load_dwordx4 v[96:99], v8, s[24:27], s39 offen offset:0 sc1
  buffer_load_dwordx4 v[100:103], v8, s[24:27], s39 offen offset:1024 sc1
  buffer_load_dwordx4 v[104:107], v8, s[24:27], s39 offen offset:2048 sc1
  buffer_load_dwordx4 v[108:111], v8, s[24:27], s39 offen offset:3072 sc1
  s_add_u32 s39, s37, 12288
  buffer_load_dwordx4 v[112:115], v8, s[24:27], s39 offen offset:0 sc1
  buffer_load_dwordx4 v[116:119], v8, s[24:27], s39 offen offset:1024 sc1
  buffer_load_dwordx4 v[120:123], v8, s[24:27], s39 offen offset:2048 sc1
  buffer_load_dwordx4 v[124:127], v8, s[24:27], s39 offen offset:3072 sc1
  s_barrier
  ds_read_b64_tr_b16 v[12:13], v6 offset:0
  ds_read_b64_tr_b16 v[14:15], v6 offset:512
  ds_read_b64_tr_b16 v[16:17], v7 offset:0
  ds_read_b64_tr_b16 v[18:19], v7 offset:512
  ds_read_b64_tr_b16 v[20:21], v6 offset:2048
  ds_read_b64_tr_b16 v[22:23], v6 offset:2560
  ds_read_b64_tr_b16 v[24:25], v7 offset:2048
  ds_read_b64_tr_b16 v[26:27], v7 offset:2560
  ds_read_b64_tr_b16 v[28:29], v6 offset:4096
  ds_read_b64_tr_b16 v[30:31], v6 offset:4608
  ds_read_b64_tr_b16 v[32:33], v7 offset:4096
  ds_read_b64_tr_b16 v[34:35], v7 offset:4608
  s_waitcnt vmcnt(15) lgkmcnt(8)
  v_mfma_f32_32x32x16_bf16 v[168:183], v[16:19], v[64:67], 0
  ds_read_b64_tr_b16 v[36:37], v6 offset:6144
  ds_read_b64_tr_b16 v[38:39], v6 offset:6656
  v_mfma_f32_32x32x16_bf16 v[152:167], v[12:15], v[64:67], 0
  ds_read_b64_tr_b16 v[40:41], v7 offset:6144
  ds_read_b64_tr_b16 v[42:43], v7 offset:6656
  s_waitcnt vmcnt(14) lgkmcnt(8)
  v_mfma_f32_32x32x16_bf16 v[168:183], v[24:27], v[68:71], v[168:183]
  ds_read_b64_tr_b16 v[12:13], v6 offset:8192
  ds_read_b64_tr_b16 v[14:15], v6 offset:8704
  v_mfma_f32_32x32x16_bf16 v[152:167], v[20:23], v[68:71], v[152:167]
  ds_read_b64_tr_b16 v[16:17], v7 offset:8192
  ds_read_b64_tr_b16 v[18:19], v7 offset:8704
  s_waitcnt vmcnt(13) lgkmcnt(8)
  v_mfma_f32_32x32x16_bf16 v[168:183], v[32:35], v[72:75], v[168:183]
  ds_read_b64_tr_b16 v[20:21], v6 offset:10240
  ds_read_b64_tr_b16 v[22:23], v6 offset:10752
  v_mfma_f32_32x32x16_bf16 v[152:167], v[28:31], v[72:75], v[152:167]
  ds_read_b64_tr_b16 v[24:25], v7 offset:10240
  ds_read_b64_tr_b16 v[26:27], v7 offset:10752
  s_waitcnt vmcnt(12) lgkmcnt(8)
  v_mfma_f32_32x32x16_bf16 v[168:183], v[40:43], v[76:79], v[168:183]
  ds_read_b64_tr_b16 v[28:29], v6 offset:12288
  ds_read_b64_tr_b16 v[30:31], v6 offset:12800
  v_mfma_f32_32x32x16_bf16 v[152:167], v[36:39], v[76:79], v[152:167]
  ds_read_b64_tr_b16 v[32:33], v7 offset:12288
  ds_read_b64_tr_b16 v[34:35], v7 offset:12800
  s_waitcnt vmcnt(11) lgkmcnt(8)
  v_mfma_f32_32x32x16_bf16 v[168:183], v[16:19], v[80:83], v[168:183]
  ds_read_b64_tr_b16 v[36:37], v6 offset:14336
  ds_read_b64_tr_b16 v[38:39], v6 offset:14848
  v_mfma_f32_32x32x16_bf16 v[152:167], v[12:15], v[80:83], v[152:167]
  ds_read_b64_tr_b16 v[40:41], v7 offset:14336
  ds_read_b64_tr_b16 v[42:43], v7 offset:14848
  s_waitcnt vmcnt(10) lgkmcnt(8)
  v_mfma_f32_32x32x16_bf16 v[168:183], v[24:27], v[84:87], v[168:183]
  ds_read_b64_tr_b16 v[12:13], v6 offset:16384
  ds_read_b64_tr_b16 v[14:15], v6 offset:16896
  v_mfma_f32_32x32x16_bf16 v[152:167], v[20:23], v[84:87], v[152:167]
  ds_read_b64_tr_b16 v[16:17], v7 offset:16384
  ds_read_b64_tr_b16 v[18:19], v7 offset:16896
  s_waitcnt vmcnt(9) lgkmcnt(8)
  v_mfma_f32_32x32x16_bf16 v[168:183], v[32:35], v[88:91], v[168:183]
  ds_read_b64_tr_b16 v[20:21], v6 offset:18432
  ds_read_b64_tr_b16 v[22:23], v6 offset:18944
  v_mfma_f32_32x32x16_bf16 v[152:167], v[28:31], v[88:91], v[152:167]
  ds_read_b64_tr_b16 v[24:25], v7 offset:18432
  ds_read_b64_tr_b16 v[26:27], v7 offset:18944
  s_waitcnt vmcnt(8) lgkmcnt(8)
  v_mfma_f32_32x32x16_bf16 v[168:183], v[40:43], v[92:95], v[168:183]
  ds_read_b64_tr_b16 v[28:29], v6 offset:20480
  ds_read_b64_tr_b16 v[30:31], v6 offset:20992
  v_mfma_f32_32x32x16_bf16 v[152:167], v[36:39], v[92:95], v[152:167]
  ds_read_b64_tr_b16 v[32:33], v7 offset:20480
  ds_read_b64_tr_b16 v[34:35], v7 offset:20992
  s_waitcnt vmcnt(7) lgkmcnt(8)
  v_mfma_f32_32x32x16_bf16 v[168:183], v[16:19], v[96:99], v[168:183]
  ds_read_b64_tr_b16 v[36:37], v6 offset:22528
  ds_read_b64_tr_b16 v[38:39], v6 offset:23040
  v_mfma_f32_32x32x16_bf16 v[152:167], v[12:15], v[96:99], v[152:167]
  ds_read_b64_tr_b16 v[40:41], v7 offset:22528
  ds_read_b64_tr_b16 v[42:43], v7 offset:23040
  s_waitcnt vmcnt(6) lgkmcnt(8)
  v_mfma_f32_32x32x16_bf16 v[168:183], v[24:27], v[100:103], v[168:183]
  ds_read_b64_tr_b16 v[12:13], v6 offset:24576
  ds_read_b64_tr_b16 v[14:15], v6 offset:25088
  v_mfma_f32_32x32x16_bf16 v[152:167], v[20:23], v[100:103], v[152:167]
  ds_read_b64_tr_b16 v[16:17], v7 offset:24576
  ds_read_b64_tr_b16 v[18:19], v7 offset:25088
  s_waitcnt vmcnt(5) lgkmcnt(8)
  v_mfma_f32_32x32x16_bf16 v[168:183], v[32:35], v[104:107], v[168:183]
  ds_read_b64_tr_b16 v[20:21], v6 offset:26624
  ds_read_b64_tr_b16 v[22:23], v6 offset:27136
  v_mfma_f32_32x32x16_bf16 v[152:167], v[28:31], v[104:107], v[152:167]
  ds_read_b64_tr_b16 v[24:25], v7 offset:26624
  ds_read_b64_tr_b16 v[26:27], v7 offset:27136
  s_waitcnt vmcnt(4) lgkmcnt(8)
  v_mfma_f32_32x32x16_bf16 v[168:183], v[40:43], v[108:111], v[168:183]
  ds_read_b64_tr_b16 v[28:29], v6 offset:28672
  ds_read_b64_tr_b16 v[30:31], v6 offset:29184
  v_mfma_f32_32x32x16_bf16 v[152:167], v[36:39], v[108:111], v[152:167]
  ds_read_b64_tr_b16 v[32:33], v7 offset:28672
  ds_read_b64_tr_b16 v[34:35], v7 offset:29184
  s_waitcnt vmcnt(3) lgkmcnt(8)
  v_mfma_f32_32x32x16_bf16 v[168:183], v[16:19], v[112:115], v[168:183]
  ds_read_b64_tr_b16 v[36:37], v6 offset:30720
  ds_read_b64_tr_b16 v[38:39], v6 offset:31232
  v_mfma_f32_32x32x16_bf16 v[152:167], v[12:15], v[112:115], v[152:167]
  ds_read_b64_tr_b16 v[40:41], v7 offset:30720
  ds_read_b64_tr_b16 v[42:43], v7 offset:31232
  s_waitcnt vmcnt(2) lgkmcnt(8)
  v_mfma_f32_32x32x16_bf16 v[168:183], v[24:27], v[116:119], v[168:183]
  v_mfma_f32_32x32x16_bf16 v[152:167], v[20:23], v[116:119], v[152:167]
  s_waitcnt vmcnt(1) lgkmcnt(4)
  v_mfma_f32_32x32x16_bf16 v[168:183], v[32:35], v[120:123], v[168:183]
  v_mfma_f32_32x32x16_bf16 v[152:167], v[28:31], v[120:123], v[152:167]
  s_waitcnt vmcnt(0) lgkmcnt(0)
  v_mfma_f32_32x32x16_bf16 v[168:183], v[40:43], v[124:127], v[168:183]
  v_mfma_f32_32x32x16_bf16 v[152:167], v[36:39], v[124:127], v[152:167]
  s_nop 10
  ds_write_b128 v3, v[168:171] offset:0
  ds_write_b128 v3, v[172:175] offset:1024
  ds_write_b128 v3, v[176:179] offset:2048
  ds_write_b128 v3, v[180:183] offset:3072
  v_pk_fma_f32 v[184:185], v[152:153], v[224:225], v[184:185]
  v_pk_fma_f32 v[186:187], v[154:155], v[226:227], v[186:187]
  v_pk_fma_f32 v[188:189], v[156:157], v[228:229], v[188:189]
  v_pk_fma_f32 v[190:191], v[158:159], v[230:231], v[190:191]
  v_pk_fma_f32 v[192:193], v[160:161], v[232:233], v[192:193]
  v_pk_fma_f32 v[194:195], v[162:163], v[234:235], v[194:195]
  v_pk_fma_f32 v[196:197], v[164:165], v[236:237], v[196:197]
  v_pk_fma_f32 v[198:199], v[166:167], v[238:239], v[198:199]
  s_waitcnt lgkmcnt(0)
  s_barrier
  ds_read_b128 v[64:67], v9 offset:0
  ds_read_b128 v[68:71], v9 offset:1024
  ds_read_b128 v[72:75], v9 offset:2048
  ds_read_b128 v[76:79], v9 offset:3072
  s_waitcnt lgkmcnt(0)
  s_barrier
  v_pk_fma_f32 v[184:185], v[64:65], v[224:225], v[184:185]
  v_pk_fma_f32 v[186:187], v[66:67], v[226:227], v[186:187]
  v_pk_fma_f32 v[188:189], v[68:69], v[228:229], v[188:189]
  v_pk_fma_f32 v[190:191], v[70:71], v[230:231], v[190:191]
  v_pk_fma_f32 v[192:193], v[72:73], v[232:233], v[192:193]
  v_pk_fma_f32 v[194:195], v[74:75], v[234:235], v[194:195]
  v_pk_fma_f32 v[196:197], v[76:77], v[236:237], v[196:197]
  v_pk_fma_f32 v[198:199], v[78:79], v[238:239], v[198:199]
  v_pk_fma_f32 v[136:137], v[136:137], v[184:185], v[184:185]
  v_pk_fma_f32 v[138:139], v[138:139], v[186:187], v[186:187]
  v_pk_fma_f32 v[140:141], v[140:141], v[188:189], v[188:189]
  v_pk_fma_f32 v[142:143], v[142:143], v[190:191], v[190:191]
  v_pk_fma_f32 v[144:145], v[144:145], v[192:193], v[192:193]
  v_pk_fma_f32 v[146:147], v[146:147], v[194:195], v[194:195]
  v_pk_fma_f32 v[148:149], v[148:149], v[196:197], v[196:197]
  v_pk_fma_f32 v[150:151], v[150:151], v[198:199], v[198:199]
  v_cvt_pk_bf16_f32 v96, v136, v137
  v_cvt_pk_bf16_f32 v97, v138, v139
  v_cvt_pk_bf16_f32 v98, v140, v141
  v_cvt_pk_bf16_f32 v99, v142, v143
  v_cvt_pk_bf16_f32 v100, v144, v145
  v_cvt_pk_bf16_f32 v101, v146, v147
  v_cvt_pk_bf16_f32 v102, v148, v149
  v_cvt_pk_bf16_f32 v103, v150, v151
  s_lshl_b32 s43, s40, 15
  s_lshl_b32 s29, s41, 11
  s_add_u32 s43, s43, s29
  s_add_u32 s43, s43, 0x1400000
  buffer_store_dwordx4 v[96:99], v2, s[24:27], s43 offen offset:0
  buffer_store_dwordx4 v[100:103], v2, s[24:27], s43 offen offset:1024
  v_cvt_pk_bf16_f32 v248, v184, v185
  v_cvt_pk_bf16_f32 v249, v186, v187
  v_cvt_pk_bf16_f32 v250, v188, v189
  v_cvt_pk_bf16_f32 v251, v190, v191
  v_cvt_pk_bf16_f32 v252, v192, v193
  v_cvt_pk_bf16_f32 v253, v194, v195
  v_cvt_pk_bf16_f32 v254, v196, v197
  v_cvt_pk_bf16_f32 v255, v198, v199
  v_mov_b32 v6, 0x3f803f80
  v_dot2_f32_bf16 v4, v248, v6, 0
  v_dot2_f32_bf16 v5, v248, v248, 0
  v_dot2_f32_bf16 v4, v249, v6, v4
  v_dot2_f32_bf16 v5, v249, v249, v5
  v_dot2_f32_bf16 v4, v250, v6, v4
  v_dot2_f32_bf16 v5, v250, v250, v5
  v_dot2_f32_bf16 v4, v251, v6, v4
  v_dot2_f32_bf16 v5, v251, v251, v5
  v_dot2_f32_bf16 v4, v252, v6, v4
  v_dot2_f32_bf16 v5, v252, v252, v5
  v_dot2_f32_bf16 v4, v253, v6, v4
  v_dot2_f32_bf16 v5, v253, v253, v5
  v_dot2_f32_bf16 v4, v254, v6, v4
  v_dot2_f32_bf16 v5, v254, v254, v5
  v_dot2_f32_bf16 v4, v255, v6, v4
  v_dot2_f32_bf16 v5, v255, v255, v5
  v_mov_b32 v6, v4
  v_mov_b32 v7, v5
  s_nop 0
  v_permlane32_swap_b32 v4, v6
  v_permlane32_swap_b32 v5, v7
  v_add_f32 v4, v4, v6
  v_add_f32 v5, v5, v7
  v_lshlrev_b32 v6, 3, v1
  s_lshl_b32 s29, s40, 12
  s_lshl_b32 s46, s41, 8
  s_add_u32 s29, s29, s46
  s_add_u32 s29, s29, 0x20000
  s_mov_b64 exec, 0xffffffff
  buffer_store_dwordx2 v[4:5], v6, s[24:27], s29 offen
  s_mov_b64 exec, -1
  s_and_b32 s29, s40, 7
  s_lshl_b32 s29, s29, 4
  s_add_u32 s4, s29, s41
  s_cmp_ge_u32 s28, 14
  s_cselect_b32 s46, 1, 0
  s_mul_i32 s47, s46, 14
  s_sub_u32 s41, s28, s47
  s_lshl_b32 s40, s3, 1
  s_add_u32 s40, s40, s46
  s_lshl_b32 s40, s40, 2
  s_add_u32 s40, s40, s34
  v_mov_b32 v28, 0
  v_mov_b32 v29, 0
  v_mov_b32 v30, 0
  v_mov_b32 v31, 0
  v_bfe_u32 v3, v1, 2, 2
  v_mul_u32_u24 v3, 1088, v3
  v_lshrrev_b32 v12, 5, v1
  v_lshl_add_u32 v3, v12, 9, v3
  v_and_b32 v13, 15, v1
  v_lshlrev_b32 v13, 4, v13
  v_lshl_add_u32 v13, v12, 9, v13
  v_and_b32 v12, 3, v1
  v_lshl_add_u32 v3, v12, 3, v3
  v_bfe_u32 v12, v1, 4, 1
  v_lshl_add_u32 v14, v12, 10, v13
  v_lshl_add_u32 v13, v12, 3, v13
  v_mul_u32_u24 v12, 4384, v12
  s_and_b32 s29, s34, 1
  s_lshl_b32 s29, s29, 7
  v_add3_u32 v5, v3, v12, s29
  s_lshl_b32 s36, s34, 11
  s_add_u32 s36, s36, 17664
  s_and_b32 s29, s34, 2
  s_lshl_b32 s29, s29, 11
  s_add_u32 s29, s29, 17664
  v_add_u32 v8, s29, v14
  s_mov_b32 s43, 103424
  v_add_u32 v4, s43, v5
  v_add_u32 v7, s43, v8
  s_lshl_b32 s37, s40, 15
  s_add_u32 s37, s37, 0x1400000
  v_and_b32 v3, 31, v1
  v_lshlrev_b32 v3, 3, v3
  v_lshrrev_b32 v12, 5, v1
  v_lshl_add_u32 v3, v12, 11, v3
  s_lshl_b32 s35, s40, 12
  s_add_u32 s35, s35, 0x20000
  s_lshl_b32 s29, s34, 11
  s_add_u32 s29, s29, 155136
  v_add_u32 v9, s29, v2
  s_and_b32 s29, s34, 2
  s_lshl_b32 s29, s29, 11
  s_add_u32 s29, s29, 155136
  v_add_u32 v6, s29, v13
  v_mfma_f32_32x32x16_bf16 v[84:99], v[28:31], v[28:31], 0
  v_mfma_f32_32x32x16_bf16 v[100:115], v[28:31], v[28:31], 0
  v_mfma_f32_32x32x16_bf16 v[116:131], v[28:31], v[28:31], 0
  v_mfma_f32_32x32x16_bf16 v[132:147], v[28:31], v[28:31], 0
  v_mfma_f32_32x32x16_bf16 v[148:163], v[28:31], v[28:31], 0
  v_mfma_f32_32x32x16_bf16 v[164:179], v[28:31], v[28:31], 0
  v_mfma_f32_32x32x16_bf16 v[180:195], v[28:31], v[28:31], 0
  v_mfma_f32_32x32x16_bf16 v[196:211], v[28:31], v[28:31], 0
  s_mov_b32 s42, 0
  s_and_b32 s29, s40, 7
  s_lshl_b32 s29, s29, 4
  s_waitcnt vmcnt(0)
  s_mov_b64 exec, 1
  v_mov_b32 v240, s101
  v_mov_b32 v241, s4
  v_lshlrev_b32 v241, 2, v241
  s_cmp_eq_u32 s44, 1
  s_cbranch_scc0 SIGS_p4
  buffer_store_dword v240, v241, s[24:27], s45 offen offset:512
SIGD_p4:
  s_mov_b64 exec, -1
  s_barrier
  s_cmp_ge_u32 s28, 28
  s_cbranch_scc1 LO_P6
  s_setprio 1
  v_add_lshl_u32 v241, v1, s29, 2
  s_mov_b32 s46, 0xffff
  s_mov_b32 s47, 0
  s_mov_b64 exec, s[46:47]
  s_mov_b32 s46, 400000
POLL_p5:
  buffer_load_dword v240, v241, s[24:27], s45 offen offset:512 sc1
  s_waitcnt vmcnt(0)
  v_cmp_ne_u32 vcc, s101, v240
  s_cbranch_vccz POLLD_p5
  s_sub_u32 s46, s46, 1
  s_cmp_lg_u32 s46, 0
  s_cbranch_scc1 POLL_p5
POLLD_p5:
  s_mov_b64 exec, -1
  s_cmp_eq_u32 s44, 1
  s_cbranch_scc0 POLLS_p5
POLLF_p5:
  s_and_b32 s40, s40, -2
  s_add_u32 s39, s37, 0
  s_add_u32 m0, s36, 103424
  s_nop 0
  buffer_load_dwordx4 v2, s[24:27], s39 offen sc1 lds
  buffer_load_dwordx4 v2, s[24:27], s39 offen offset:1024 sc1 lds
  s_add_u32 s39, s37, 2048
  s_add_u32 m0, s36, 129280
  s_nop 0
  buffer_load_dwordx4 v2, s[24:27], s39 offen sc1 lds
  buffer_load_dwordx4 v2, s[24:27], s39 offen offset:1024 sc1 lds
  buffer_load_dwordx2 v[212:213], v3, s[24:27], s35 offen offset:0 sc1
  buffer_load_dwordx2 v[214:215], v3, s[24:27], s35 offen offset:256 sc1
  buffer_load_dwordx2 v[216:217], v3, s[24:27], s35 offen offset:512 sc1
  buffer_load_dwordx2 v[218:219], v3, s[24:27], s35 offen offset:768 sc1
  buffer_load_dwordx2 v[220:221], v3, s[24:27], s35 offen offset:1024 sc1
  buffer_load_dwordx2 v[222:223], v3, s[24:27], s35 offen offset:1280 sc1
  buffer_load_dwordx2 v[224:225], v3, s[24:27], s35 offen offset:1536 sc1
  buffer_load_dwordx2 v[226:227], v3, s[24:27], s35 offen offset:1792 sc1
  s_mul_i32 s38, s40, 112
  s_lshl_b32 s29, s41, 1
  s_and_b32 s46, s34, 1
  s_add_u32 s29, s29, s46
  s_and_b32 s4, s40, 7
  s_lshl_b32 s4, s4, 5
  s_add_u32 s4, s4, s29
  s_lshl_b32 s29, s29, 2
  s_add_u32 s38, s38, s29
  s_lshl_b32 s38, s38, 10
  s_add_u32 s38, s38, 0xd00000
  s_add_u32 s39, s38, 114688
  v_and_b32 v3, 15, v1
  v_lshlrev_b32 v83, 2, v3
  v_lshlrev_b32 v3, 4, v3
  v_lshrrev_b32 v11, 4, v1
  v_lshl_add_u32 v3, v11, 9, v3
  v_and_b32 v11, -9, v6
  v_and_b32 v10, 32, v1
  v_lshlrev_b32 v10, 5, v10
  v_sub_u32 v10, v6, v10
  v_add_u32 v10, 512, v10
  s_lshl_b32 s35, s29, 9
  s_mul_i32 s36, s3, 114688
  s_add_u32 s35, s35, s36
  s_add_u32 s35, s35, 0x1600000
  s_waitcnt vmcnt(8)
  s_barrier
  ds_read_b128 v[44:47], v7 offset:0
  ds_read_b128 v[48:51], v7 offset:256
  ds_read_b128 v[52:55], v7 offset:2048
  ds_read_b128 v[56:59], v7 offset:2304
  ds_read_b64_tr_b16 v[12:13], v4 offset:0
  ds_read_b64_tr_b16 v[14:15], v4 offset:256
  ds_read_b64_tr_b16 v[16:17], v4 offset:32
  ds_read_b64_tr_b16 v[18:19], v4 offset:288
  ds_read_b64_tr_b16 v[20:21], v4 offset:8768
  ds_read_b64_tr_b16 v[22:23], v4 offset:9024
  ds_read_b64_tr_b16 v[24:25], v4 offset:8800
  ds_read_b64_tr_b16 v[26:27], v4 offset:9056
  .p2align 6
P5_LOOP:
  s_waitcnt lgkmcnt(6)
  v_mfma_f32_16x16x32_bf16 v[84:87], v[12:15], v[44:47], v[84:87]
  ds_read_b64_tr_b16 v[28:29], v4 offset:64
  v_mfma_f32_16x16x32_bf16 v[116:119], v[12:15], v[48:51], v[116:119]
  ds_read_b64_tr_b16 v[30:31], v4 offset:320
  v_mfma_f32_16x16x32_bf16 v[148:151], v[12:15], v[52:55], v[148:151]
  v_mfma_f32_16x16x32_bf16 v[180:183], v[12:15], v[56:59], v[180:183]
  s_waitcnt lgkmcnt(6)
  v_mfma_f32_16x16x32_bf16 v[88:91], v[16:19], v[44:47], v[88:91]
  ds_read_b64_tr_b16 v[32:33], v4 offset:96
  v_mfma_f32_16x16x32_bf16 v[120:123], v[16:19], v[48:51], v[120:123]
  ds_read_b64_tr_b16 v[34:35], v4 offset:352
  v_mfma_f32_16x16x32_bf16 v[152:155], v[16:19], v[52:55], v[152:155]
  v_mfma_f32_16x16x32_bf16 v[184:187], v[16:19], v[56:59], v[184:187]
  s_waitcnt lgkmcnt(6)
  v_mfma_f32_16x16x32_bf16 v[92:95], v[20:23], v[44:47], v[92:95]
  ds_read_b64_tr_b16 v[36:37], v4 offset:8832
  v_mfma_f32_16x16x32_bf16 v[124:127], v[20:23], v[48:51], v[124:127]
  ds_read_b64_tr_b16 v[38:39], v4 offset:9088
  v_mfma_f32_16x16x32_bf16 v[156:159], v[20:23], v[52:55], v[156:159]
  v_mfma_f32_16x16x32_bf16 v[188:191], v[20:23], v[56:59], v[188:191]
  s_waitcnt lgkmcnt(6)
  v_mfma_f32_16x16x32_bf16 v[96:99], v[24:27], v[44:47], v[96:99]
  ds_read_b64_tr_b16 v[40:41], v4 offset:8864
  v_mfma_f32_16x16x32_bf16 v[128:131], v[24:27], v[48:51], v[128:131]
  ds_read_b64_tr_b16 v[42:43], v4 offset:9120
  v_mfma_f32_16x16x32_bf16 v[160:163], v[24:27], v[52:55], v[160:163]
  v_mfma_f32_16x16x32_bf16 v[192:195], v[24:27], v[56:59], v[192:195]
  s_barrier
  s_waitcnt lgkmcnt(6)
  v_mfma_f32_16x16x32_bf16 v[100:103], v[28:31], v[44:47], v[100:103]
  ds_read_b128 v[60:63], v7 offset:25856
  ds_read_b128 v[64:67], v7 offset:26112
  v_mfma_f32_16x16x32_bf16 v[132:135], v[28:31], v[48:51], v[132:135]
  ds_read_b128 v[68:71], v7 offset:27904
  ds_read_b128 v[72:75], v7 offset:28160
  v_mfma_f32_16x16x32_bf16 v[164:167], v[28:31], v[52:55], v[164:167]
  ds_read_b64_tr_b16 v[12:13], v4 offset:25856
  ds_read_b64_tr_b16 v[14:15], v4 offset:26112
  v_mfma_f32_16x16x32_bf16 v[196:199], v[28:31], v[56:59], v[196:199]
  s_waitcnt lgkmcnt(10)
  v_mfma_f32_16x16x32_bf16 v[104:107], v[32:35], v[44:47], v[104:107]
  ds_read_b64_tr_b16 v[16:17], v4 offset:25888
  v_mfma_f32_16x16x32_bf16 v[136:139], v[32:35], v[48:51], v[136:139]
  ds_read_b64_tr_b16 v[18:19], v4 offset:26144
  v_mfma_f32_16x16x32_bf16 v[168:171], v[32:35], v[52:55], v[168:171]
  v_mfma_f32_16x16x32_bf16 v[200:203], v[32:35], v[56:59], v[200:203]
  s_waitcnt lgkmcnt(10)
  v_mfma_f32_16x16x32_bf16 v[108:111], v[36:39], v[44:47], v[108:111]
  ds_read_b64_tr_b16 v[20:21], v4 offset:34624
  v_mfma_f32_16x16x32_bf16 v[140:143], v[36:39], v[48:51], v[140:143]
  ds_read_b64_tr_b16 v[22:23], v4 offset:34880
  s_branch SK_P5
ST_P5:
  s_branch ST_P6
SK_P5:
  v_mfma_f32_16x16x32_bf16 v[172:175], v[36:39], v[52:55], v[172:175]
  v_mfma_f32_16x16x32_bf16 v[204:207], v[36:39], v[56:59], v[204:207]
  s_waitcnt lgkmcnt(10)
  v_mfma_f32_16x16x32_bf16 v[112:115], v[40:43], v[44:47], v[112:115]
  ds_read_b64_tr_b16 v[24:25], v4 offset:34656
  v_mfma_f32_16x16x32_bf16 v[144:147], v[40:43], v[48:51], v[144:147]
  ds_read_b64_tr_b16 v[26:27], v4 offset:34912
  v_mfma_f32_16x16x32_bf16 v[176:179], v[40:43], v[52:55], v[176:179]
  v_mfma_f32_16x16x32_bf16 v[208:211], v[40:43], v[56:59], v[208:211]
  s_waitcnt lgkmcnt(6)
  v_mfma_f32_16x16x32_bf16 v[84:87], v[12:15], v[60:63], v[84:87]
  ds_read_b64_tr_b16 v[28:29], v4 offset:25920
  v_mfma_f32_16x16x32_bf16 v[116:119], v[12:15], v[64:67], v[116:119]
  ds_read_b64_tr_b16 v[30:31], v4 offset:26176
  v_mfma_f32_16x16x32_bf16 v[148:151], v[12:15], v[68:71], v[148:151]
  v_mfma_f32_16x16x32_bf16 v[180:183], v[12:15], v[72:75], v[180:183]
  s_waitcnt lgkmcnt(6)
  v_mfma_f32_16x16x32_bf16 v[88:91], v[16:19], v[60:63], v[88:91]
  ds_read_b64_tr_b16 v[32:33], v4 offset:25952
  v_mfma_f32_16x16x32_bf16 v[120:123], v[16:19], v[64:67], v[120:123]
  ds_read_b64_tr_b16 v[34:35], v4 offset:26208
  v_mfma_f32_16x16x32_bf16 v[152:155], v[16:19], v[68:71], v[152:155]
  v_mfma_f32_16x16x32_bf16 v[184:187], v[16:19], v[72:75], v[184:187]
  s_waitcnt lgkmcnt(6)
  v_mfma_f32_16x16x32_bf16 v[92:95], v[20:23], v[60:63], v[92:95]
  ds_read_b64_tr_b16 v[36:37], v4 offset:34688
  ds_read_b64_tr_b16 v[38:39], v4 offset:34944
  v_mfma_f32_16x16x32_bf16 v[124:127], v[20:23], v[64:67], v[124:127]
  s_add_u32 s43, s43, 51712
  s_cmp_eq_u32 s43, 155136
  v_mfma_f32_16x16x32_bf16 v[156:159], v[20:23], v[68:71], v[156:159]
  s_cselect_b32 s43, 0, s43
  v_mfma_f32_16x16x32_bf16 v[188:191], v[20:23], v[72:75], v[188:191]
  s_waitcnt lgkmcnt(6)
  v_mfma_f32_16x16x32_bf16 v[96:99], v[24:27], v[60:63], v[96:99]
  ds_read_b64_tr_b16 v[40:41], v4 offset:34720
  v_mfma_f32_16x16x32_bf16 v[128:131], v[24:27], v[64:67], v[128:131]
  ds_read_b64_tr_b16 v[42:43], v4 offset:34976
  v_mfma_f32_16x16x32_bf16 v[160:163], v[24:27], v[68:71], v[160:163]
  v_add_u32 v4, s43, v5
  v_mfma_f32_16x16x32_bf16 v[192:195], v[24:27], v[72:75], v[192:195]
  v_add_u32 v7, s43, v8
  s_barrier
  s_waitcnt lgkmcnt(6)
  v_mfma_f32_16x16x32_bf16 v[100:103], v[28:31], v[60:63], v[100:103]
  ds_read_b128 v[44:47], v7 offset:0
  ds_read_b128 v[48:51], v7 offset:256
  v_mfma_f32_16x16x32_bf16 v[132:135], v[28:31], v[64:67], v[132:135]
  ds_read_b128 v[52:55], v7 offset:2048
  ds_read_b128 v[56:59], v7 offset:2304
  v_mfma_f32_16x16x32_bf16 v[164:167], v[28:31], v[68:71], v[164:167]
  ds_read_b64_tr_b16 v[12:13], v4 offset:0
  ds_read_b64_tr_b16 v[14:15], v4 offset:256
  v_mfma_f32_16x16x32_bf16 v[196:199], v[28:31], v[72:75], v[196:199]
  s_waitcnt lgkmcnt(10)
  v_mfma_f32_16x16x32_bf16 v[104:107], v[32:35], v[60:63], v[104:107]
  ds_read_b64_tr_b16 v[16:17], v4 offset:32
  v_mfma_f32_16x16x32_bf16 v[136:139], v[32:35], v[64:67], v[136:139]
  ds_read_b64_tr_b16 v[18:19], v4 offset:288
  v_mfma_f32_16x16x32_bf16 v[168:171], v[32:35], v[68:71], v[168:171]
  v_mfma_f32_16x16x32_bf16 v[200:203], v[32:35], v[72:75], v[200:203]
  s_waitcnt lgkmcnt(10)
  v_mfma_f32_16x16x32_bf16 v[108:111], v[36:39], v[60:63], v[108:111]
  ds_read_b64_tr_b16 v[20:21], v4 offset:8768
  v_mfma_f32_16x16x32_bf16 v[140:143], v[36:39], v[64:67], v[140:143]
  ds_read_b64_tr_b16 v[22:23], v4 offset:9024
  v_mfma_f32_16x16x32_bf16 v[172:175], v[36:39], v[68:71], v[172:175]
  s_add_u32 s42, s42, 1
  v_mfma_f32_16x16x32_bf16 v[204:207], v[36:39], v[72:75], v[204:207]
  s_cmp_lt_u32 s42, 2
  s_waitcnt lgkmcnt(10)
  v_mfma_f32_16x16x32_bf16 v[112:115], v[40:43], v[60:63], v[112:115]
  ds_read_b64_tr_b16 v[24:25], v4 offset:8800
  v_mfma_f32_16x16x32_bf16 v[144:147], v[40:43], v[64:67], v[144:147]
  ds_read_b64_tr_b16 v[26:27], v4 offset:9056
  v_mfma_f32_16x16x32_bf16 v[176:179], v[40:43], v[68:71], v[176:179]
  v_mfma_f32_16x16x32_bf16 v[208:211], v[40:43], v[72:75], v[208:211]
  s_cbranch_scc1 P5_LOOP
  s_waitcnt lgkmcnt(6)
  v_mfma_f32_16x16x32_bf16 v[84:87], v[12:15], v[44:47], v[84:87]
  ds_read_b64_tr_b16 v[28:29], v4 offset:64
  v_mfma_f32_16x16x32_bf16 v[116:119], v[12:15], v[48:51], v[116:119]
  ds_read_b64_tr_b16 v[30:31], v4 offset:320
  v_mfma_f32_16x16x32_bf16 v[148:151], v[12:15], v[52:55], v[148:151]
  buffer_load_dword v82, v83, s[24:27], s45 offen offset:2176 sc1
  v_mfma_f32_16x16x32_bf16 v[180:183], v[12:15], v[56:59], v[180:183]
  s_waitcnt lgkmcnt(6)
  v_mfma_f32_16x16x32_bf16 v[88:91], v[16:19], v[44:47], v[88:91]
  ds_read_b64_tr_b16 v[32:33], v4 offset:96
  v_mfma_f32_16x16x32_bf16 v[120:123], v[16:19], v[48:51], v[120:123]
  ds_read_b64_tr_b16 v[34:35], v4 offset:352
  v_mfma_f32_16x16x32_bf16 v[152:155], v[16:19], v[52:55], v[152:155]
  v_mfma_f32_16x16x32_bf16 v[184:187], v[16:19], v[56:59], v[184:187]
  s_waitcnt lgkmcnt(6)
  v_mfma_f32_16x16x32_bf16 v[92:95], v[20:23], v[44:47], v[92:95]
  ds_read_b64_tr_b16 v[36:37], v4 offset:8832
  v_mfma_f32_16x16x32_bf16 v[124:127], v[20:23], v[48:51], v[124:127]
  ds_read_b64_tr_b16 v[38:39], v4 offset:9088
  v_mfma_f32_16x16x32_bf16 v[156:159], v[20:23], v[52:55], v[156:159]
  v_mfma_f32_16x16x32_bf16 v[188:191], v[20:23], v[56:59], v[188:191]
  s_waitcnt lgkmcnt(6)
  v_mfma_f32_16x16x32_bf16 v[96:99], v[24:27], v[44:47], v[96:99]
  ds_read_b64_tr_b16 v[40:41], v4 offset:8864
  v_mfma_f32_16x16x32_bf16 v[128:131], v[24:27], v[48:51], v[128:131]
  ds_read_b64_tr_b16 v[42:43], v4 offset:9120
  v_mfma_f32_16x16x32_bf16 v[160:163], v[24:27], v[52:55], v[160:163]
  v_mfma_f32_16x16x32_bf16 v[192:195], v[24:27], v[56:59], v[192:195]
  s_barrier
  s_waitcnt lgkmcnt(6)
  v_mfma_f32_16x16x32_bf16 v[100:103], v[28:31], v[44:47], v[100:103]
  ds_read_b128 v[60:63], v7 offset:25856
  ds_read_b128 v[64:67], v7 offset:26112
  v_mfma_f32_16x16x32_bf16 v[132:135], v[28:31], v[48:51], v[132:135]
  ds_read_b128 v[68:71], v7 offset:27904
  ds_read_b128 v[72:75], v7 offset:28160
  v_mfma_f32_16x16x32_bf16 v[164:167], v[28:31], v[52:55], v[164:167]
  ds_read_b64_tr_b16 v[12:13], v4 offset:25856
  ds_read_b64_tr_b16 v[14:15], v4 offset:26112
  v_mfma_f32_16x16x32_bf16 v[196:199], v[28:31], v[56:59], v[196:199]
  s_waitcnt lgkmcnt(10)
  v_mfma_f32_16x16x32_bf16 v[104:107], v[32:35], v[44:47], v[104:107]
  ds_read_b64_tr_b16 v[16:17], v4 offset:25888
  v_mfma_f32_16x16x32_bf16 v[136:139], v[32:35], v[48:51], v[136:139]
  ds_read_b64_tr_b16 v[18:19], v4 offset:26144
  v_mfma_f32_16x16x32_bf16 v[168:171], v[32:35], v[52:55], v[168:171]
  v_mfma_f32_16x16x32_bf16 v[200:203], v[32:35], v[56:59], v[200:203]
  s_waitcnt lgkmcnt(10)
  v_mfma_f32_16x16x32_bf16 v[108:111], v[36:39], v[44:47], v[108:111]
  ds_read_b64_tr_b16 v[20:21], v4 offset:34624
  v_mfma_f32_16x16x32_bf16 v[140:143], v[36:39], v[48:51], v[140:143]
  ds_read_b64_tr_b16 v[22:23], v4 offset:34880
  v_mfma_f32_16x16x32_bf16 v[172:175], v[36:39], v[52:55], v[172:175]
  v_mfma_f32_16x16x32_bf16 v[204:207], v[36:39], v[56:59], v[204:207]
  s_waitcnt lgkmcnt(10)
  v_mfma_f32_16x16x32_bf16 v[112:115], v[40:43], v[44:47], v[112:115]
  ds_read_b64_tr_b16 v[24:25], v4 offset:34656
  v_mfma_f32_16x16x32_bf16 v[144:147], v[40:43], v[48:51], v[144:147]
  ds_read_b64_tr_b16 v[26:27], v4 offset:34912
  v_mfma_f32_16x16x32_bf16 v[176:179], v[40:43], v[52:55], v[176:179]
  v_mfma_f32_16x16x32_bf16 v[208:211], v[40:43], v[56:59], v[208:211]
  s_waitcnt lgkmcnt(6)
  v_mfma_f32_16x16x32_bf16 v[84:87], v[12:15], v[60:63], v[84:87]
  ds_read_b64_tr_b16 v[28:29], v4 offset:25920
  ds_read_b64_tr_b16 v[30:31], v4 offset:26176
  v_mfma_f32_16x16x32_bf16 v[116:119], v[12:15], v[64:67], v[116:119]
  s_waitcnt vmcnt(0)
  v_cmp_ne_u32 vcc, s101, v82
  v_mfma_f32_16x16x32_bf16 v[148:151], v[12:15], v[68:71], v[148:151]
  s_nop 0
  s_cmp_eq_u64 vcc, 0
  v_mfma_f32_16x16x32_bf16 v[180:183], v[12:15], v[72:75], v[180:183]
  s_cselect_b32 s46, s44, 0
  s_cmp_lg_u32 s46, 1
  s_waitcnt lgkmcnt(6)
  v_mfma_f32_16x16x32_bf16 v[88:91], v[16:19], v[60:63], v[88:91]
  ds_read_b64_tr_b16 v[32:33], v4 offset:25952
  v_mfma_f32_16x16x32_bf16 v[120:123], v[16:19], v[64:67], v[120:123]
  ds_read_b64_tr_b16 v[34:35], v4 offset:26208
  v_mfma_f32_16x16x32_bf16 v[152:155], v[16:19], v[68:71], v[152:155]
  s_cbranch_scc1 HI_XRS
HI_XRD:
  v_mfma_f32_16x16x32_bf16 v[184:187], v[16:19], v[72:75], v[184:187]
  s_waitcnt lgkmcnt(6)
  v_mfma_f32_16x16x32_bf16 v[92:95], v[20:23], v[60:63], v[92:95]
  ds_read_b64_tr_b16 v[36:37], v4 offset:34688
  ds_read_b64_tr_b16 v[38:39], v4 offset:34944
  v_mfma_f32_16x16x32_bf16 v[124:127], v[20:23], v[64:67], v[124:127]
  s_add_u32 s43, s43, 51712
  s_cmp_eq_u32 s43, 155136
  v_mfma_f32_16x16x32_bf16 v[156:159], v[20:23], v[68:71], v[156:159]
  s_cselect_b32 s43, 0, s43
  buffer_load_dwordx4 v[228:231], v2, s[24:27], s35 offen offset:0 sc1
  v_mfma_f32_16x16x32_bf16 v[188:191], v[20:23], v[72:75], v[188:191]
  s_waitcnt lgkmcnt(6)
  v_mfma_f32_16x16x32_bf16 v[96:99], v[24:27], v[60:63], v[96:99]
  ds_read_b64_tr_b16 v[40:41], v4 offset:34720
  ds_read_b64_tr_b16 v[42:43], v4 offset:34976
  v_mfma_f32_16x16x32_bf16 v[128:131], v[24:27], v[64:67], v[128:131]
  v_add_u32 v4, s43, v5
  v_add_u32 v7, s43, v8
  v_mfma_f32_16x16x32_bf16 v[160:163], v[24:27], v[68:71], v[160:163]
  buffer_load_dwordx4 v[232:235], v2, s[24:27], s35 offen offset:1024 sc1
  v_mfma_f32_16x16x32_bf16 v[192:195], v[24:27], v[72:75], v[192:195]
  s_barrier
  s_waitcnt lgkmcnt(6)
  v_mfma_f32_16x16x32_bf16 v[100:103], v[28:31], v[60:63], v[100:103]
  ds_read_b128 v[44:47], v7 offset:0
  ds_read_b128 v[48:51], v7 offset:256
  v_mfma_f32_16x16x32_bf16 v[132:135], v[28:31], v[64:67], v[132:135]
  ds_read_b128 v[52:55], v7 offset:2048
  ds_read_b128 v[56:59], v7 offset:2304
  v_mfma_f32_16x16x32_bf16 v[164:167], v[28:31], v[68:71], v[164:167]
  ds_read_b64_tr_b16 v[12:13], v4 offset:0
  ds_read_b64_tr_b16 v[14:15], v4 offset:256
  v_mfma_f32_16x16x32_bf16 v[196:199], v[28:31], v[72:75], v[196:199]
  s_waitcnt lgkmcnt(10)
  v_mfma_f32_16x16x32_bf16 v[104:107], v[32:35], v[60:63], v[104:107]
  ds_read_b64_tr_b16 v[16:17], v4 offset:32
  v_mfma_f32_16x16x32_bf16 v[136:139], v[32:35], v[64:67], v[136:139]
  ds_read_b64_tr_b16 v[18:19], v4 offset:288
  v_mfma_f32_16x16x32_bf16 v[168:171], v[32:35], v[68:71], v[168:171]
  v_mfma_f32_16x16x32_bf16 v[200:203], v[32:35], v[72:75], v[200:203]
  s_waitcnt lgkmcnt(10)
  v_mfma_f32_16x16x32_bf16 v[108:111], v[36:39], v[60:63], v[108:111]
  ds_read_b64_tr_b16 v[20:21], v4 offset:8768
  v_mfma_f32_16x16x32_bf16 v[140:143], v[36:39], v[64:67], v[140:143]
  ds_read_b64_tr_b16 v[22:23], v4 offset:9024
  v_mfma_f32_16x16x32_bf16 v[172:175], v[36:39], v[68:71], v[172:175]
  v_mfma_f32_16x16x32_bf16 v[204:207], v[36:39], v[72:75], v[204:207]
  s_waitcnt lgkmcnt(10)
  v_mfma_f32_16x16x32_bf16 v[112:115], v[40:43], v[60:63], v[112:115]
  ds_read_b64_tr_b16 v[24:25], v4 offset:8800
  v_mfma_f32_16x16x32_bf16 v[144:147], v[40:43], v[64:67], v[144:147]
  ds_read_b64_tr_b16 v[26:27], v4 offset:9056
  v_mfma_f32_16x16x32_bf16 v[176:179], v[40:43], v[68:71], v[176:179]
  v_mfma_f32_16x16x32_bf16 v[208:211], v[40:43], v[72:75], v[208:211]
  s_waitcnt lgkmcnt(6)
  v_mfma_f32_16x16x32_bf16 v[84:87], v[12:15], v[44:47], v[84:87]
  ds_read_b64_tr_b16 v[28:29], v4 offset:64
  v_mfma_f32_16x16x32_bf16 v[116:119], v[12:15], v[48:51], v[116:119]
  ds_read_b64_tr_b16 v[30:31], v4 offset:320
  v_mfma_f32_16x16x32_bf16 v[148:151], v[12:15], v[52:55], v[148:151]
  v_mfma_f32_16x16x32_bf16 v[180:183], v[12:15], v[56:59], v[180:183]
  s_waitcnt lgkmcnt(6)
  v_mfma_f32_16x16x32_bf16 v[88:91], v[16:19], v[44:47], v[88:91]
  ds_read_b64_tr_b16 v[32:33], v4 offset:96
  v_mfma_f32_16x16x32_bf16 v[120:123], v[16:19], v[48:51], v[120:123]
  ds_read_b64_tr_b16 v[34:35], v4 offset:352
  v_mfma_f32_16x16x32_bf16 v[152:155], v[16:19], v[52:55], v[152:155]
  v_mfma_f32_16x16x32_bf16 v[184:187], v[16:19], v[56:59], v[184:187]
  s_waitcnt lgkmcnt(6)
  v_mfma_f32_16x16x32_bf16 v[92:95], v[20:23], v[44:47], v[92:95]
  ds_read_b64_tr_b16 v[36:37], v4 offset:8832
  v_mfma_f32_16x16x32_bf16 v[124:127], v[20:23], v[48:51], v[124:127]
  ds_read_b64_tr_b16 v[38:39], v4 offset:9088
  v_mfma_f32_16x16x32_bf16 v[156:159], v[20:23], v[52:55], v[156:159]
  v_mfma_f32_16x16x32_bf16 v[188:191], v[20:23], v[56:59], v[188:191]
  s_waitcnt lgkmcnt(6)
  v_mfma_f32_16x16x32_bf16 v[96:99], v[24:27], v[44:47], v[96:99]
  ds_read_b64_tr_b16 v[40:41], v4 offset:8864
  v_mfma_f32_16x16x32_bf16 v[128:131], v[24:27], v[48:51], v[128:131]
  ds_read_b64_tr_b16 v[42:43], v4 offset:9120
  v_mfma_f32_16x16x32_bf16 v[160:163], v[24:27], v[52:55], v[160:163]
  v_mfma_f32_16x16x32_bf16 v[192:195], v[24:27], v[56:59], v[192:195]
  v_pk_add_f32 v[212:213], v[212:213], v[220:221]
  v_pk_add_f32 v[214:215], v[214:215], v[222:223]
  v_pk_add_f32 v[216:217], v[216:217], v[224:225]
  v_pk_add_f32 v[218:219], v[218:219], v[226:227]
  v_pk_add_f32 v[212:213], v[212:213], v[216:217]
  v_pk_add_f32 v[214:215], v[214:215], v[218:219]
  v_pk_add_f32 v[212:213], v[212:213], v[214:215]
  v_mov_b64 v[214:215], v[212:213]
  s_mov_b32 s46, 0
  s_mov_b32 s47, -1
  v_permlane32_swap_b32 v212, v214
  v_permlane32_swap_b32 v213, v215
  v_pk_add_f32 v[212:213], v[212:213], v[214:215]
  v_mul_f32 v216, 0xbb000000, v212
  v_mul_f32 v213, 0x3b000000, v213
  v_fma_f32 v213, -v216, v216, v213
  v_max_f32 v213, 0, v213
  v_add_f32 v81, 0x3727c5ac, v213
  v_rsq_f32 v214, v81
  v_cvt_pk_bf16_f32 v76, v216, v216
  v_sqrt_f32 v217, v81
  v_mul_f32 v80, 0xbfb8aa3b, v214
  v_lshlrev_b32 v212, 16, v76
  v_cvt_pk_bf16_f32 v77, v217, v217
  v_sub_f32 v212, v216, v212
  v_lshlrev_b32 v213, 16, v77
  v_sub_f32 v213, v217, v213
  v_cvt_pk_bf16_f32 v78, v212, v213
  v_mov_b32 v79, 0
  ds_write_b64 v9, v[80:81] offset:1024
  v_cndmask_b32 v76, v76, v79, s[46:47]
  v_cndmask_b32 v77, v77, v79, s[46:47]
  v_cndmask_b32 v78, v78, v79, s[46:47]
  ds_write_b128 v9, v[76:79]
  s_waitcnt lgkmcnt(0)
  s_barrier
  s_waitcnt lgkmcnt(6)
  v_mfma_f32_16x16x32_bf16 v[100:103], v[28:31], v[44:47], v[100:103]
  ds_read_b128 v[60:63], v7 offset:25856
  ds_read_b128 v[64:67], v7 offset:26112
  v_mfma_f32_16x16x32_bf16 v[132:135], v[28:31], v[48:51], v[132:135]
  ds_read_b128 v[68:71], v7 offset:27904
  ds_read_b128 v[72:75], v7 offset:28160
  v_mfma_f32_16x16x32_bf16 v[164:167], v[28:31], v[52:55], v[164:167]
  ds_read_b64_tr_b16 v[12:13], v4 offset:25856
  ds_read_b64_tr_b16 v[14:15], v4 offset:26112
  v_mfma_f32_16x16x32_bf16 v[196:199], v[28:31], v[56:59], v[196:199]
  s_waitcnt lgkmcnt(10)
  v_mfma_f32_16x16x32_bf16 v[104:107], v[32:35], v[44:47], v[104:107]
  ds_read_b64_tr_b16 v[16:17], v4 offset:25888
  ds_read_b64_tr_b16 v[18:19], v4 offset:26144
  v_mfma_f32_16x16x32_bf16 v[136:139], v[32:35], v[48:51], v[136:139]
  ds_read_b64 v[212:213], v6 offset:0
  ds_read_b64 v[220:221], v11 offset:1024
  v_mfma_f32_16x16x32_bf16 v[168:171], v[32:35], v[52:55], v[168:171]
  ds_read_b64 v[214:215], v6 offset:256
  ds_read_b64 v[222:223], v11 offset:1280
  v_mfma_f32_16x16x32_bf16 v[200:203], v[32:35], v[56:59], v[200:203]
  ds_read_b64 v[236:237], v10 offset:0
  ds_read_b64 v[238:239], v10 offset:256
  s_waitcnt lgkmcnt(14)
  v_mfma_f32_16x16x32_bf16 v[108:111], v[36:39], v[44:47], v[108:111]
  ds_read_b64_tr_b16 v[20:21], v4 offset:34624
  ds_read_b64_tr_b16 v[22:23], v4 offset:34880
  v_mfma_f32_16x16x32_bf16 v[140:143], v[36:39], v[48:51], v[140:143]
  ds_read_b64 v[216:217], v6 offset:2048
  ds_read_b64 v[224:225], v11 offset:3072
  v_mfma_f32_16x16x32_bf16 v[172:175], v[36:39], v[52:55], v[172:175]
  ds_read_b64 v[218:219], v6 offset:2304
  ds_read_b64 v[226:227], v11 offset:3328
  v_mfma_f32_16x16x32_bf16 v[204:207], v[36:39], v[56:59], v[204:207]
  ds_read_b64 v[240:241], v10 offset:2048
  ds_read_b64 v[242:243], v10 offset:2304
  s_waitcnt lgkmcnt(14)
  v_mfma_f32_16x16x32_bf16 v[112:115], v[40:43], v[44:47], v[112:115]
  ds_read_b64_tr_b16 v[24:25], v4 offset:34656
  v_mfma_f32_16x16x32_bf16 v[144:147], v[40:43], v[48:51], v[144:147]
  ds_read_b64_tr_b16 v[26:27], v4 offset:34912
  v_mfma_f32_16x16x32_bf16 v[176:179], v[40:43], v[52:55], v[176:179]
  v_mfma_f32_16x16x32_bf16 v[208:211], v[40:43], v[56:59], v[208:211]
  s_waitcnt vmcnt(0) lgkmcnt(2)
  v_mfma_f32_16x16x16_bf16 v[84:87], v[228:229], v[212:213], v[84:87]
  v_mfma_f32_16x16x16_bf16 v[116:119], v[228:229], v[214:215], v[116:119]
  v_mfma_f32_16x16x16_bf16 v[148:151], v[228:229], v[216:217], v[148:151]
  v_mfma_f32_16x16x16_bf16 v[180:183], v[228:229], v[218:219], v[180:183]
  v_mfma_f32_16x16x16_bf16 v[88:91], v[230:231], v[212:213], v[88:91]
  v_mfma_f32_16x16x16_bf16 v[120:123], v[230:231], v[214:215], v[120:123]
  v_mfma_f32_16x16x16_bf16 v[152:155], v[230:231], v[216:217], v[152:155]
  v_mfma_f32_16x16x16_bf16 v[184:187], v[230:231], v[218:219], v[184:187]
  v_mfma_f32_16x16x16_bf16 v[92:95], v[232:233], v[212:213], v[92:95]
  v_mfma_f32_16x16x16_bf16 v[124:127], v[232:233], v[214:215], v[124:127]
  v_mfma_f32_16x16x16_bf16 v[156:159], v[232:233], v[216:217], v[156:159]
  v_mfma_f32_16x16x16_bf16 v[188:191], v[232:233], v[218:219], v[188:191]
  v_mfma_f32_16x16x16_bf16 v[96:99], v[234:235], v[212:213], v[96:99]
  v_mfma_f32_16x16x16_bf16 v[128:131], v[234:235], v[214:215], v[128:131]
  v_mfma_f32_16x16x16_bf16 v[160:163], v[234:235], v[216:217], v[160:163]
  v_mfma_f32_16x16x16_bf16 v[192:195], v[234:235], v[218:219], v[192:195]
  v_mfma_f32_16x16x16_bf16 v[100:103], v[228:229], v[236:237], v[100:103]
  v_mfma_f32_16x16x16_bf16 v[132:135], v[228:229], v[238:239], v[132:135]
  v_mfma_f32_16x16x16_bf16 v[164:167], v[228:229], v[240:241], v[164:167]
  v_mfma_f32_16x16x16_bf16 v[196:199], v[228:229], v[242:243], v[196:199]
  v_mfma_f32_16x16x16_bf16 v[104:107], v[230:231], v[236:237], v[104:107]
  v_mfma_f32_16x16x16_bf16 v[136:139], v[230:231], v[238:239], v[136:139]
  v_mfma_f32_16x16x16_bf16 v[168:171], v[230:231], v[240:241], v[168:171]
  v_mfma_f32_16x16x16_bf16 v[200:203], v[230:231], v[242:243], v[200:203]
  v_mfma_f32_16x16x16_bf16 v[108:111], v[232:233], v[236:237], v[108:111]
  v_mfma_f32_16x16x16_bf16 v[140:143], v[232:233], v[238:239], v[140:143]
  v_mfma_f32_16x16x16_bf16 v[172:175], v[232:233], v[240:241], v[172:175]
  v_mfma_f32_16x16x16_bf16 v[204:207], v[232:233], v[242:243], v[204:207]
  v_mfma_f32_16x16x16_bf16 v[112:115], v[234:235], v[236:237], v[112:115]
  v_mfma_f32_16x16x16_bf16 v[144:147], v[234:235], v[238:239], v[144:147]
  v_mfma_f32_16x16x16_bf16 v[176:179], v[234:235], v[240:241], v[176:179]
  v_mfma_f32_16x16x16_bf16 v[208:211], v[234:235], v[242:243], v[208:211]
  s_waitcnt lgkmcnt(6)
  v_mfma_f32_16x16x32_bf16 v[84:87], v[12:15], v[60:63], v[84:87]
  ds_read_b64_tr_b16 v[28:29], v4 offset:25920
  v_mfma_f32_16x16x32_bf16 v[116:119], v[12:15], v[64:67], v[116:119]
  ds_read_b64_tr_b16 v[30:31], v4 offset:26176
  v_mfma_f32_16x16x32_bf16 v[148:151], v[12:15], v[68:71], v[148:151]
  v_mfma_f32_16x16x32_bf16 v[180:183], v[12:15], v[72:75], v[180:183]
  s_waitcnt lgkmcnt(6)
  v_mfma_f32_16x16x32_bf16 v[88:91], v[16:19], v[60:63], v[88:91]
  ds_read_b64_tr_b16 v[32:33], v4 offset:25952
  v_mfma_f32_16x16x32_bf16 v[120:123], v[16:19], v[64:67], v[120:123]
  ds_read_b64_tr_b16 v[34:35], v4 offset:26208
  v_mfma_f32_16x16x32_bf16 v[152:155], v[16:19], v[68:71], v[152:155]
  v_mfma_f32_16x16x32_bf16 v[184:187], v[16:19], v[72:75], v[184:187]
  s_waitcnt lgkmcnt(6)
  v_mfma_f32_16x16x32_bf16 v[92:95], v[20:23], v[60:63], v[92:95]
  ds_read_b64_tr_b16 v[36:37], v4 offset:34688
  ds_read_b64_tr_b16 v[38:39], v4 offset:34944
  v_mfma_f32_16x16x32_bf16 v[124:127], v[20:23], v[64:67], v[124:127]
  s_add_u32 s43, s43, 51712
  s_cmp_eq_u32 s43, 155136
  v_mfma_f32_16x16x32_bf16 v[156:159], v[20:23], v[68:71], v[156:159]
  s_cselect_b32 s43, 0, s43
  v_mfma_f32_16x16x32_bf16 v[188:191], v[20:23], v[72:75], v[188:191]
  s_waitcnt lgkmcnt(6)
  v_mfma_f32_16x16x32_bf16 v[96:99], v[24:27], v[60:63], v[96:99]
  ds_read_b64_tr_b16 v[40:41], v4 offset:34720
  v_mfma_f32_16x16x32_bf16 v[128:131], v[24:27], v[64:67], v[128:131]
  ds_read_b64_tr_b16 v[42:43], v4 offset:34976
  v_mfma_f32_16x16x32_bf16 v[160:163], v[24:27], v[68:71], v[160:163]
  v_add_u32 v4, s43, v5
  v_mfma_f32_16x16x32_bf16 v[192:195], v[24:27], v[72:75], v[192:195]
  v_add_u32 v7, s43, v8
  s_barrier
  s_waitcnt lgkmcnt(6)
  v_mfma_f32_16x16x32_bf16 v[100:103], v[28:31], v[60:63], v[100:103]
  ds_read_b128 v[44:47], v7 offset:0
  ds_read_b128 v[48:51], v7 offset:256
  v_mfma_f32_16x16x32_bf16 v[132:135], v[28:31], v[64:67], v[132:135]
  ds_read_b128 v[52:55], v7 offset:2048
  ds_read_b128 v[56:59], v7 offset:2304
  v_mfma_f32_16x16x32_bf16 v[164:167], v[28:31], v[68:71], v[164:167]
  ds_read_b64_tr_b16 v[12:13], v4 offset:0
  ds_read_b64_tr_b16 v[14:15], v4 offset:256
  v_mfma_f32_16x16x32_bf16 v[196:199], v[28:31], v[72:75], v[196:199]
  s_waitcnt lgkmcnt(10)
  v_mfma_f32_16x16x32_bf16 v[104:107], v[32:35], v[60:63], v[104:107]
  ds_read_b64_tr_b16 v[16:17], v4 offset:32
  v_mfma_f32_16x16x32_bf16 v[136:139], v[32:35], v[64:67], v[136:139]
  ds_read_b64_tr_b16 v[18:19], v4 offset:288
  v_mfma_f32_16x16x32_bf16 v[168:171], v[32:35], v[68:71], v[168:171]
  v_mfma_f32_16x16x32_bf16 v[200:203], v[32:35], v[72:75], v[200:203]
  s_waitcnt lgkmcnt(10)
  v_mfma_f32_16x16x32_bf16 v[108:111], v[36:39], v[60:63], v[108:111]
  ds_read_b64_tr_b16 v[20:21], v4 offset:8768
  v_mfma_f32_16x16x32_bf16 v[140:143], v[36:39], v[64:67], v[140:143]
  ds_read_b64_tr_b16 v[22:23], v4 offset:9024
  v_mfma_f32_16x16x32_bf16 v[172:175], v[36:39], v[68:71], v[172:175]
  v_mfma_f32_16x16x32_bf16 v[204:207], v[36:39], v[72:75], v[204:207]
  s_waitcnt lgkmcnt(10)
  v_mfma_f32_16x16x32_bf16 v[112:115], v[40:43], v[60:63], v[112:115]
  ds_read_b64_tr_b16 v[24:25], v4 offset:8800
  v_mfma_f32_16x16x32_bf16 v[144:147], v[40:43], v[64:67], v[144:147]
  ds_read_b64_tr_b16 v[26:27], v4 offset:9056
  v_mfma_f32_16x16x32_bf16 v[176:179], v[40:43], v[68:71], v[176:179]
  v_mfma_f32_16x16x32_bf16 v[208:211], v[40:43], v[72:75], v[208:211]
P5_LOOP2:
  s_waitcnt lgkmcnt(6)
  v_mfma_f32_16x16x32_bf16 v[84:87], v[12:15], v[44:47], v[84:87]
  ds_read_b64_tr_b16 v[28:29], v4 offset:64
  v_mfma_f32_16x16x32_bf16 v[116:119], v[12:15], v[48:51], v[116:119]
  ds_read_b64_tr_b16 v[30:31], v4 offset:320
  v_mfma_f32_16x16x32_bf16 v[148:151], v[12:15], v[52:55], v[148:151]
  v_mfma_f32_16x16x32_bf16 v[180:183], v[12:15], v[56:59], v[180:183]
  s_waitcnt lgkmcnt(6)
  v_mfma_f32_16x16x32_bf16 v[88:91], v[16:19], v[44:47], v[88:91]
  ds_read_b64_tr_b16 v[32:33], v4 offset:96
  v_mfma_f32_16x16x32_bf16 v[120:123], v[16:19], v[48:51], v[120:123]
  ds_read_b64_tr_b16 v[34:35], v4 offset:352
  v_mfma_f32_16x16x32_bf16 v[152:155], v[16:19], v[52:55], v[152:155]
  v_mfma_f32_16x16x32_bf16 v[184:187], v[16:19], v[56:59], v[184:187]
  s_waitcnt lgkmcnt(6)
  v_mfma_f32_16x16x32_bf16 v[92:95], v[20:23], v[44:47], v[92:95]
  ds_read_b64_tr_b16 v[36:37], v4 offset:8832
  v_mfma_f32_16x16x32_bf16 v[124:127], v[20:23], v[48:51], v[124:127]
  ds_read_b64_tr_b16 v[38:39], v4 offset:9088
  v_mfma_f32_16x16x32_bf16 v[156:159], v[20:23], v[52:55], v[156:159]
  v_mfma_f32_16x16x32_bf16 v[188:191], v[20:23], v[56:59], v[188:191]
  s_waitcnt lgkmcnt(6)
  v_mfma_f32_16x16x32_bf16 v[96:99], v[24:27], v[44:47], v[96:99]
  ds_read_b64_tr_b16 v[40:41], v4 offset:8864
  v_mfma_f32_16x16x32_bf16 v[128:131], v[24:27], v[48:51], v[128:131]
  ds_read_b64_tr_b16 v[42:43], v4 offset:9120
  v_mfma_f32_16x16x32_bf16 v[160:163], v[24:27], v[52:55], v[160:163]
  v_mfma_f32_16x16x32_bf16 v[192:195], v[24:27], v[56:59], v[192:195]
  s_barrier
  s_waitcnt lgkmcnt(6)
  v_mfma_f32_16x16x32_bf16 v[100:103], v[28:31], v[44:47], v[100:103]
  ds_read_b128 v[60:63], v7 offset:25856
  ds_read_b128 v[64:67], v7 offset:26112
  v_mfma_f32_16x16x32_bf16 v[132:135], v[28:31], v[48:51], v[132:135]
  ds_read_b128 v[68:71], v7 offset:27904
  ds_read_b128 v[72:75], v7 offset:28160
  v_mfma_f32_16x16x32_bf16 v[164:167], v[28:31], v[52:55], v[164:167]
  ds_read_b64_tr_b16 v[12:13], v4 offset:25856
  ds_read_b64_tr_b16 v[14:15], v4 offset:26112
  v_mfma_f32_16x16x32_bf16 v[196:199], v[28:31], v[56:59], v[196:199]
  s_waitcnt lgkmcnt(10)
  v_mfma_f32_16x16x32_bf16 v[104:107], v[32:35], v[44:47], v[104:107]
  ds_read_b64_tr_b16 v[16:17], v4 offset:25888
  v_mfma_f32_16x16x32_bf16 v[136:139], v[32:35], v[48:51], v[136:139]
  ds_read_b64_tr_b16 v[18:19], v4 offset:26144
  v_mfma_f32_16x16x32_bf16 v[168:171], v[32:35], v[52:55], v[168:171]
  v_mfma_f32_16x16x32_bf16 v[200:203], v[32:35], v[56:59], v[200:203]
  s_waitcnt lgkmcnt(10)
  v_mfma_f32_16x16x32_bf16 v[108:111], v[36:39], v[44:47], v[108:111]
  ds_read_b64_tr_b16 v[20:21], v4 offset:34624
  v_mfma_f32_16x16x32_bf16 v[140:143], v[36:39], v[48:51], v[140:143]
  ds_read_b64_tr_b16 v[22:23], v4 offset:34880
  v_mfma_f32_16x16x32_bf16 v[172:175], v[36:39], v[52:55], v[172:175]
  v_mfma_f32_16x16x32_bf16 v[204:207], v[36:39], v[56:59], v[204:207]
  s_waitcnt lgkmcnt(10)
  v_mfma_f32_16x16x32_bf16 v[112:115], v[40:43], v[44:47], v[112:115]
  ds_read_b64_tr_b16 v[24:25], v4 offset:34656
  v_mfma_f32_16x16x32_bf16 v[144:147], v[40:43], v[48:51], v[144:147]
  ds_read_b64_tr_b16 v[26:27], v4 offset:34912
  v_mfma_f32_16x16x32_bf16 v[176:179], v[40:43], v[52:55], v[176:179]
  v_mfma_f32_16x16x32_bf16 v[208:211], v[40:43], v[56:59], v[208:211]
  s_waitcnt lgkmcnt(6)
  v_mfma_f32_16x16x32_bf16 v[84:87], v[12:15], v[60:63], v[84:87]
  ds_read_b64_tr_b16 v[28:29], v4 offset:25920
  v_mfma_f32_16x16x32_bf16 v[116:119], v[12:15], v[64:67], v[116:119]
  ds_read_b64_tr_b16 v[30:31], v4 offset:26176
  v_mfma_f32_16x16x32_bf16 v[148:151], v[12:15], v[68:71], v[148:151]
  v_mfma_f32_16x16x32_bf16 v[180:183], v[12:15], v[72:75], v[180:183]
  s_waitcnt lgkmcnt(6)
  v_mfma_f32_16x16x32_bf16 v[88:91], v[16:19], v[60:63], v[88:91]
  ds_read_b64_tr_b16 v[32:33], v4 offset:25952
  v_mfma_f32_16x16x32_bf16 v[120:123], v[16:19], v[64:67], v[120:123]
  ds_read_b64_tr_b16 v[34:35], v4 offset:26208
  v_mfma_f32_16x16x32_bf16 v[152:155], v[16:19], v[68:71], v[152:155]
  v_mfma_f32_16x16x32_bf16 v[184:187], v[16:19], v[72:75], v[184:187]
  s_waitcnt lgkmcnt(6)
  v_mfma_f32_16x16x32_bf16 v[92:95], v[20:23], v[60:63], v[92:95]
  ds_read_b64_tr_b16 v[36:37], v4 offset:34688
  ds_read_b64_tr_b16 v[38:39], v4 offset:34944
  v_mfma_f32_16x16x32_bf16 v[124:127], v[20:23], v[64:67], v[124:127]
  s_add_u32 s43, s43, 51712
  s_cmp_eq_u32 s43, 155136
  v_mfma_f32_16x16x32_bf16 v[156:159], v[20:23], v[68:71], v[156:159]
  s_cselect_b32 s43, 0, s43
  v_mfma_f32_16x16x32_bf16 v[188:191], v[20:23], v[72:75], v[188:191]
  s_waitcnt lgkmcnt(6)
  v_mfma_f32_16x16x32_bf16 v[96:99], v[24:27], v[60:63], v[96:99]
  ds_read_b64_tr_b16 v[40:41], v4 offset:34720
  v_mfma_f32_16x16x32_bf16 v[128:131], v[24:27], v[64:67], v[128:131]
  ds_read_b64_tr_b16 v[42:43], v4 offset:34976
  v_mfma_f32_16x16x32_bf16 v[160:163], v[24:27], v[68:71], v[160:163]
  v_add_u32 v4, s43, v5
  v_mfma_f32_16x16x32_bf16 v[192:195], v[24:27], v[72:75], v[192:195]
  v_add_u32 v7, s43, v8
  s_barrier
  s_waitcnt lgkmcnt(6)
  v_mfma_f32_16x16x32_bf16 v[100:103], v[28:31], v[60:63], v[100:103]
  ds_read_b128 v[44:47], v7 offset:0
  ds_read_b128 v[48:51], v7 offset:256
  v_mfma_f32_16x16x32_bf16 v[132:135], v[28:31], v[64:67], v[132:135]
  ds_read_b128 v[52:55], v7 offset:2048
  ds_read_b128 v[56:59], v7 offset:2304
  v_mfma_f32_16x16x32_bf16 v[164:167], v[28:31], v[68:71], v[164:167]
  ds_read_b64_tr_b16 v[12:13], v4 offset:0
  ds_read_b64_tr_b16 v[14:15], v4 offset:256
  v_mfma_f32_16x16x32_bf16 v[196:199], v[28:31], v[72:75], v[196:199]
  s_waitcnt lgkmcnt(10)
  v_mfma_f32_16x16x32_bf16 v[104:107], v[32:35], v[60:63], v[104:107]
  ds_read_b64_tr_b16 v[16:17], v4 offset:32
  v_mfma_f32_16x16x32_bf16 v[136:139], v[32:35], v[64:67], v[136:139]
  ds_read_b64_tr_b16 v[18:19], v4 offset:288
  v_mfma_f32_16x16x32_bf16 v[168:171], v[32:35], v[68:71], v[168:171]
  v_mfma_f32_16x16x32_bf16 v[200:203], v[32:35], v[72:75], v[200:203]
  s_waitcnt lgkmcnt(10)
  v_mfma_f32_16x16x32_bf16 v[108:111], v[36:39], v[60:63], v[108:111]
  ds_read_b64_tr_b16 v[20:21], v4 offset:8768
  v_mfma_f32_16x16x32_bf16 v[140:143], v[36:39], v[64:67], v[140:143]
  ds_read_b64_tr_b16 v[22:23], v4 offset:9024
  v_mfma_f32_16x16x32_bf16 v[172:175], v[36:39], v[68:71], v[172:175]
  s_add_u32 s42, s42, 1
  v_mfma_f32_16x16x32_bf16 v[204:207], v[36:39], v[72:75], v[204:207]
  s_cmp_lt_u32 s42, 5
  s_waitcnt lgkmcnt(10)
  v_mfma_f32_16x16x32_bf16 v[112:115], v[40:43], v[60:63], v[112:115]
  ds_read_b64_tr_b16 v[24:25], v4 offset:8800
  v_mfma_f32_16x16x32_bf16 v[144:147], v[40:43], v[64:67], v[144:147]
  ds_read_b64_tr_b16 v[26:27], v4 offset:9056
  v_mfma_f32_16x16x32_bf16 v[176:179], v[40:43], v[68:71], v[176:179]
  v_mfma_f32_16x16x32_bf16 v[208:211], v[40:43], v[72:75], v[208:211]
  s_cbranch_scc1 P5_LOOP2
  s_waitcnt lgkmcnt(6)
  v_mfma_f32_16x16x32_bf16 v[84:87], v[12:15], v[44:47], v[84:87]
  ds_read_b64_tr_b16 v[28:29], v4 offset:64
  v_mfma_f32_16x16x32_bf16 v[116:119], v[12:15], v[48:51], v[116:119]
  ds_read_b64_tr_b16 v[30:31], v4 offset:320
  v_mfma_f32_16x16x32_bf16 v[148:151], v[12:15], v[52:55], v[148:151]
  v_mfma_f32_16x16x32_bf16 v[180:183], v[12:15], v[56:59], v[180:183]
  s_waitcnt lgkmcnt(6)
  v_mfma_f32_16x16x32_bf16 v[88:91], v[16:19], v[44:47], v[88:91]
  ds_read_b64_tr_b16 v[32:33], v4 offset:96
  v_mfma_f32_16x16x32_bf16 v[120:123], v[16:19], v[48:51], v[120:123]
  ds_read_b64_tr_b16 v[34:35], v4 offset:352
  s_branch SK_P6
ST_P6:
  s_branch ST_P7
SK_P6:
  v_mfma_f32_16x16x32_bf16 v[152:155], v[16:19], v[52:55], v[152:155]
  v_mfma_f32_16x16x32_bf16 v[184:187], v[16:19], v[56:59], v[184:187]
  s_waitcnt lgkmcnt(6)
  v_mfma_f32_16x16x32_bf16 v[92:95], v[20:23], v[44:47], v[92:95]
  ds_read_b64_tr_b16 v[36:37], v4 offset:8832
  v_mfma_f32_16x16x32_bf16 v[124:127], v[20:23], v[48:51], v[124:127]
  ds_read_b64_tr_b16 v[38:39], v4 offset:9088
  v_mfma_f32_16x16x32_bf16 v[156:159], v[20:23], v[52:55], v[156:159]
  v_mfma_f32_16x16x32_bf16 v[188:191], v[20:23], v[56:59], v[188:191]
  s_waitcnt lgkmcnt(6)
  v_mfma_f32_16x16x32_bf16 v[96:99], v[24:27], v[44:47], v[96:99]
  ds_read_b64_tr_b16 v[40:41], v4 offset:8864
  v_mfma_f32_16x16x32_bf16 v[128:131], v[24:27], v[48:51], v[128:131]
  ds_read_b64_tr_b16 v[42:43], v4 offset:9120
  v_mfma_f32_16x16x32_bf16 v[160:163], v[24:27], v[52:55], v[160:163]
  v_mfma_f32_16x16x32_bf16 v[192:195], v[24:27], v[56:59], v[192:195]
  s_barrier
  s_waitcnt lgkmcnt(6)
  v_mfma_f32_16x16x32_bf16 v[100:103], v[28:31], v[44:47], v[100:103]
  ds_read_b128 v[60:63], v7 offset:25856
  ds_read_b128 v[64:67], v7 offset:26112
  v_mfma_f32_16x16x32_bf16 v[132:135], v[28:31], v[48:51], v[132:135]
  ds_read_b128 v[68:71], v7 offset:27904
  ds_read_b128 v[72:75], v7 offset:28160
  v_mfma_f32_16x16x32_bf16 v[164:167], v[28:31], v[52:55], v[164:167]
  ds_read_b64_tr_b16 v[12:13], v4 offset:25856
  ds_read_b64_tr_b16 v[14:15], v4 offset:26112
  v_mfma_f32_16x16x32_bf16 v[196:199], v[28:31], v[56:59], v[196:199]
  ds_read_b64_tr_b16 v[228:229], v4 offset:25920
  ds_read_b64_tr_b16 v[230:231], v4 offset:26176
  s_waitcnt lgkmcnt(12)
  v_mfma_f32_16x16x32_bf16 v[104:107], v[32:35], v[44:47], v[104:107]
  ds_read_b64_tr_b16 v[16:17], v4 offset:25888
  v_mfma_f32_16x16x32_bf16 v[136:139], v[32:35], v[48:51], v[136:139]
  ds_read_b64_tr_b16 v[18:19], v4 offset:26144
  v_mfma_f32_16x16x32_bf16 v[168:171], v[32:35], v[52:55], v[168:171]
  ds_read_b64_tr_b16 v[232:233], v4 offset:25952
  v_mfma_f32_16x16x32_bf16 v[200:203], v[32:35], v[56:59], v[200:203]
  ds_read_b64_tr_b16 v[234:235], v4 offset:26208
  s_waitcnt lgkmcnt(14)
  v_mfma_f32_16x16x32_bf16 v[108:111], v[36:39], v[44:47], v[108:111]
  ds_read_b64_tr_b16 v[20:21], v4 offset:34624
  v_mfma_f32_16x16x32_bf16 v[140:143], v[36:39], v[48:51], v[140:143]
  ds_read_b64_tr_b16 v[22:23], v4 offset:34880
  v_mfma_f32_16x16x32_bf16 v[172:175], v[36:39], v[52:55], v[172:175]
  ds_read_b64_tr_b16 v[236:237], v4 offset:34688
  v_mfma_f32_16x16x32_bf16 v[204:207], v[36:39], v[56:59], v[204:207]
  ds_read_b64_tr_b16 v[238:239], v4 offset:34944
  s_waitcnt lgkmcnt(14)
  v_mfma_f32_16x16x32_bf16 v[112:115], v[40:43], v[44:47], v[112:115]
  ds_read_b64_tr_b16 v[24:25], v4 offset:34656
  v_mfma_f32_16x16x32_bf16 v[144:147], v[40:43], v[48:51], v[144:147]
  ds_read_b64_tr_b16 v[26:27], v4 offset:34912
  v_mfma_f32_16x16x32_bf16 v[176:179], v[40:43], v[52:55], v[176:179]
  ds_read_b64_tr_b16 v[240:241], v4 offset:34720
  v_mfma_f32_16x16x32_bf16 v[208:211], v[40:43], v[56:59], v[208:211]
  ds_read_b64_tr_b16 v[242:243], v4 offset:34976
  s_waitcnt lgkmcnt(0)
  s_barrier
  v_mfma_f32_16x16x32_bf16 v[84:87], v[12:15], v[60:63], v[84:87]
  v_mfma_f32_16x16x32_bf16 v[88:91], v[16:19], v[60:63], v[88:91]
  v_mfma_f32_16x16x32_bf16 v[92:95], v[20:23], v[60:63], v[92:95]
  v_mfma_f32_16x16x32_bf16 v[96:99], v[24:27], v[60:63], v[96:99]
  v_mfma_f32_16x16x32_bf16 v[100:103], v[228:231], v[60:63], v[100:103]
  v_mfma_f32_16x16x32_bf16 v[104:107], v[232:235], v[60:63], v[104:107]
  v_mfma_f32_16x16x32_bf16 v[108:111], v[236:239], v[60:63], v[108:111]
  v_mfma_f32_16x16x32_bf16 v[112:115], v[240:243], v[60:63], v[112:115]
  s_nop 0
  v_pk_mul_f32 v[44:45], v[84:85], v[220:221] op_sel:[0,0] op_sel_hi:[1,0]
  v_pk_mul_f32 v[46:47], v[86:87], v[220:221] op_sel:[0,0] op_sel_hi:[1,0]
  v_pk_mul_f32 v[48:49], v[88:89], v[220:221] op_sel:[0,0] op_sel_hi:[1,0]
  v_pk_mul_f32 v[50:51], v[90:91], v[220:221] op_sel:[0,0] op_sel_hi:[1,0]
  v_exp_f32 v44, v44
  v_exp_f32 v45, v45
  v_mfma_f32_16x16x32_bf16 v[116:119], v[12:15], v[64:67], v[116:119]
  v_exp_f32 v46, v46
  v_exp_f32 v47, v47
  v_exp_f32 v48, v48
  v_exp_f32 v49, v49
  v_exp_f32 v50, v50
  v_mfma_f32_16x16x32_bf16 v[120:123], v[16:19], v[64:67], v[120:123]
  v_exp_f32 v51, v51
  v_pk_mul_f32 v[84:85], v[84:85], v[92:93]
  v_pk_mul_f32 v[86:87], v[86:87], v[94:95]
  v_pk_mul_f32 v[88:89], v[88:89], v[96:97]
  v_pk_mul_f32 v[90:91], v[90:91], v[98:99]
  v_pk_fma_f32 v[44:45], v[220:221], v[44:45], v[220:221] op_sel:[1,0,1] op_sel_hi:[1,1,1]
  v_mfma_f32_16x16x32_bf16 v[124:127], v[20:23], v[64:67], v[124:127]
  v_pk_fma_f32 v[46:47], v[220:221], v[46:47], v[220:221] op_sel:[1,0,1] op_sel_hi:[1,1,1]
  v_pk_fma_f32 v[48:49], v[220:221], v[48:49], v[220:221] op_sel:[1,0,1] op_sel_hi:[1,1,1]
  v_pk_fma_f32 v[50:51], v[220:221], v[50:51], v[220:221] op_sel:[1,0,1] op_sel_hi:[1,1,1]
  v_rcp_f32 v44, v44
  v_rcp_f32 v45, v45
  v_rcp_f32 v46, v46
  v_mfma_f32_16x16x32_bf16 v[128:131], v[24:27], v[64:67], v[128:131]
  v_rcp_f32 v47, v47
  v_rcp_f32 v48, v48
  v_rcp_f32 v49, v49
  v_rcp_f32 v50, v50
  v_rcp_f32 v51, v51
  v_pk_mul_f32 v[84:85], v[84:85], v[44:45]
  v_pk_mul_f32 v[86:87], v[86:87], v[46:47]
  v_pk_mul_f32 v[88:89], v[88:89], v[48:49]
  v_pk_mul_f32 v[90:91], v[90:91], v[50:51]
  v_cvt_pk_bf16_f32 v92, v84, v85
  v_cvt_pk_bf16_f32 v93, v86, v87
  v_cvt_pk_bf16_f32 v94, v88, v89
  v_cvt_pk_bf16_f32 v95, v90, v91
  buffer_store_dwordx4 v[92:95], v3, s[24:27], s38 offen offset:0 sc0 sc1
  v_pk_mul_f32 v[52:53], v[100:101], v[220:221] op_sel:[0,0] op_sel_hi:[1,0]
  v_pk_mul_f32 v[54:55], v[102:103], v[220:221] op_sel:[0,0] op_sel_hi:[1,0]
  v_pk_mul_f32 v[56:57], v[104:105], v[220:221] op_sel:[0,0] op_sel_hi:[1,0]
  v_pk_mul_f32 v[58:59], v[106:107], v[220:221] op_sel:[0,0] op_sel_hi:[1,0]
  v_exp_f32 v52, v52
  v_exp_f32 v53, v53
  v_mfma_f32_16x16x32_bf16 v[132:135], v[228:231], v[64:67], v[132:135]
  v_exp_f32 v54, v54
  v_exp_f32 v55, v55
  v_exp_f32 v56, v56
  v_exp_f32 v57, v57
  v_exp_f32 v58, v58
  v_mfma_f32_16x16x32_bf16 v[136:139], v[232:235], v[64:67], v[136:139]
  v_exp_f32 v59, v59
  v_pk_mul_f32 v[100:101], v[100:101], v[108:109]
  v_pk_mul_f32 v[102:103], v[102:103], v[110:111]
  v_pk_mul_f32 v[104:105], v[104:105], v[112:113]
  v_pk_mul_f32 v[106:107], v[106:107], v[114:115]
  v_pk_fma_f32 v[52:53], v[220:221], v[52:53], v[220:221] op_sel:[1,0,1] op_sel_hi:[1,1,1]
  v_mfma_f32_16x16x32_bf16 v[140:143], v[236:239], v[64:67], v[140:143]
  v_pk_fma_f32 v[54:55], v[220:221], v[54:55], v[220:221] op_sel:[1,0,1] op_sel_hi:[1,1,1]
  v_pk_fma_f32 v[56:57], v[220:221], v[56:57], v[220:221] op_sel:[1,0,1] op_sel_hi:[1,1,1]
  v_pk_fma_f32 v[58:59], v[220:221], v[58:59], v[220:221] op_sel:[1,0,1] op_sel_hi:[1,1,1]
  v_rcp_f32 v52, v52
  v_rcp_f32 v53, v53
  v_rcp_f32 v54, v54
  v_mfma_f32_16x16x32_bf16 v[144:147], v[240:243], v[64:67], v[144:147]
  v_rcp_f32 v55, v55
  v_rcp_f32 v56, v56
  v_rcp_f32 v57, v57
  v_rcp_f32 v58, v58
  v_rcp_f32 v59, v59
  v_pk_mul_f32 v[100:101], v[100:101], v[52:53]
  v_pk_mul_f32 v[102:103], v[102:103], v[54:55]
  v_pk_mul_f32 v[104:105], v[104:105], v[56:57]
  v_pk_mul_f32 v[106:107], v[106:107], v[58:59]
  v_cvt_pk_bf16_f32 v108, v100, v101
  v_cvt_pk_bf16_f32 v109, v102, v103
  v_cvt_pk_bf16_f32 v110, v104, v105
  v_cvt_pk_bf16_f32 v111, v106, v107
  buffer_store_dwordx4 v[108:111], v3, s[24:27], s38 offen offset:2048 sc0 sc1
  v_pk_mul_f32 v[44:45], v[116:117], v[222:223] op_sel:[0,0] op_sel_hi:[1,0]
  v_pk_mul_f32 v[46:47], v[118:119], v[222:223] op_sel:[0,0] op_sel_hi:[1,0]
  v_pk_mul_f32 v[48:49], v[120:121], v[222:223] op_sel:[0,0] op_sel_hi:[1,0]
  v_pk_mul_f32 v[50:51], v[122:123], v[222:223] op_sel:[0,0] op_sel_hi:[1,0]
  v_exp_f32 v44, v44
  v_exp_f32 v45, v45
  v_mfma_f32_16x16x32_bf16 v[148:151], v[12:15], v[68:71], v[148:151]
  v_exp_f32 v46, v46
  v_exp_f32 v47, v47
  v_exp_f32 v48, v48
  v_exp_f32 v49, v49
  v_exp_f32 v50, v50
  v_mfma_f32_16x16x32_bf16 v[152:155], v[16:19], v[68:71], v[152:155]
  v_exp_f32 v51, v51
  v_pk_mul_f32 v[116:117], v[116:117], v[124:125]
  v_pk_mul_f32 v[118:119], v[118:119], v[126:127]
  v_pk_mul_f32 v[120:121], v[120:121], v[128:129]
  v_pk_mul_f32 v[122:123], v[122:123], v[130:131]
  v_pk_fma_f32 v[44:45], v[222:223], v[44:45], v[222:223] op_sel:[1,0,1] op_sel_hi:[1,1,1]
  v_mfma_f32_16x16x32_bf16 v[156:159], v[20:23], v[68:71], v[156:159]
  v_pk_fma_f32 v[46:47], v[222:223], v[46:47], v[222:223] op_sel:[1,0,1] op_sel_hi:[1,1,1]
  v_pk_fma_f32 v[48:49], v[222:223], v[48:49], v[222:223] op_sel:[1,0,1] op_sel_hi:[1,1,1]
  v_pk_fma_f32 v[50:51], v[222:223], v[50:51], v[222:223] op_sel:[1,0,1] op_sel_hi:[1,1,1]
  v_rcp_f32 v44, v44
  v_rcp_f32 v45, v45
  v_rcp_f32 v46, v46
  v_mfma_f32_16x16x32_bf16 v[160:163], v[24:27], v[68:71], v[160:163]
  v_rcp_f32 v47, v47
  v_rcp_f32 v48, v48
  v_rcp_f32 v49, v49
  v_rcp_f32 v50, v50
  v_rcp_f32 v51, v51
  v_pk_mul_f32 v[116:117], v[116:117], v[44:45]
  v_pk_mul_f32 v[118:119], v[118:119], v[46:47]
  v_pk_mul_f32 v[120:121], v[120:121], v[48:49]
  v_pk_mul_f32 v[122:123], v[122:123], v[50:51]
  v_cvt_pk_bf16_f32 v124, v116, v117
  v_cvt_pk_bf16_f32 v125, v118, v119
  v_cvt_pk_bf16_f32 v126, v120, v121
  v_cvt_pk_bf16_f32 v127, v122, v123
  buffer_store_dwordx4 v[124:127], v3, s[24:27], s38 offen offset:256 sc0 sc1
  v_pk_mul_f32 v[52:53], v[132:133], v[222:223] op_sel:[0,0] op_sel_hi:[1,0]
  v_pk_mul_f32 v[54:55], v[134:135], v[222:223] op_sel:[0,0] op_sel_hi:[1,0]
  v_pk_mul_f32 v[56:57], v[136:137], v[222:223] op_sel:[0,0] op_sel_hi:[1,0]
  v_pk_mul_f32 v[58:59], v[138:139], v[222:223] op_sel:[0,0] op_sel_hi:[1,0]
  v_exp_f32 v52, v52
  v_exp_f32 v53, v53
  v_mfma_f32_16x16x32_bf16 v[164:167], v[228:231], v[68:71], v[164:167]
  v_exp_f32 v54, v54
  v_exp_f32 v55, v55
  v_exp_f32 v56, v56
  v_exp_f32 v57, v57
  v_exp_f32 v58, v58
  v_mfma_f32_16x16x32_bf16 v[168:171], v[232:235], v[68:71], v[168:171]
  v_exp_f32 v59, v59
  v_pk_mul_f32 v[132:133], v[132:133], v[140:141]
  v_pk_mul_f32 v[134:135], v[134:135], v[142:143]
  v_pk_mul_f32 v[136:137], v[136:137], v[144:145]
  v_pk_mul_f32 v[138:139], v[138:139], v[146:147]
  v_pk_fma_f32 v[52:53], v[222:223], v[52:53], v[222:223] op_sel:[1,0,1] op_sel_hi:[1,1,1]
  v_mfma_f32_16x16x32_bf16 v[172:175], v[236:239], v[68:71], v[172:175]
  v_pk_fma_f32 v[54:55], v[222:223], v[54:55], v[222:223] op_sel:[1,0,1] op_sel_hi:[1,1,1]
  v_pk_fma_f32 v[56:57], v[222:223], v[56:57], v[222:223] op_sel:[1,0,1] op_sel_hi:[1,1,1]
  v_pk_fma_f32 v[58:59], v[222:223], v[58:59], v[222:223] op_sel:[1,0,1] op_sel_hi:[1,1,1]
  v_rcp_f32 v52, v52
  v_rcp_f32 v53, v53
  v_rcp_f32 v54, v54
  v_mfma_f32_16x16x32_bf16 v[176:179], v[240:243], v[68:71], v[176:179]
  v_rcp_f32 v55, v55
  v_rcp_f32 v56, v56
  v_rcp_f32 v57, v57
  v_rcp_f32 v58, v58
  v_rcp_f32 v59, v59
  v_pk_mul_f32 v[132:133], v[132:133], v[52:53]
  v_pk_mul_f32 v[134:135], v[134:135], v[54:55]
  v_pk_mul_f32 v[136:137], v[136:137], v[56:57]
  v_pk_mul_f32 v[138:139], v[138:139], v[58:59]
  v_cvt_pk_bf16_f32 v140, v132, v133
  v_cvt_pk_bf16_f32 v141, v134, v135
  v_cvt_pk_bf16_f32 v142, v136, v137
  v_cvt_pk_bf16_f32 v143, v138, v139
  buffer_store_dwordx4 v[140:143], v3, s[24:27], s38 offen offset:2304 sc0 sc1
  v_pk_mul_f32 v[44:45], v[148:149], v[224:225] op_sel:[0,0] op_sel_hi:[1,0]
  v_pk_mul_f32 v[46:47], v[150:151], v[224:225] op_sel:[0,0] op_sel_hi:[1,0]
  v_pk_mul_f32 v[48:49], v[152:153], v[224:225] op_sel:[0,0] op_sel_hi:[1,0]
  v_pk_mul_f32 v[50:51], v[154:155], v[224:225] op_sel:[0,0] op_sel_hi:[1,0]
  v_exp_f32 v44, v44
  v_exp_f32 v45, v45
  v_mfma_f32_16x16x32_bf16 v[180:183], v[12:15], v[72:75], v[180:183]
  v_exp_f32 v46, v46
  v_exp_f32 v47, v47
  v_exp_f32 v48, v48
  v_exp_f32 v49, v49
  v_exp_f32 v50, v50
  v_mfma_f32_16x16x32_bf16 v[184:187], v[16:19], v[72:75], v[184:187]
  v_exp_f32 v51, v51
  v_pk_mul_f32 v[148:149], v[148:149], v[156:157]
  v_pk_mul_f32 v[150:151], v[150:151], v[158:159]
  v_pk_mul_f32 v[152:153], v[152:153], v[160:161]
  v_pk_mul_f32 v[154:155], v[154:155], v[162:163]
  v_pk_fma_f32 v[44:45], v[224:225], v[44:45], v[224:225] op_sel:[1,0,1] op_sel_hi:[1,1,1]
  v_mfma_f32_16x16x32_bf16 v[188:191], v[20:23], v[72:75], v[188:191]
  v_pk_fma_f32 v[46:47], v[224:225], v[46:47], v[224:225] op_sel:[1,0,1] op_sel_hi:[1,1,1]
  v_pk_fma_f32 v[48:49], v[224:225], v[48:49], v[224:225] op_sel:[1,0,1] op_sel_hi:[1,1,1]
  v_pk_fma_f32 v[50:51], v[224:225], v[50:51], v[224:225] op_sel:[1,0,1] op_sel_hi:[1,1,1]
  v_rcp_f32 v44, v44
  v_rcp_f32 v45, v45
  v_rcp_f32 v46, v46
  v_mfma_f32_16x16x32_bf16 v[192:195], v[24:27], v[72:75], v[192:195]
  v_rcp_f32 v47, v47
  v_rcp_f32 v48, v48
  v_rcp_f32 v49, v49
  v_rcp_f32 v50, v50
  v_rcp_f32 v51, v51
  v_pk_mul_f32 v[148:149], v[148:149], v[44:45]
  v_pk_mul_f32 v[150:151], v[150:151], v[46:47]
  v_pk_mul_f32 v[152:153], v[152:153], v[48:49]
  v_pk_mul_f32 v[154:155], v[154:155], v[50:51]
  v_cvt_pk_bf16_f32 v156, v148, v149
  v_cvt_pk_bf16_f32 v157, v150, v151
  v_cvt_pk_bf16_f32 v158, v152, v153
  v_cvt_pk_bf16_f32 v159, v154, v155
  buffer_store_dwordx4 v[156:159], v3, s[24:27], s39 offen offset:0 sc0 sc1
  v_pk_mul_f32 v[52:53], v[164:165], v[224:225] op_sel:[0,0] op_sel_hi:[1,0]
  v_pk_mul_f32 v[54:55], v[166:167], v[224:225] op_sel:[0,0] op_sel_hi:[1,0]
  v_pk_mul_f32 v[56:57], v[168:169], v[224:225] op_sel:[0,0] op_sel_hi:[1,0]
  v_pk_mul_f32 v[58:59], v[170:171], v[224:225] op_sel:[0,0] op_sel_hi:[1,0]
  v_exp_f32 v52, v52
  v_exp_f32 v53, v53
  v_mfma_f32_16x16x32_bf16 v[196:199], v[228:231], v[72:75], v[196:199]
  v_exp_f32 v54, v54
  v_exp_f32 v55, v55
  v_exp_f32 v56, v56
  v_exp_f32 v57, v57
  v_exp_f32 v58, v58
  v_mfma_f32_16x16x32_bf16 v[200:203], v[232:235], v[72:75], v[200:203]
  v_exp_f32 v59, v59
  v_pk_mul_f32 v[164:165], v[164:165], v[172:173]
  v_pk_mul_f32 v[166:167], v[166:167], v[174:175]
  v_pk_mul_f32 v[168:169], v[168:169], v[176:177]
  v_pk_mul_f32 v[170:171], v[170:171], v[178:179]
  v_pk_fma_f32 v[52:53], v[224:225], v[52:53], v[224:225] op_sel:[1,0,1] op_sel_hi:[1,1,1]
  v_mfma_f32_16x16x32_bf16 v[204:207], v[236:239], v[72:75], v[204:207]
  v_pk_fma_f32 v[54:55], v[224:225], v[54:55], v[224:225] op_sel:[1,0,1] op_sel_hi:[1,1,1]
  v_pk_fma_f32 v[56:57], v[224:225], v[56:57], v[224:225] op_sel:[1,0,1] op_sel_hi:[1,1,1]
  v_pk_fma_f32 v[58:59], v[224:225], v[58:59], v[224:225] op_sel:[1,0,1] op_sel_hi:[1,1,1]
  v_rcp_f32 v52, v52
  v_rcp_f32 v53, v53
  v_rcp_f32 v54, v54
  v_mfma_f32_16x16x32_bf16 v[208:211], v[240:243], v[72:75], v[208:211]
  v_rcp_f32 v55, v55
  v_rcp_f32 v56, v56
  v_rcp_f32 v57, v57
  v_rcp_f32 v58, v58
  v_rcp_f32 v59, v59
  v_pk_mul_f32 v[164:165], v[164:165], v[52:53]
  v_pk_mul_f32 v[166:167], v[166:167], v[54:55]
  v_pk_mul_f32 v[168:169], v[168:169], v[56:57]
  v_pk_mul_f32 v[170:171], v[170:171], v[58:59]
  v_cvt_pk_bf16_f32 v172, v164, v165
  v_cvt_pk_bf16_f32 v173, v166, v167
  v_cvt_pk_bf16_f32 v174, v168, v169
  v_cvt_pk_bf16_f32 v175, v170, v171
  buffer_store_dwordx4 v[172:175], v3, s[24:27], s39 offen offset:2048 sc0 sc1
  v_pk_mul_f32 v[44:45], v[180:181], v[226:227] op_sel:[0,0] op_sel_hi:[1,0]
  v_pk_mul_f32 v[46:47], v[182:183], v[226:227] op_sel:[0,0] op_sel_hi:[1,0]
  v_pk_mul_f32 v[48:49], v[184:185], v[226:227] op_sel:[0,0] op_sel_hi:[1,0]
  v_pk_mul_f32 v[50:51], v[186:187], v[226:227] op_sel:[0,0] op_sel_hi:[1,0]
  v_exp_f32 v44, v44
  v_exp_f32 v45, v45
  v_exp_f32 v46, v46
  v_exp_f32 v47, v47
  v_exp_f32 v48, v48
  v_exp_f32 v49, v49
  v_exp_f32 v50, v50
  v_exp_f32 v51, v51
  v_pk_mul_f32 v[180:181], v[180:181], v[188:189]
  v_pk_mul_f32 v[182:183], v[182:183], v[190:191]
  v_pk_mul_f32 v[184:185], v[184:185], v[192:193]
  v_pk_mul_f32 v[186:187], v[186:187], v[194:195]
  v_pk_fma_f32 v[44:45], v[226:227], v[44:45], v[226:227] op_sel:[1,0,1] op_sel_hi:[1,1,1]
  v_pk_fma_f32 v[46:47], v[226:227], v[46:47], v[226:227] op_sel:[1,0,1] op_sel_hi:[1,1,1]
  v_pk_fma_f32 v[48:49], v[226:227], v[48:49], v[226:227] op_sel:[1,0,1] op_sel_hi:[1,1,1]
  v_pk_fma_f32 v[50:51], v[226:227], v[50:51], v[226:227] op_sel:[1,0,1] op_sel_hi:[1,1,1]
  v_rcp_f32 v44, v44
  v_rcp_f32 v45, v45
  v_rcp_f32 v46, v46
  v_rcp_f32 v47, v47
  v_rcp_f32 v48, v48
  v_rcp_f32 v49, v49
  v_rcp_f32 v50, v50
  v_rcp_f32 v51, v51
  v_pk_mul_f32 v[180:181], v[180:181], v[44:45]
  v_pk_mul_f32 v[182:183], v[182:183], v[46:47]
  v_pk_mul_f32 v[184:185], v[184:185], v[48:49]
  v_pk_mul_f32 v[186:187], v[186:187], v[50:51]
  v_cvt_pk_bf16_f32 v188, v180, v181
  v_cvt_pk_bf16_f32 v189, v182, v183
  v_cvt_pk_bf16_f32 v190, v184, v185
  v_cvt_pk_bf16_f32 v191, v186, v187
  buffer_store_dwordx4 v[188:191], v3, s[24:27], s39 offen offset:256 sc0 sc1
  s_waitcnt vmcnt(3)
  s_mov_b64 exec, 1
  v_mov_b32 v10, s101
  v_mov_b32 v11, s4
  v_lshlrev_b32 v11, 2, v11
  s_cmp_eq_u32 s44, 1
  s_cbranch_scc0 SIGS_p5a
  buffer_store_dword v10, v11, s[24:27], s45 offen offset:1024
SIGD_p5a:
  s_mov_b64 exec, -1
  s_add_u32 s4, s4, 32
  v_pk_mul_f32 v[52:53], v[196:197], v[226:227] op_sel:[0,0] op_sel_hi:[1,0]
  v_pk_mul_f32 v[54:55], v[198:199], v[226:227] op_sel:[0,0] op_sel_hi:[1,0]
  v_pk_mul_f32 v[56:57], v[200:201], v[226:227] op_sel:[0,0] op_sel_hi:[1,0]
  v_pk_mul_f32 v[58:59], v[202:203], v[226:227] op_sel:[0,0] op_sel_hi:[1,0]
  v_exp_f32 v52, v52
  v_exp_f32 v53, v53
  v_exp_f32 v54, v54
  v_exp_f32 v55, v55
  v_exp_f32 v56, v56
  v_exp_f32 v57, v57
  v_exp_f32 v58, v58
  v_exp_f32 v59, v59
  v_pk_mul_f32 v[196:197], v[196:197], v[204:205]
  v_pk_mul_f32 v[198:199], v[198:199], v[206:207]
  v_pk_mul_f32 v[200:201], v[200:201], v[208:209]
  v_pk_mul_f32 v[202:203], v[202:203], v[210:211]
  v_pk_fma_f32 v[52:53], v[226:227], v[52:53], v[226:227] op_sel:[1,0,1] op_sel_hi:[1,1,1]
  v_pk_fma_f32 v[54:55], v[226:227], v[54:55], v[226:227] op_sel:[1,0,1] op_sel_hi:[1,1,1]
  v_pk_fma_f32 v[56:57], v[226:227], v[56:57], v[226:227] op_sel:[1,0,1] op_sel_hi:[1,1,1]
  v_pk_fma_f32 v[58:59], v[226:227], v[58:59], v[226:227] op_sel:[1,0,1] op_sel_hi:[1,1,1]
  v_rcp_f32 v52, v52
  v_rcp_f32 v53, v53
  v_rcp_f32 v54, v54
  v_rcp_f32 v55, v55
  v_rcp_f32 v56, v56
  v_rcp_f32 v57, v57
  v_rcp_f32 v58, v58
  v_rcp_f32 v59, v59
  v_pk_mul_f32 v[196:197], v[196:197], v[52:53]
  v_pk_mul_f32 v[198:199], v[198:199], v[54:55]
  v_pk_mul_f32 v[200:201], v[200:201], v[56:57]
  v_pk_mul_f32 v[202:203], v[202:203], v[58:59]
  v_cvt_pk_bf16_f32 v204, v196, v197
  v_cvt_pk_bf16_f32 v205, v198, v199
  v_cvt_pk_bf16_f32 v206, v200, v201
  v_cvt_pk_bf16_f32 v207, v202, v203
  buffer_store_dwordx4 v[204:207], v3, s[24:27], s39 offen offset:2304 sc0 sc1
  s_setprio 0
  v_lshrrev_b32 v3, 3, v1
  v_and_b32 v10, 7, v1
  v_bfe_u32 v11, v1, 4, 1
  v_lshlrev_b32 v11, 2, v11
  v_xor_b32 v10, v10, v11
  v_lshlrev_b32 v3, 10, v3
  v_lshl_add_u32 v4, v10, 4, v3
  v_add_u32 v5, 15360, v4
  s_mul_i32 s35, s34, 458752
  s_lshl_b32 s29, s33, 7
  s_add_u32 s35, s35, s29
  s_mul_i32 s36, s34, 40960
  v_bfe_u32 v3, v1, 2, 2
  v_lshrrev_b32 v10, 5, v1
  v_lshl_add_u32 v3, v10, 2, v3
  v_lshlrev_b32 v3, 7, v3
  v_and_b32 v10, 1, v1
  v_lshl_add_u32 v3, v10, 4, v3
  v_bfe_u32 v10, v1, 1, 1
  v_lshl_add_u32 v3, v10, 3, v3
  v_bfe_u32 v10, v1, 4, 1
  v_lshl_add_u32 v3, v10, 5, v3
  v_bfe_u32 v10, v1, 3, 1
  v_lshl_add_u32 v3, v10, 6, v3
  s_lshl_b32 s29, s34, 5
  s_and_b32 s29, s29, 64
  v_xor_b32 v3, s29, v3
  v_add_u32 v6, s36, v3
  v_xor_b32 v3, 64, v3
  v_add_u32 v7, s36, v3
  s_and_b32 s29, s34, 1
  s_mul_i32 s29, s29, 114688
  v_add_u32 v8, s29, v2
  s_sub_u32 s29, 114688, s29
  v_add_u32 v9, s29, v2
  s_mul_i32 s37, s32, 229376
  s_mul_i32 s29, s34, 28672
  s_add_u32 s37, s37, s29
  s_add_u32 s37, s37, 0xd00000
  s_waitcnt vmcnt(0)
  s_mov_b64 exec, 1
  v_mov_b32 v240, s101
  v_mov_b32 v241, s4
  v_lshlrev_b32 v241, 2, v241
  s_cmp_eq_u32 s44, 1
  s_cbranch_scc0 SIGS_p5
  buffer_store_dword v240, v241, s[24:27], s45 offen offset:1024
SIGD_p5:
  s_mov_b64 exec, -1
  s_branch LO_P6A
LO_P6:
  v_lshrrev_b32 v3, 3, v1
  v_and_b32 v10, 7, v1
  v_bfe_u32 v11, v1, 4, 1
  v_lshlrev_b32 v11, 2, v11
  v_xor_b32 v10, v10, v11
  v_lshlrev_b32 v3, 10, v3
  v_lshl_add_u32 v4, v10, 4, v3
  v_add_u32 v5, 15360, v4
  s_mul_i32 s35, s34, 458752
  s_lshl_b32 s29, s33, 7
  s_add_u32 s35, s35, s29
  s_mul_i32 s36, s34, 40960
  v_bfe_u32 v3, v1, 2, 2
  v_lshrrev_b32 v10, 5, v1
  v_lshl_add_u32 v3, v10, 2, v3
  v_lshlrev_b32 v3, 7, v3
  v_and_b32 v10, 1, v1
  v_lshl_add_u32 v3, v10, 4, v3
  v_bfe_u32 v10, v1, 1, 1
  v_lshl_add_u32 v3, v10, 3, v3
  v_bfe_u32 v10, v1, 4, 1
  v_lshl_add_u32 v3, v10, 5, v3
  v_bfe_u32 v10, v1, 3, 1
  v_lshl_add_u32 v3, v10, 6, v3
  s_lshl_b32 s29, s34, 5
  s_and_b32 s29, s29, 64
  v_xor_b32 v3, s29, v3
  v_add_u32 v6, s36, v3
  v_xor_b32 v3, 64, v3
  v_add_u32 v7, s36, v3
  s_and_b32 s29, s34, 1
  s_mul_i32 s29, s29, 114688
  v_add_u32 v8, s29, v2
  s_sub_u32 s29, 114688, s29
  v_add_u32 v9, s29, v2
  s_mul_i32 s37, s32, 229376
  s_mul_i32 s29, s34, 28672
  s_add_u32 s37, s37, s29
  s_add_u32 s37, s37, 0xd00000
LO_P6A:
  s_barrier
  s_and_b32 s29, s34, 1
  s_lshl_b32 s40, s32, 1
  s_add_u32 s40, s40, s29
  s_lshr_b32 s29, s34, 1
  s_lshl_b32 s41, s33, 1
  s_add_u32 s41, s41, s29
  s_lshl_b32 s42, s40, 15
  s_lshl_b32 s29, s41, 6
  s_add_u32 s42, s42, s29
  v_lshrrev_b32 v10, 5, v1
  v_lshlrev_b32 v11, 5, v10
  s_lshl_b32 s29, s41, 7
  s_add_u32 s29, s29, 10240
  buffer_load_dwordx4 v[216:219], v11, s[24:27], s29 offen offset:0 sc1
  buffer_load_dwordx4 v[220:223], v11, s[24:27], s29 offen offset:16 sc1
  buffer_load_dwordx4 v[224:227], v11, s[24:27], s29 offen offset:64 sc1
  buffer_load_dwordx4 v[228:231], v11, s[24:27], s29 offen offset:80 sc1
  v_and_b32 v11, 31, v1
  v_lshlrev_b32 v11, 10, v11
  v_lshl_add_u32 v10, v10, 4, v11
  s_and_b32 s9, s34, 1
  s_mul_i32 s9, s9, 4096
  s_sub_u32 s8, 4096, s9
  s_add_u32 s8, s8, s37
  s_add_u32 s9, s9, s37
  s_mul_i32 s46, s34, 7
  s_and_b32 s47, s34, 1
  s_xor_b32 s47, s47, 1
  s_add_u32 s46, s46, s47
  s_lshl_b32 s29, 0x15, s46
  s_lshr_b32 s6, s28, 3
  s_lshl_b32 s6, s6, 6
  v_add_lshl_u32 v241, v1, s6, 2
  s_mov_b32 s46, s29
  s_mov_b32 s47, s29
  s_mov_b64 exec, s[46:47]
  s_mov_b32 s46, 400000
POLL_p6:
  buffer_load_dword v240, v241, s[24:27], s45 offen offset:1024 sc1
  s_waitcnt vmcnt(0)
  v_cmp_ne_u32 vcc, s101, v240
  s_cbranch_vccz POLLD_p6
  s_sub_u32 s46, s46, 1
  s_cmp_lg_u32 s46, 0
  s_cbranch_scc1 POLL_p6
POLLD_p6:
  s_mov_b64 exec, -1
  s_cmp_eq_u32 s44, 1
  s_cbranch_scc0 POLLS_p6
POLLF_p6:
  s_add_u32 s39, s8, 0
  buffer_load_dwordx4 v[44:47], v8, s[24:27], s39 offen sc1
  buffer_load_dwordx4 v[48:51], v9, s[24:27], s39 offen sc1
  s_add_u32 s39, s8, 1024
  buffer_load_dwordx4 v[52:55], v8, s[24:27], s39 offen sc1
  buffer_load_dwordx4 v[56:59], v9, s[24:27], s39 offen sc1
  s_add_u32 s39, s8, 2048
  buffer_load_dwordx4 v[60:63], v8, s[24:27], s39 offen sc1
  buffer_load_dwordx4 v[64:67], v9, s[24:27], s39 offen sc1
  s_add_u32 s39, s8, 3072
  buffer_load_dwordx4 v[68:71], v8, s[24:27], s39 offen sc1
  buffer_load_dwordx4 v[72:75], v9, s[24:27], s39 offen sc1
  ds_read_b64_tr_b16 v[12:13], v6 offset:0
  ds_read_b64_tr_b16 v[14:15], v6 offset:1024
  ds_read_b64_tr_b16 v[16:17], v7 offset:0
  ds_read_b64_tr_b16 v[18:19], v7 offset:1024
  ds_read_b64_tr_b16 v[20:21], v6 offset:2048
  ds_read_b64_tr_b16 v[22:23], v6 offset:3072
  ds_read_b64_tr_b16 v[24:25], v7 offset:2048
  ds_read_b64_tr_b16 v[26:27], v7 offset:3072
  v_add_u32 v3, s36, v2
  s_waitcnt vmcnt(6) lgkmcnt(4)
  v_mfma_f32_32x32x16_bf16 v[88:103], v[12:15], v[44:47], 0
  ds_read_b64_tr_b16 v[28:29], v6 offset:4096
  ds_read_b64_tr_b16 v[30:31], v6 offset:5120
  v_mfma_f32_32x32x16_bf16 v[104:119], v[12:15], v[48:51], 0
  ds_read_b64_tr_b16 v[32:33], v7 offset:4096
  ds_read_b64_tr_b16 v[34:35], v7 offset:5120
  v_mfma_f32_32x32x16_bf16 v[120:135], v[16:19], v[44:47], 0
  s_add_u32 s39, s8, 8192
  buffer_load_dwordx4 v[76:79], v8, s[24:27], s39 offen sc1
  buffer_load_dwordx4 v[80:83], v9, s[24:27], s39 offen sc1
  v_mfma_f32_32x32x16_bf16 v[136:151], v[16:19], v[48:51], 0
  s_waitcnt vmcnt(6) lgkmcnt(4)
  v_mfma_f32_32x32x16_bf16 v[88:103], v[20:23], v[52:55], v[88:103]
  ds_read_b64_tr_b16 v[36:37], v6 offset:6144
  ds_read_b64_tr_b16 v[38:39], v6 offset:7168
  v_mfma_f32_32x32x16_bf16 v[104:119], v[20:23], v[56:59], v[104:119]
  ds_read_b64_tr_b16 v[40:41], v7 offset:6144
  ds_read_b64_tr_b16 v[42:43], v7 offset:7168
  v_mfma_f32_32x32x16_bf16 v[120:135], v[24:27], v[52:55], v[120:135]
  s_add_u32 s39, s8, 9216
  buffer_load_dwordx4 v[152:155], v8, s[24:27], s39 offen sc1
  buffer_load_dwordx4 v[156:159], v9, s[24:27], s39 offen sc1
  v_mfma_f32_32x32x16_bf16 v[136:151], v[24:27], v[56:59], v[136:151]
  s_waitcnt vmcnt(6) lgkmcnt(4)
  v_mfma_f32_32x32x16_bf16 v[88:103], v[28:31], v[60:63], v[88:103]
  ds_read_b64_tr_b16 v[12:13], v6 offset:8192
  ds_read_b64_tr_b16 v[14:15], v6 offset:9216
  v_mfma_f32_32x32x16_bf16 v[104:119], v[28:31], v[64:67], v[104:119]
  ds_read_b64_tr_b16 v[16:17], v7 offset:8192
  ds_read_b64_tr_b16 v[18:19], v7 offset:9216
  v_mfma_f32_32x32x16_bf16 v[120:135], v[32:35], v[60:63], v[120:135]
  s_add_u32 s39, s8, 10240
  buffer_load_dwordx4 v[160:163], v8, s[24:27], s39 offen sc1
  buffer_load_dwordx4 v[164:167], v9, s[24:27], s39 offen sc1
  v_mfma_f32_32x32x16_bf16 v[136:151], v[32:35], v[64:67], v[136:151]
  s_waitcnt vmcnt(6) lgkmcnt(4)
  v_mfma_f32_32x32x16_bf16 v[88:103], v[36:39], v[68:71], v[88:103]
  ds_read_b64_tr_b16 v[20:21], v6 offset:10240
  ds_read_b64_tr_b16 v[22:23], v6 offset:11264
  v_mfma_f32_32x32x16_bf16 v[104:119], v[36:39], v[72:75], v[104:119]
  ds_read_b64_tr_b16 v[24:25], v7 offset:10240
  ds_read_b64_tr_b16 v[26:27], v7 offset:11264
  v_mfma_f32_32x32x16_bf16 v[120:135], v[40:43], v[68:71], v[120:135]
  s_add_u32 s39, s8, 11264
  buffer_load_dwordx4 v[168:171], v8, s[24:27], s39 offen sc1
  buffer_load_dwordx4 v[172:175], v9, s[24:27], s39 offen sc1
  v_mfma_f32_32x32x16_bf16 v[136:151], v[40:43], v[72:75], v[136:151]
  s_waitcnt vmcnt(6) lgkmcnt(4)
  v_mfma_f32_32x32x16_bf16 v[88:103], v[12:15], v[76:79], v[88:103]
  ds_read_b64_tr_b16 v[28:29], v6 offset:12288
  ds_read_b64_tr_b16 v[30:31], v6 offset:13312
  v_mfma_f32_32x32x16_bf16 v[104:119], v[12:15], v[80:83], v[104:119]
  ds_read_b64_tr_b16 v[32:33], v7 offset:12288
  ds_read_b64_tr_b16 v[34:35], v7 offset:13312
  v_mfma_f32_32x32x16_bf16 v[120:135], v[16:19], v[76:79], v[120:135]
  s_add_u32 s39, s8, 16384
  buffer_load_dwordx4 v[176:179], v8, s[24:27], s39 offen sc1
  buffer_load_dwordx4 v[180:183], v9, s[24:27], s39 offen sc1
  v_mfma_f32_32x32x16_bf16 v[136:151], v[16:19], v[80:83], v[136:151]
  s_waitcnt vmcnt(6) lgkmcnt(4)
  v_mfma_f32_32x32x16_bf16 v[88:103], v[20:23], v[152:155], v[88:103]
  ds_read_b64_tr_b16 v[36:37], v6 offset:14336
  ds_read_b64_tr_b16 v[38:39], v6 offset:15360
  v_mfma_f32_32x32x16_bf16 v[104:119], v[20:23], v[156:159], v[104:119]
  ds_read_b64_tr_b16 v[40:41], v7 offset:14336
  ds_read_b64_tr_b16 v[42:43], v7 offset:15360
  v_mfma_f32_32x32x16_bf16 v[120:135], v[24:27], v[152:155], v[120:135]
  s_add_u32 s39, s8, 17408
  buffer_load_dwordx4 v[184:187], v8, s[24:27], s39 offen sc1
  buffer_load_dwordx4 v[188:191], v9, s[24:27], s39 offen sc1
  v_mfma_f32_32x32x16_bf16 v[136:151], v[24:27], v[156:159], v[136:151]
  s_waitcnt vmcnt(6) lgkmcnt(4)
  v_mfma_f32_32x32x16_bf16 v[88:103], v[28:31], v[160:163], v[88:103]
  ds_read_b64_tr_b16 v[12:13], v6 offset:16384
  ds_read_b64_tr_b16 v[14:15], v6 offset:17408
  s_branch SK_P7
ST_P7:
  s_branch ST_P8
SK_P7:
  v_mfma_f32_32x32x16_bf16 v[104:119], v[28:31], v[164:167], v[104:119]
  ds_read_b64_tr_b16 v[16:17], v7 offset:16384
  ds_read_b64_tr_b16 v[18:19], v7 offset:17408
  v_mfma_f32_32x32x16_bf16 v[120:135], v[32:35], v[160:163], v[120:135]
  s_add_u32 s39, s8, 18432
  buffer_load_dwordx4 v[44:47], v8, s[24:27], s39 offen sc1
  buffer_load_dwordx4 v[48:51], v9, s[24:27], s39 offen sc1
  v_mfma_f32_32x32x16_bf16 v[136:151], v[32:35], v[164:167], v[136:151]
  s_waitcnt vmcnt(6) lgkmcnt(4)
  v_mfma_f32_32x32x16_bf16 v[88:103], v[36:39], v[168:171], v[88:103]
  ds_read_b64_tr_b16 v[20:21], v6 offset:18432
  ds_read_b64_tr_b16 v[22:23], v6 offset:19456
  v_mfma_f32_32x32x16_bf16 v[104:119], v[36:39], v[172:175], v[104:119]
  ds_read_b64_tr_b16 v[24:25], v7 offset:18432
  ds_read_b64_tr_b16 v[26:27], v7 offset:19456
  v_mfma_f32_32x32x16_bf16 v[120:135], v[40:43], v[168:171], v[120:135]
  s_add_u32 s39, s8, 19456
  buffer_load_dwordx4 v[52:55], v8, s[24:27], s39 offen sc1
  buffer_load_dwordx4 v[56:59], v9, s[24:27], s39 offen sc1
  v_mfma_f32_32x32x16_bf16 v[136:151], v[40:43], v[172:175], v[136:151]
  s_waitcnt vmcnt(6) lgkmcnt(4)
  v_mfma_f32_32x32x16_bf16 v[88:103], v[12:15], v[176:179], v[88:103]
  ds_read_b64_tr_b16 v[28:29], v6 offset:20480
  ds_read_b64_tr_b16 v[30:31], v6 offset:21504
  v_mfma_f32_32x32x16_bf16 v[104:119], v[12:15], v[180:183], v[104:119]
  ds_read_b64_tr_b16 v[32:33], v7 offset:20480
  ds_read_b64_tr_b16 v[34:35], v7 offset:21504
  v_mfma_f32_32x32x16_bf16 v[120:135], v[16:19], v[176:179], v[120:135]
  v_mfma_f32_32x32x16_bf16 v[136:151], v[16:19], v[180:183], v[136:151]
  s_waitcnt vmcnt(4) lgkmcnt(4)
  v_mfma_f32_32x32x16_bf16 v[88:103], v[20:23], v[184:187], v[88:103]
  ds_read_b64_tr_b16 v[36:37], v6 offset:22528
  ds_read_b64_tr_b16 v[38:39], v6 offset:23552
  v_mfma_f32_32x32x16_bf16 v[104:119], v[20:23], v[188:191], v[104:119]
  ds_read_b64_tr_b16 v[40:41], v7 offset:22528
  ds_read_b64_tr_b16 v[42:43], v7 offset:23552
  v_mfma_f32_32x32x16_bf16 v[120:135], v[24:27], v[184:187], v[120:135]
  v_mfma_f32_32x32x16_bf16 v[136:151], v[24:27], v[188:191], v[136:151]
  s_waitcnt vmcnt(2) lgkmcnt(4)
  v_mfma_f32_32x32x16_bf16 v[104:119], v[28:31], v[48:51], v[104:119]
  s_waitcnt vmcnt(0) lgkmcnt(0)
  v_mfma_f32_32x32x16_bf16 v[104:119], v[36:39], v[56:59], v[104:119]
  v_mfma_f32_32x32x16_bf16 v[120:135], v[32:35], v[44:47], v[120:135]
  v_mfma_f32_32x32x16_bf16 v[120:135], v[40:43], v[52:55], v[120:135]
  s_nop 9
  ds_write_b128 v3, v[104:107] offset:4096
  ds_write_b128 v3, v[108:111] offset:5120
  v_mfma_f32_32x32x16_bf16 v[136:151], v[32:35], v[48:51], v[136:151]
  ds_write_b128 v3, v[112:115] offset:6144
  ds_write_b128 v3, v[116:119] offset:7168
  v_mfma_f32_32x32x16_bf16 v[136:151], v[40:43], v[56:59], v[136:151]
  ds_write_b128 v3, v[120:123] offset:8192
  ds_write_b128 v3, v[124:127] offset:9216
  v_mfma_f32_32x32x16_bf16 v[88:103], v[28:31], v[44:47], v[88:103]
  ds_write_b128 v3, v[128:131] offset:10240
  ds_write_b128 v3, v[132:135] offset:11264
  v_mfma_f32_32x32x16_bf16 v[88:103], v[36:39], v[52:55], v[88:103]
  s_nop 5
  ds_write_b128 v3, v[136:139] offset:12288
  ds_write_b128 v3, v[140:143] offset:13312
  ds_write_b128 v3, v[144:147] offset:14336
  ds_write_b128 v3, v[148:151] offset:15360
  s_xor_b32 s29, s34, 1
  s_mul_i32 s29, s29, 40960
  s_add_u32 s29, s29, 4096
  v_add_u32 v4, s29, v2
  s_xor_b32 s29, s34, 2
  s_mul_i32 s29, s29, 40960
  s_add_u32 s29, s29, 8192
  v_add_u32 v5, s29, v2
  s_xor_b32 s29, s34, 3
  s_mul_i32 s29, s29, 40960
  s_add_u32 s29, s29, 12288
  v_add_u32 v6, s29, v2
  v_lshlrev_b32 v200, 16, v248
  v_and_b32 v201, s31, v248
  v_lshlrev_b32 v202, 16, v249
  v_and_b32 v203, s31, v249
  v_lshlrev_b32 v204, 16, v250
  v_and_b32 v205, s31, v250
  v_lshlrev_b32 v206, 16, v251
  v_and_b32 v207, s31, v251
  v_lshlrev_b32 v208, 16, v252
  v_and_b32 v209, s31, v252
  v_lshlrev_b32 v210, 16, v253
  v_and_b32 v211, s31, v253
  v_lshlrev_b32 v212, 16, v254
  v_and_b32 v213, s31, v254
  v_lshlrev_b32 v214, 16, v255
  v_and_b32 v215, s31, v255
  s_waitcnt lgkmcnt(0)
  s_barrier
  ds_read_b128 v[104:107], v4 offset:0
  ds_read_b128 v[108:111], v4 offset:1024
  ds_read_b128 v[112:115], v4 offset:2048
  ds_read_b128 v[116:119], v4 offset:3072
  ds_read_b128 v[120:123], v5 offset:0
  ds_read_b128 v[124:127], v5 offset:1024
  ds_read_b128 v[128:131], v5 offset:2048
  ds_read_b128 v[132:135], v5 offset:3072
  ds_read_b128 v[136:139], v6 offset:0
  ds_read_b128 v[140:143], v6 offset:1024
  ds_read_b128 v[144:147], v6 offset:2048
  ds_read_b128 v[148:151], v6 offset:3072
  ds_read_b128 v[152:155], v3 offset:24576
  ds_read_b128 v[156:159], v3 offset:25600
  ds_read_b128 v[160:163], v3 offset:26624
  ds_read_b128 v[164:167], v3 offset:27648
  s_waitcnt lgkmcnt(12)
  v_pk_add_f32 v[88:89], v[88:89], v[104:105]
  v_pk_add_f32 v[90:91], v[90:91], v[106:107]
  v_pk_add_f32 v[92:93], v[92:93], v[108:109]
  v_pk_add_f32 v[94:95], v[94:95], v[110:111]
  v_pk_add_f32 v[96:97], v[96:97], v[112:113]
  v_pk_add_f32 v[98:99], v[98:99], v[114:115]
  v_pk_add_f32 v[100:101], v[100:101], v[116:117]
  v_pk_add_f32 v[102:103], v[102:103], v[118:119]
  ds_read_b128 v[168:171], v4 offset:24576
  ds_read_b128 v[172:175], v4 offset:25600
  ds_read_b128 v[176:179], v4 offset:26624
  ds_read_b128 v[180:183], v4 offset:27648
  ds_read_b128 v[184:187], v5 offset:24576
  ds_read_b128 v[188:191], v5 offset:25600
  ds_read_b128 v[192:195], v5 offset:26624
  ds_read_b128 v[196:199], v5 offset:27648
  s_waitcnt lgkmcnt(12)
  v_pk_add_f32 v[120:121], v[120:121], v[136:137]
  v_pk_add_f32 v[122:123], v[122:123], v[138:139]
  v_pk_add_f32 v[124:125], v[124:125], v[140:141]
  v_pk_add_f32 v[126:127], v[126:127], v[142:143]
  v_pk_add_f32 v[128:129], v[128:129], v[144:145]
  v_pk_add_f32 v[130:131], v[130:131], v[146:147]
  v_pk_add_f32 v[132:133], v[132:133], v[148:149]
  v_pk_add_f32 v[134:135], v[134:135], v[150:151]
  ds_read_b128 v[64:67], v6 offset:24576
  ds_read_b128 v[68:71], v6 offset:25600
  ds_read_b128 v[72:75], v6 offset:26624
  ds_read_b128 v[76:79], v6 offset:27648
  s_waitcnt lgkmcnt(8)
  v_pk_add_f32 v[152:153], v[152:153], v[168:169]
  v_pk_add_f32 v[154:155], v[154:155], v[170:171]
  v_pk_add_f32 v[156:157], v[156:157], v[172:173]
  v_pk_add_f32 v[158:159], v[158:159], v[174:175]
  v_pk_add_f32 v[160:161], v[160:161], v[176:177]
  v_pk_add_f32 v[162:163], v[162:163], v[178:179]
  v_pk_add_f32 v[164:165], v[164:165], v[180:181]
  v_pk_add_f32 v[166:167], v[166:167], v[182:183]
  v_pk_add_f32 v[88:89], v[88:89], v[120:121]
  v_pk_add_f32 v[90:91], v[90:91], v[122:123]
  v_pk_add_f32 v[92:93], v[92:93], v[124:125]
  v_pk_add_f32 v[94:95], v[94:95], v[126:127]
  v_pk_add_f32 v[96:97], v[96:97], v[128:129]
  v_pk_add_f32 v[98:99], v[98:99], v[130:131]
  v_pk_add_f32 v[100:101], v[100:101], v[132:133]
  v_pk_add_f32 v[102:103], v[102:103], v[134:135]
  s_waitcnt vmcnt(0) lgkmcnt(0)
  v_pk_add_f32 v[184:185], v[184:185], v[64:65]
  v_pk_add_f32 v[186:187], v[186:187], v[66:67]
  v_pk_add_f32 v[188:189], v[188:189], v[68:69]
  v_pk_add_f32 v[190:191], v[190:191], v[70:71]
  v_pk_add_f32 v[192:193], v[192:193], v[72:73]
  v_pk_add_f32 v[194:195], v[194:195], v[74:75]
  v_pk_add_f32 v[196:197], v[196:197], v[76:77]
  v_pk_add_f32 v[198:199], v[198:199], v[78:79]
  v_pk_add_f32 v[88:89], v[88:89], v[152:153]
  v_pk_add_f32 v[90:91], v[90:91], v[154:155]
  v_pk_add_f32 v[92:93], v[92:93], v[156:157]
  v_pk_add_f32 v[94:95], v[94:95], v[158:159]
  v_pk_add_f32 v[96:97], v[96:97], v[160:161]
  v_pk_add_f32 v[98:99], v[98:99], v[162:163]
  v_pk_add_f32 v[100:101], v[100:101], v[164:165]
  v_pk_add_f32 v[102:103], v[102:103], v[166:167]
  v_pk_add_f32 v[88:89], v[88:89], v[184:185]
  v_pk_add_f32 v[90:91], v[90:91], v[186:187]
  v_pk_add_f32 v[92:93], v[92:93], v[188:189]
  v_pk_add_f32 v[94:95], v[94:95], v[190:191]
  v_pk_add_f32 v[96:97], v[96:97], v[192:193]
  v_pk_add_f32 v[98:99], v[98:99], v[194:195]
  v_pk_add_f32 v[100:101], v[100:101], v[196:197]
  v_pk_add_f32 v[102:103], v[102:103], v[198:199]
  v_pk_fma_f32 v[200:201], v[88:89], v[216:217], v[200:201]
  v_pk_fma_f32 v[202:203], v[90:91], v[218:219], v[202:203]
  v_pk_fma_f32 v[204:205], v[92:93], v[220:221], v[204:205]
  v_pk_fma_f32 v[206:207], v[94:95], v[222:223], v[206:207]
  v_pk_fma_f32 v[208:209], v[96:97], v[224:225], v[208:209]
  v_pk_fma_f32 v[210:211], v[98:99], v[226:227], v[210:211]
  v_pk_fma_f32 v[212:213], v[100:101], v[228:229], v[212:213]
  v_pk_fma_f32 v[214:215], v[102:103], v[230:231], v[214:215]
  v_cvt_pk_bf16_f32 v64, v200, v201
  v_cvt_pk_bf16_f32 v65, v202, v203
  v_cvt_pk_bf16_f32 v66, v204, v205
  v_cvt_pk_bf16_f32 v67, v206, v207
  v_cvt_pk_bf16_f32 v68, v208, v209
  v_cvt_pk_bf16_f32 v69, v210, v211
  v_cvt_pk_bf16_f32 v70, v212, v213
  v_cvt_pk_bf16_f32 v71, v214, v215
  buffer_store_dwordx4 v[64:67], v10, s[20:23], s42 offen offset:0
  buffer_store_dwordx4 v[68:71], v10, s[20:23], s42 offen offset:32
KF_DUMP:
  s_endpgm
HI_P4:
  s_cmp_ge_u32 s28, 28
  s_cbranch_scc1 HI_IDLE
  s_cmp_ge_u32 s28, 14
  s_cselect_b32 s46, 1, 0
  s_mul_i32 s47, s46, 14
  s_sub_u32 s41, s28, s47
  s_lshl_b32 s40, s3, 1
  s_add_u32 s40, s40, s46
  s_lshl_b32 s40, s40, 2
  s_add_u32 s40, s40, s34
  v_lshrrev_b32 v8, 4, v1
  v_mul_u32_u24 v8, 14336, v8
  v_and_b32 v9, 15, v1
  v_lshl_add_u32 v8, v9, 4, v8
  v_add_u32 v12, 0, v8
  v_add_u32 v13, 2496, v8
  v_add_u32 v14, 4992, v8
  v_add_u32 v15, 7488, v8
  s_and_b32 s29, s34, 1
  s_mul_i32 s36, s29, 57344
  s_mul_i32 s37, s29, 4384
  s_lshl_b32 s29, s41, 8
  s_add_u32 s36, s36, s29
  s_lshr_b32 s29, s34, 1
  s_mul_i32 s29, s29, 8768
  s_add_u32 s37, s37, s29
  s_lshl_b32 s42, s34, 11
  s_add_u32 s42, s42, 17664
  s_lshl_b32 s43, s40, 15
  s_add_u32 s43, s43, 0x1400000
  s_cmp_ge_u32 s34, 2
  s_cselect_b32 s12, s56, s52
  s_cselect_b32 s13, s57, s53
  s_mov_b32 s14, 1835008
  s_mov_b32 s15, 0x20000
  v_lshrrev_b32 v3, 3, v1
  v_and_b32 v10, 7, v1
  v_bfe_u32 v11, v1, 4, 1
  v_lshlrev_b32 v11, 2, v11
  v_xor_b32 v10, v10, v11
  v_lshlrev_b32 v3, 10, v3
  v_lshl_add_u32 v4, v10, 4, v3
  v_add_u32 v5, 15360, v4
  s_mul_i32 s35, s34, 458752
  s_lshl_b32 s29, s33, 7
  s_add_u32 s35, s35, s29
  s_and_b32 s5, s34, 1
  s_mul_i32 s5, s5, 65536
  s_sub_u32 s4, 65536, s5
  s_add_u32 s4, s4, s35
  s_add_u32 s5, s5, s35
  s_barrier
  s_cmp_lg_u32 s7, 3
  s_cbranch_scc1 UVA_a
  buffer_atomic_add_f32 v152, v156, s[24:27], s10 offen
  buffer_atomic_add_f32 v154, v156, s[24:27], s11 offen
  s_mov_b64 exec, s[8:9]
  buffer_atomic_add_f32 v153, v156, s[24:27], s10 offen offset:256
  buffer_atomic_add_f32 v155, v156, s[24:27], s11 offen offset:256
  s_mov_b64 exec, -1
UVA_a:
  s_add_u32 s38, s36, 0
  s_add_u32 m0, s37, 103424
  s_nop 0
  buffer_load_dwordx4 v12, s[12:15], s38 offen offset:0 lds
  buffer_load_dwordx4 v13, s[12:15], s38 offen offset:1088 lds
  buffer_load_dwordx4 v14, s[12:15], s38 offen offset:2176 lds
  buffer_load_dwordx4 v15, s[12:15], s38 offen offset:3264 lds
  s_add_u32 s38, s36, 114688
  s_add_u32 m0, s37, 129280
  s_nop 0
  buffer_load_dwordx4 v12, s[12:15], s38 offen offset:0 lds
  buffer_load_dwordx4 v13, s[12:15], s38 offen offset:1088 lds
  buffer_load_dwordx4 v14, s[12:15], s38 offen offset:2176 lds
  buffer_load_dwordx4 v15, s[12:15], s38 offen offset:3264 lds
  s_barrier
  s_barrier
  s_waitcnt vmcnt(4)
  s_cmp_lg_u32 s7, 3
  s_cbranch_scc1 UVS_a
  s_mov_b64 exec, 1
  v_mov_b32 v48, s101
  v_mov_b32 v49, s28
  v_lshlrev_b32 v49, 2, v49
  s_cmp_eq_u32 s44, 1
  s_cbranch_scc0 SIGS_uva
  buffer_store_dword v48, v49, s[24:27], s45 offen offset:2432
SIGD_uva:
  s_mov_b64 exec, -1
UVS_a:
  s_add_u32 s38, s36, 229376
  s_add_u32 m0, s37, 0
  s_nop 0
  buffer_load_dwordx4 v12, s[12:15], s38 offen offset:0 lds
  buffer_load_dwordx4 v13, s[12:15], s38 offen offset:1088 lds
  buffer_load_dwordx4 v14, s[12:15], s38 offen offset:2176 lds
  buffer_load_dwordx4 v15, s[12:15], s38 offen offset:3264 lds
  s_barrier
  s_add_u32 s38, s36, 344064
  s_add_u32 m0, s37, 25856
  s_nop 0
  buffer_load_dwordx4 v12, s[12:15], s38 offen offset:0 lds
  buffer_load_dwordx4 v13, s[12:15], s38 offen offset:1088 lds
  buffer_load_dwordx4 v14, s[12:15], s38 offen offset:2176 lds
  buffer_load_dwordx4 v15, s[12:15], s38 offen offset:3264 lds
  s_add_u32 s38, s36, 458752
  s_add_u32 m0, s37, 51712
  s_nop 0
  buffer_load_dwordx4 v12, s[12:15], s38 offen offset:0 lds
  buffer_load_dwordx4 v13, s[12:15], s38 offen offset:1088 lds
  buffer_load_dwordx4 v14, s[12:15], s38 offen offset:2176 lds
  buffer_load_dwordx4 v15, s[12:15], s38 offen offset:3264 lds
  s_add_u32 s38, s36, 573440
  s_add_u32 m0, s37, 77568
  s_nop 0
  buffer_load_dwordx4 v12, s[12:15], s38 offen offset:0 lds
  buffer_load_dwordx4 v13, s[12:15], s38 offen offset:1088 lds
  buffer_load_dwordx4 v14, s[12:15], s38 offen offset:2176 lds
  buffer_load_dwordx4 v15, s[12:15], s38 offen offset:3264 lds
  s_waitcnt vmcnt(20)
  s_barrier
  s_cmp_eq_u32 s44, 1
  s_cbranch_scc0 HI_INV
HI_INVD:
  s_add_u32 s39, s43, 4096
  s_add_u32 m0, s42, 0
  s_nop 0
  buffer_load_dwordx4 v2, s[24:27], s39 offen sc1 lds
  buffer_load_dwordx4 v2, s[24:27], s39 offen offset:1024 sc1 lds
  s_add_u32 s39, s43, 6144
  s_add_u32 m0, s42, 25856
  s_nop 0
  buffer_load_dwordx4 v2, s[24:27], s39 offen sc1 lds
  buffer_load_dwordx4 v2, s[24:27], s39 offen offset:1024 sc1 lds
  s_add_u32 s39, s43, 8192
  s_add_u32 m0, s42, 51712
  s_nop 0
  buffer_load_dwordx4 v2, s[24:27], s39 offen sc1 lds
  buffer_load_dwordx4 v2, s[24:27], s39 offen offset:1024 sc1 lds
  s_add_u32 s39, s43, 10240
  s_add_u32 m0, s42, 77568
  s_nop 0
  buffer_load_dwordx4 v2, s[24:27], s39 offen sc1 lds
  buffer_load_dwordx4 v2, s[24:27], s39 offen offset:1024 sc1 lds
  s_waitcnt vmcnt(24)
  s_barrier
  s_waitcnt vmcnt(6)
  s_barrier
  s_add_u32 s39, s43, 12288
  s_add_u32 m0, s42, 103424
  s_nop 0
  buffer_load_dwordx4 v2, s[24:27], s39 offen sc1 lds
  buffer_load_dwordx4 v2, s[24:27], s39 offen offset:1024 sc1 lds
  s_add_u32 s38, s36, 688128
  s_add_u32 m0, s37, 103424
  s_nop 0
  buffer_load_dwordx4 v12, s[12:15], s38 offen offset:0 lds
  buffer_load_dwordx4 v13, s[12:15], s38 offen offset:1088 lds
  buffer_load_dwordx4 v14, s[12:15], s38 offen offset:2176 lds
  buffer_load_dwordx4 v15, s[12:15], s38 offen offset:3264 lds
  s_waitcnt vmcnt(10)
  s_barrier
  s_add_u32 s39, s43, 14336
  s_add_u32 m0, s42, 129280
  s_nop 0
  buffer_load_dwordx4 v2, s[24:27], s39 offen sc1 lds
  buffer_load_dwordx4 v2, s[24:27], s39 offen offset:1024 sc1 lds
  s_add_u32 s38, s36, 802816
  s_add_u32 m0, s37, 129280
  s_nop 0
  buffer_load_dwordx4 v12, s[12:15], s38 offen offset:0 lds
  buffer_load_dwordx4 v13, s[12:15], s38 offen offset:1088 lds
  buffer_load_dwordx4 v14, s[12:15], s38 offen offset:2176 lds
  buffer_load_dwordx4 v15, s[12:15], s38 offen offset:3264 lds
  s_waitcnt vmcnt(14)
  s_barrier
  s_add_u32 s39, s43, 16384
  s_add_u32 m0, s42, 0
  s_nop 0
  buffer_load_dwordx4 v2, s[24:27], s39 offen sc1 lds
  buffer_load_dwordx4 v2, s[24:27], s39 offen offset:1024 sc1 lds
  s_add_u32 s38, s36, 917504
  s_add_u32 m0, s37, 0
  s_nop 0
  buffer_load_dwordx4 v12, s[12:15], s38 offen offset:0 lds
  buffer_load_dwordx4 v13, s[12:15], s38 offen offset:1088 lds
  buffer_load_dwordx4 v14, s[12:15], s38 offen offset:2176 lds
  buffer_load_dwordx4 v15, s[12:15], s38 offen offset:3264 lds
  s_waitcnt vmcnt(18)
  s_barrier
  s_add_u32 s39, s43, 18432
  s_add_u32 m0, s42, 25856
  s_nop 0
  buffer_load_dwordx4 v2, s[24:27], s39 offen sc1 lds
  buffer_load_dwordx4 v2, s[24:27], s39 offen offset:1024 sc1 lds
  s_add_u32 s38, s36, 1032192
  s_add_u32 m0, s37, 25856
  s_nop 0
  buffer_load_dwordx4 v12, s[12:15], s38 offen offset:0 lds
  buffer_load_dwordx4 v13, s[12:15], s38 offen offset:1088 lds
  buffer_load_dwordx4 v14, s[12:15], s38 offen offset:2176 lds
  buffer_load_dwordx4 v15, s[12:15], s38 offen offset:3264 lds
  s_waitcnt vmcnt(18)
  s_barrier
  s_add_u32 s39, s43, 20480
  s_add_u32 m0, s42, 51712
  s_nop 0
  buffer_load_dwordx4 v2, s[24:27], s39 offen sc1 lds
  buffer_load_dwordx4 v2, s[24:27], s39 offen offset:1024 sc1 lds
  s_add_u32 s38, s36, 1146880
  s_add_u32 m0, s37, 51712
  s_nop 0
  buffer_load_dwordx4 v12, s[12:15], s38 offen offset:0 lds
  buffer_load_dwordx4 v13, s[12:15], s38 offen offset:1088 lds
  buffer_load_dwordx4 v14, s[12:15], s38 offen offset:2176 lds
  buffer_load_dwordx4 v15, s[12:15], s38 offen offset:3264 lds
  s_waitcnt vmcnt(18)
  s_barrier
  s_add_u32 s39, s43, 22528
  s_add_u32 m0, s42, 77568
  s_nop 0
  buffer_load_dwordx4 v2, s[24:27], s39 offen sc1 lds
  buffer_load_dwordx4 v2, s[24:27], s39 offen offset:1024 sc1 lds
  s_add_u32 s38, s36, 1261568
  s_add_u32 m0, s37, 77568
  s_nop 0
  buffer_load_dwordx4 v12, s[12:15], s38 offen offset:0 lds
  buffer_load_dwordx4 v13, s[12:15], s38 offen offset:1088 lds
  buffer_load_dwordx4 v14, s[12:15], s38 offen offset:2176 lds
  buffer_load_dwordx4 v15, s[12:15], s38 offen offset:3264 lds
  s_waitcnt vmcnt(18)
  s_barrier
  s_add_u32 s39, s43, 24576
  s_add_u32 m0, s42, 103424
  s_nop 0
  buffer_load_dwordx4 v2, s[24:27], s39 offen sc1 lds
  buffer_load_dwordx4 v2, s[24:27], s39 offen offset:1024 sc1 lds
  s_add_u32 s38, s36, 1376256
  s_add_u32 m0, s37, 103424
  s_nop 0
  buffer_load_dwordx4 v12, s[12:15], s38 offen offset:0 lds
  buffer_load_dwordx4 v13, s[12:15], s38 offen offset:1088 lds
  buffer_load_dwordx4 v14, s[12:15], s38 offen offset:2176 lds
  buffer_load_dwordx4 v15, s[12:15], s38 offen offset:3264 lds
  s_waitcnt vmcnt(18)
  s_barrier
  s_add_u32 s39, s43, 26624
  s_add_u32 m0, s42, 129280
  s_nop 0
  buffer_load_dwordx4 v2, s[24:27], s39 offen sc1 lds
  buffer_load_dwordx4 v2, s[24:27], s39 offen offset:1024 sc1 lds
  s_add_u32 s38, s36, 1490944
  s_add_u32 m0, s37, 129280
  s_nop 0
  buffer_load_dwordx4 v12, s[12:15], s38 offen offset:0 lds
  buffer_load_dwordx4 v13, s[12:15], s38 offen offset:1088 lds
  buffer_load_dwordx4 v14, s[12:15], s38 offen offset:2176 lds
  buffer_load_dwordx4 v15, s[12:15], s38 offen offset:3264 lds
  s_waitcnt vmcnt(18)
  s_barrier
  s_add_u32 s39, s43, 28672
  s_add_u32 m0, s42, 0
  s_nop 0
  buffer_load_dwordx4 v2, s[24:27], s39 offen sc1 lds
  buffer_load_dwordx4 v2, s[24:27], s39 offen offset:1024 sc1 lds
  s_add_u32 s38, s36, 1605632
  s_add_u32 m0, s37, 0
  s_nop 0
  buffer_load_dwordx4 v12, s[12:15], s38 offen offset:0 lds
  buffer_load_dwordx4 v13, s[12:15], s38 offen offset:1088 lds
  buffer_load_dwordx4 v14, s[12:15], s38 offen offset:2176 lds
  buffer_load_dwordx4 v15, s[12:15], s38 offen offset:3264 lds
  s_waitcnt vmcnt(18)
  s_barrier
  s_add_u32 s39, s43, 30720
  s_add_u32 m0, s42, 25856
  s_nop 0
  buffer_load_dwordx4 v2, s[24:27], s39 offen sc1 lds
  buffer_load_dwordx4 v2, s[24:27], s39 offen offset:1024 sc1 lds
  s_add_u32 s38, s36, 1720320
  s_add_u32 m0, s37, 25856
  s_nop 0
  buffer_load_dwordx4 v12, s[12:15], s38 offen offset:0 lds
  buffer_load_dwordx4 v13, s[12:15], s38 offen offset:1088 lds
  buffer_load_dwordx4 v14, s[12:15], s38 offen offset:2176 lds
  buffer_load_dwordx4 v15, s[12:15], s38 offen offset:3264 lds
  s_waitcnt vmcnt(18)
  s_barrier
  s_add_u32 s46, s5, 262144
  buffer_load_dwordx4 v[152:155], v4, s[60:63], s46 offen offset:0
  s_add_u32 s46, s5, 262144
  buffer_load_dwordx4 v[156:159], v5, s[60:63], s46 offen offset:1024
  s_add_u32 s46, s5, 270336
  buffer_load_dwordx4 v[160:163], v4, s[60:63], s46 offen offset:0
  s_add_u32 s46, s5, 270336
  buffer_load_dwordx4 v[164:167], v5, s[60:63], s46 offen offset:1024
  s_add_u32 s46, s5, 294912
  buffer_load_dwordx4 v[168:171], v4, s[60:63], s46 offen offset:0
  s_waitcnt vmcnt(17)
  s_barrier
  s_add_u32 s46, s5, 294912
  buffer_load_dwordx4 v[172:175], v5, s[60:63], s46 offen offset:1024
  s_add_u32 s46, s5, 303104
  buffer_load_dwordx4 v[176:179], v4, s[60:63], s46 offen offset:0
  s_add_u32 s46, s5, 303104
  buffer_load_dwordx4 v[180:183], v5, s[60:63], s46 offen offset:1024
  s_add_u32 s46, s35, 393216
  buffer_load_dwordx4 v[184:187], v4, s[60:63], s46 offen offset:0
  s_waitcnt vmcnt(15)
  s_barrier
  s_mul_i32 s36, s34, 40960
  v_bfe_u32 v3, v1, 2, 2
  v_lshrrev_b32 v10, 5, v1
  v_lshl_add_u32 v3, v10, 2, v3
  v_lshlrev_b32 v3, 7, v3
  v_and_b32 v10, 1, v1
  v_lshl_add_u32 v3, v10, 4, v3
  v_bfe_u32 v10, v1, 1, 1
  v_lshl_add_u32 v3, v10, 3, v3
  v_bfe_u32 v10, v1, 4, 1
  v_lshl_add_u32 v3, v10, 5, v3
  v_bfe_u32 v10, v1, 3, 1
  v_lshl_add_u32 v3, v10, 6, v3
  s_lshl_b32 s29, s34, 5
  s_and_b32 s29, s29, 64
  v_xor_b32 v3, s29, v3
  v_add_u32 v6, s36, v3
  v_xor_b32 v3, 64, v3
  v_add_u32 v7, s36, v3
  s_and_b32 s29, s34, 1
  s_mul_i32 s29, s29, 114688
  v_add_u32 v8, s29, v2
  s_sub_u32 s29, 114688, s29
  v_add_u32 v9, s29, v2
  s_mul_i32 s37, s32, 229376
  s_mul_i32 s29, s34, 28672
  s_add_u32 s37, s37, s29
  s_add_u32 s37, s37, 0xd00000
  s_add_u32 s46, s35, 393216
  buffer_load_dwordx4 v[188:191], v5, s[60:63], s46 offen offset:1024
  s_add_u32 s46, s35, 401408
  buffer_load_dwordx4 v[192:195], v4, s[60:63], s46 offen offset:0
  s_add_u32 s46, s35, 401408
  buffer_load_dwordx4 v[196:199], v5, s[60:63], s46 offen offset:1024
  s_add_u32 s46, s35, 425984
  buffer_load_dwordx4 v[200:203], v4, s[60:63], s46 offen offset:0
  s_add_u32 s46, s35, 425984
  buffer_load_dwordx4 v[204:207], v5, s[60:63], s46 offen offset:1024
  s_waitcnt vmcnt(14)
  s_barrier
  s_add_u32 s46, s35, 434176
  buffer_load_dwordx4 v[208:211], v4, s[60:63], s46 offen offset:0
  s_add_u32 s46, s35, 434176
  buffer_load_dwordx4 v[212:215], v5, s[60:63], s46 offen offset:1024
  s_setprio 3
  s_barrier
  v_add_u32 v3, s36, v2
  s_waitcnt vmcnt(62)
  ds_write_b128 v3, v[16:19] offset:0
  ds_write_b128 v3, v[20:23] offset:1024
  ds_write_b128 v3, v[24:27] offset:2048
  ds_write_b128 v3, v[28:31] offset:3072
  ds_write_b128 v3, v[32:35] offset:4096
  ds_write_b128 v3, v[36:39] offset:5120
  ds_write_b128 v3, v[40:43] offset:6144
  ds_write_b128 v3, v[44:47] offset:7168
  ds_write_b128 v3, v[56:59] offset:8192
  ds_write_b128 v3, v[60:63] offset:9216
  ds_write_b128 v3, v[64:67] offset:10240
  ds_write_b128 v3, v[68:71] offset:11264
  ds_write_b128 v3, v[72:75] offset:12288
  ds_write_b128 v3, v[76:79] offset:13312
  ds_write_b128 v3, v[80:83] offset:14336
  ds_write_b128 v3, v[84:87] offset:15360
  ds_write_b128 v3, v[88:91] offset:16384
  ds_write_b128 v3, v[92:95] offset:17408
  ds_write_b128 v3, v[96:99] offset:18432
  ds_write_b128 v3, v[100:103] offset:19456
  ds_write_b128 v3, v[104:107] offset:20480
  ds_write_b128 v3, v[108:111] offset:21504
  ds_write_b128 v3, v[112:115] offset:22528
  ds_write_b128 v3, v[116:119] offset:23552
  ds_write_b128 v3, v[120:123] offset:24576
  ds_write_b128 v3, v[124:127] offset:25600
  ds_write_b128 v3, v[128:131] offset:26624
  ds_write_b128 v3, v[132:135] offset:27648
  ds_write_b128 v3, v[136:139] offset:28672
  ds_write_b128 v3, v[140:143] offset:29696
  ds_write_b128 v3, v[144:147] offset:30720
  ds_write_b128 v3, v[148:151] offset:31744
  ds_write_b128 v3, v[224:227] offset:32768
  ds_write_b128 v3, v[228:231] offset:33792
  ds_write_b128 v3, v[232:235] offset:34816
  ds_write_b128 v3, v[236:239] offset:35840
  ds_write_b128 v3, v[240:243] offset:36864
  ds_write_b128 v3, v[244:247] offset:37888
  ds_write_b128 v3, v[248:251] offset:38912
  ds_write_b128 v3, v[252:255] offset:39936
  s_waitcnt lgkmcnt(0)
  s_setprio 0
HI_P6:
  s_barrier
  s_and_b32 s9, s34, 1
  s_mul_i32 s9, s9, 4096
  s_sub_u32 s8, 4096, s9
  s_add_u32 s8, s8, s37
  s_add_u32 s9, s9, s37
  s_mul_i32 s46, s34, 7
  s_branch SK_P8
ST_P8:
  s_branch ST_P9
SK_P8:
  s_and_b32 s47, s34, 1
  s_add_u32 s29, s46, 6
  s_lshl_b32 s10, 1, s29
  s_mov_b32 s11, s10
  s_add_u32 s46, s46, s47
  s_lshl_b32 s29, 0x15, s46
  s_lshr_b32 s6, s28, 3
  s_lshl_b32 s6, s6, 6
  v_add_lshl_u32 v85, v1, s6, 2
  s_mov_b32 s46, s29
  s_mov_b32 s47, s29
  s_mov_b64 exec, s[46:47]
  s_mov_b32 s46, 400000
POLL_p6h:
  buffer_load_dword v84, v85, s[24:27], s45 offen offset:1024 sc1
  s_waitcnt vmcnt(0)
  v_cmp_ne_u32 vcc, s101, v84
  s_cbranch_vccz POLLD_p6h
  s_sub_u32 s46, s46, 1
  s_cmp_lg_u32 s46, 0
  s_cbranch_scc1 POLL_p6h
POLLD_p6h:
  s_mov_b64 exec, -1
  s_cmp_eq_u32 s44, 1
  s_cbranch_scc0 POLLS_p6h
POLLF_p6h:
  s_add_u32 s39, s9, 0
  buffer_load_dwordx4 v[44:47], v8, s[24:27], s39 offen sc1
  buffer_load_dwordx4 v[48:51], v9, s[24:27], s39 offen sc1
  s_add_u32 s39, s9, 1024
  buffer_load_dwordx4 v[52:55], v8, s[24:27], s39 offen sc1
  buffer_load_dwordx4 v[56:59], v9, s[24:27], s39 offen sc1
  s_add_u32 s39, s9, 2048
  buffer_load_dwordx4 v[60:63], v8, s[24:27], s39 offen sc1
  buffer_load_dwordx4 v[64:67], v9, s[24:27], s39 offen sc1
  ds_read_b64_tr_b16 v[12:13], v6 offset:24576
  ds_read_b64_tr_b16 v[14:15], v6 offset:25600
  ds_read_b64_tr_b16 v[16:17], v7 offset:24576
  ds_read_b64_tr_b16 v[18:19], v7 offset:25600
  ds_read_b64_tr_b16 v[20:21], v6 offset:26624
  ds_read_b64_tr_b16 v[22:23], v6 offset:27648
  ds_read_b64_tr_b16 v[24:25], v7 offset:26624
  ds_read_b64_tr_b16 v[26:27], v7 offset:27648
  v_add_u32 v3, s36, v2
  s_waitcnt vmcnt(4) lgkmcnt(4)
  v_mfma_f32_32x32x16_bf16 v[88:103], v[12:15], v[44:47], 0
  ds_read_b64_tr_b16 v[28:29], v6 offset:28672
  ds_read_b64_tr_b16 v[30:31], v6 offset:29696
  v_mfma_f32_32x32x16_bf16 v[104:119], v[12:15], v[48:51], 0
  ds_read_b64_tr_b16 v[32:33], v7 offset:28672
  ds_read_b64_tr_b16 v[34:35], v7 offset:29696
  v_mfma_f32_32x32x16_bf16 v[120:135], v[16:19], v[44:47], 0
  ds_write_b128 v3, v[152:155] offset:24576
  ds_write_b128 v3, v[156:159] offset:25600
  s_add_u32 s39, s9, 3072
  buffer_load_dwordx4 v[68:71], v8, s[24:27], s39 offen sc1
  buffer_load_dwordx4 v[72:75], v9, s[24:27], s39 offen sc1
  v_mfma_f32_32x32x16_bf16 v[136:151], v[16:19], v[48:51], 0
  s_waitcnt vmcnt(4) lgkmcnt(6)
  v_mfma_f32_32x32x16_bf16 v[88:103], v[20:23], v[52:55], v[88:103]
  ds_read_b64_tr_b16 v[36:37], v6 offset:30720
  ds_read_b64_tr_b16 v[38:39], v6 offset:31744
  v_mfma_f32_32x32x16_bf16 v[104:119], v[20:23], v[56:59], v[104:119]
  ds_read_b64_tr_b16 v[40:41], v7 offset:30720
  ds_read_b64_tr_b16 v[42:43], v7 offset:31744
  v_mfma_f32_32x32x16_bf16 v[120:135], v[24:27], v[52:55], v[120:135]
  ds_write_b128 v3, v[160:163] offset:26624
  ds_write_b128 v3, v[164:167] offset:27648
  s_add_u32 s39, s9, 8192
  buffer_load_dwordx4 v[76:79], v8, s[24:27], s39 offen sc1
  buffer_load_dwordx4 v[80:83], v9, s[24:27], s39 offen sc1
  v_mfma_f32_32x32x16_bf16 v[136:151], v[24:27], v[56:59], v[136:151]
  s_waitcnt vmcnt(4) lgkmcnt(8)
  v_mfma_f32_32x32x16_bf16 v[88:103], v[28:31], v[60:63], v[88:103]
  ds_read_b64_tr_b16 v[12:13], v6 offset:32768
  ds_read_b64_tr_b16 v[14:15], v6 offset:33792
  v_mfma_f32_32x32x16_bf16 v[104:119], v[28:31], v[64:67], v[104:119]
  ds_read_b64_tr_b16 v[16:17], v7 offset:32768
  ds_read_b64_tr_b16 v[18:19], v7 offset:33792
  v_mfma_f32_32x32x16_bf16 v[120:135], v[32:35], v[60:63], v[120:135]
  ds_write_b128 v3, v[168:171] offset:28672
  ds_write_b128 v3, v[172:175] offset:29696
  s_add_u32 s39, s9, 9216
  buffer_load_dwordx4 v[216:219], v8, s[24:27], s39 offen sc1
  buffer_load_dwordx4 v[220:223], v9, s[24:27], s39 offen sc1
  v_mfma_f32_32x32x16_bf16 v[136:151], v[32:35], v[64:67], v[136:151]
  s_waitcnt vmcnt(4) lgkmcnt(8)
  v_mfma_f32_32x32x16_bf16 v[88:103], v[36:39], v[68:71], v[88:103]
  ds_read_b64_tr_b16 v[20:21], v6 offset:34816
  ds_read_b64_tr_b16 v[22:23], v6 offset:35840
  v_mfma_f32_32x32x16_bf16 v[104:119], v[36:39], v[72:75], v[104:119]
  ds_read_b64_tr_b16 v[24:25], v7 offset:34816
  ds_read_b64_tr_b16 v[26:27], v7 offset:35840
  v_mfma_f32_32x32x16_bf16 v[120:135], v[40:43], v[68:71], v[120:135]
  ds_write_b128 v3, v[176:179] offset:30720
  ds_write_b128 v3, v[180:183] offset:31744
  s_add_u32 s39, s9, 10240
  buffer_load_dwordx4 v[224:227], v8, s[24:27], s39 offen sc1
  buffer_load_dwordx4 v[228:231], v9, s[24:27], s39 offen sc1
  v_mfma_f32_32x32x16_bf16 v[136:151], v[40:43], v[72:75], v[136:151]
  s_waitcnt vmcnt(4) lgkmcnt(8)
  v_mfma_f32_32x32x16_bf16 v[88:103], v[12:15], v[76:79], v[88:103]
  ds_read_b64_tr_b16 v[28:29], v6 offset:36864
  ds_read_b64_tr_b16 v[30:31], v6 offset:37888
  v_mfma_f32_32x32x16_bf16 v[104:119], v[12:15], v[80:83], v[104:119]
  ds_read_b64_tr_b16 v[32:33], v7 offset:36864
  ds_read_b64_tr_b16 v[34:35], v7 offset:37888
  v_mfma_f32_32x32x16_bf16 v[120:135], v[16:19], v[76:79], v[120:135]
  ds_write_b128 v3, v[184:187] offset:32768
  ds_write_b128 v3, v[188:191] offset:33792
  s_add_u32 s39, s9, 11264
  buffer_load_dwordx4 v[232:235], v8, s[24:27], s39 offen sc1
  buffer_load_dwordx4 v[236:239], v9, s[24:27], s39 offen sc1
  v_mfma_f32_32x32x16_bf16 v[136:151], v[16:19], v[80:83], v[136:151]
  s_waitcnt vmcnt(4) lgkmcnt(8)
  v_mfma_f32_32x32x16_bf16 v[88:103], v[20:23], v[216:219], v[88:103]
  ds_read_b64_tr_b16 v[36:37], v6 offset:38912
  ds_read_b64_tr_b16 v[38:39], v6 offset:39936
  v_mfma_f32_32x32x16_bf16 v[104:119], v[20:23], v[220:223], v[104:119]
  ds_read_b64_tr_b16 v[40:41], v7 offset:38912
  ds_read_b64_tr_b16 v[42:43], v7 offset:39936
  v_mfma_f32_32x32x16_bf16 v[120:135], v[24:27], v[216:219], v[120:135]
  ds_write_b128 v3, v[192:195] offset:34816
  ds_write_b128 v3, v[196:199] offset:35840
  buffer_load_dword v84, v85, s[24:27], s45 offen offset:1024 sc1
  s_add_u32 s39, s9, 16384
  buffer_load_dwordx4 v[240:243], v8, s[24:27], s39 offen sc1
  buffer_load_dwordx4 v[244:247], v9, s[24:27], s39 offen sc1
  v_mfma_f32_32x32x16_bf16 v[136:151], v[24:27], v[220:223], v[136:151]
  s_waitcnt vmcnt(5) lgkmcnt(8)
  v_mfma_f32_32x32x16_bf16 v[88:103], v[28:31], v[224:227], v[88:103]
  ds_read_b64_tr_b16 v[12:13], v6 offset:24576
  ds_read_b64_tr_b16 v[14:15], v6 offset:25600
  v_mfma_f32_32x32x16_bf16 v[104:119], v[28:31], v[228:231], v[104:119]
  ds_read_b64_tr_b16 v[16:17], v7 offset:24576
  ds_read_b64_tr_b16 v[18:19], v7 offset:25600
  v_mfma_f32_32x32x16_bf16 v[120:135], v[32:35], v[224:227], v[120:135]
  ds_write_b128 v3, v[200:203] offset:36864
  ds_write_b128 v3, v[204:207] offset:37888
  s_add_u32 s39, s9, 17408
  buffer_load_dwordx4 v[248:251], v8, s[24:27], s39 offen sc1
  buffer_load_dwordx4 v[252:255], v9, s[24:27], s39 offen sc1
  v_mfma_f32_32x32x16_bf16 v[136:151], v[32:35], v[228:231], v[136:151]
  s_waitcnt vmcnt(5) lgkmcnt(8)
  v_mfma_f32_32x32x16_bf16 v[88:103], v[36:39], v[232:235], v[88:103]
  ds_read_b64_tr_b16 v[20:21], v6 offset:26624
  ds_read_b64_tr_b16 v[22:23], v6 offset:27648
  v_mfma_f32_32x32x16_bf16 v[104:119], v[36:39], v[236:239], v[104:119]
  ds_read_b64_tr_b16 v[24:25], v7 offset:26624
  ds_read_b64_tr_b16 v[26:27], v7 offset:27648
  v_mfma_f32_32x32x16_bf16 v[120:135], v[40:43], v[232:235], v[120:135]
  ds_write_b128 v3, v[208:211] offset:38912
  ds_write_b128 v3, v[212:215] offset:39936
  s_add_u32 s39, s9, 18432
  buffer_load_dwordx4 v[44:47], v8, s[24:27], s39 offen sc1
  buffer_load_dwordx4 v[48:51], v9, s[24:27], s39 offen sc1
  v_mfma_f32_32x32x16_bf16 v[136:151], v[40:43], v[236:239], v[136:151]
  s_waitcnt vmcnt(4) lgkmcnt(8)
  v_mfma_f32_32x32x16_bf16 v[88:103], v[12:15], v[240:243], v[88:103]
  ds_read_b64_tr_b16 v[28:29], v6 offset:28672
  ds_read_b64_tr_b16 v[30:31], v6 offset:29696
  v_mfma_f32_32x32x16_bf16 v[104:119], v[12:15], v[244:247], v[104:119]
  ds_read_b64_tr_b16 v[32:33], v7 offset:28672
  ds_read_b64_tr_b16 v[34:35], v7 offset:29696
  v_mfma_f32_32x32x16_bf16 v[120:135], v[16:19], v[240:243], v[120:135]
  s_add_u32 s39, s9, 19456
  buffer_load_dwordx4 v[52:55], v8, s[24:27], s39 offen sc1
  buffer_load_dwordx4 v[56:59], v9, s[24:27], s39 offen sc1
  v_mfma_f32_32x32x16_bf16 v[136:151], v[16:19], v[244:247], v[136:151]
  s_waitcnt vmcnt(4) lgkmcnt(6)
  v_mfma_f32_32x32x16_bf16 v[88:103], v[20:23], v[248:251], v[88:103]
  ds_read_b64_tr_b16 v[36:37], v6 offset:30720
  ds_read_b64_tr_b16 v[38:39], v6 offset:31744
  v_mfma_f32_32x32x16_bf16 v[104:119], v[20:23], v[252:255], v[104:119]
  ds_read_b64_tr_b16 v[40:41], v7 offset:30720
  ds_read_b64_tr_b16 v[42:43], v7 offset:31744
  v_mfma_f32_32x32x16_bf16 v[120:135], v[24:27], v[248:251], v[120:135]
  s_waitcnt vmcnt(8)
  v_cmp_ne_u32 vcc, s101, v84
  s_nop 0
  s_and_b64 vcc, vcc, s[10:11]
  s_cselect_b32 s46, 0, s44
  s_cmp_lg_u32 s46, 1
  s_cbranch_scc1 HI_P6S
HI_P6SD:
  s_add_u32 s39, s37, 24576
  buffer_load_dwordx4 v[60:63], v8, s[24:27], s39 offen sc1
  buffer_load_dwordx4 v[64:67], v9, s[24:27], s39 offen sc1
  v_mfma_f32_32x32x16_bf16 v[136:151], v[24:27], v[252:255], v[136:151]
  s_waitcnt vmcnt(4) lgkmcnt(4)
  v_mfma_f32_32x32x16_bf16 v[88:103], v[28:31], v[44:47], v[88:103]
  ds_read_b64_tr_b16 v[12:13], v6 offset:32768
  ds_read_b64_tr_b16 v[14:15], v6 offset:33792
  v_mfma_f32_32x32x16_bf16 v[104:119], v[28:31], v[48:51], v[104:119]
  ds_read_b64_tr_b16 v[16:17], v7 offset:32768
  ds_read_b64_tr_b16 v[18:19], v7 offset:33792
  v_mfma_f32_32x32x16_bf16 v[120:135], v[32:35], v[44:47], v[120:135]
  s_add_u32 s39, s37, 25600
  buffer_load_dwordx4 v[68:71], v8, s[24:27], s39 offen sc1
  buffer_load_dwordx4 v[72:75], v9, s[24:27], s39 offen sc1
  v_mfma_f32_32x32x16_bf16 v[136:151], v[32:35], v[48:51], v[136:151]
  s_waitcnt vmcnt(4) lgkmcnt(4)
  v_mfma_f32_32x32x16_bf16 v[88:103], v[36:39], v[52:55], v[88:103]
  ds_read_b64_tr_b16 v[20:21], v6 offset:34816
  ds_read_b64_tr_b16 v[22:23], v6 offset:35840
  v_mfma_f32_32x32x16_bf16 v[104:119], v[36:39], v[56:59], v[104:119]
  ds_read_b64_tr_b16 v[24:25], v7 offset:34816
  ds_read_b64_tr_b16 v[26:27], v7 offset:35840
  v_mfma_f32_32x32x16_bf16 v[120:135], v[40:43], v[52:55], v[120:135]
  s_add_u32 s39, s37, 26624
  buffer_load_dwordx4 v[76:79], v8, s[24:27], s39 offen sc1
  buffer_load_dwordx4 v[80:83], v9, s[24:27], s39 offen sc1
  v_mfma_f32_32x32x16_bf16 v[136:151], v[40:43], v[56:59], v[136:151]
  s_waitcnt vmcnt(4) lgkmcnt(4)
  v_mfma_f32_32x32x16_bf16 v[88:103], v[12:15], v[60:63], v[88:103]
  ds_read_b64_tr_b16 v[28:29], v6 offset:36864
  ds_read_b64_tr_b16 v[30:31], v6 offset:37888
  v_mfma_f32_32x32x16_bf16 v[104:119], v[12:15], v[64:67], v[104:119]
  ds_read_b64_tr_b16 v[32:33], v7 offset:36864
  ds_read_b64_tr_b16 v[34:35], v7 offset:37888
  v_mfma_f32_32x32x16_bf16 v[120:135], v[16:19], v[60:63], v[120:135]
  s_add_u32 s39, s37, 27648
  buffer_load_dwordx4 v[216:219], v8, s[24:27], s39 offen sc1
  buffer_load_dwordx4 v[220:223], v9, s[24:27], s39 offen sc1
  v_mfma_f32_32x32x16_bf16 v[136:151], v[16:19], v[64:67], v[136:151]
  s_waitcnt vmcnt(4) lgkmcnt(4)
  v_mfma_f32_32x32x16_bf16 v[88:103], v[20:23], v[68:71], v[88:103]
  ds_read_b64_tr_b16 v[36:37], v6 offset:38912
  ds_read_b64_tr_b16 v[38:39], v6 offset:39936
  v_mfma_f32_32x32x16_bf16 v[104:119], v[20:23], v[72:75], v[104:119]
  ds_read_b64_tr_b16 v[40:41], v7 offset:38912
  ds_read_b64_tr_b16 v[42:43], v7 offset:39936
  v_mfma_f32_32x32x16_bf16 v[120:135], v[24:27], v[68:71], v[120:135]
  v_mfma_f32_32x32x16_bf16 v[136:151], v[24:27], v[72:75], v[136:151]
  s_waitcnt vmcnt(2) lgkmcnt(4)
  v_mfma_f32_32x32x16_bf16 v[88:103], v[28:31], v[76:79], v[88:103]
  s_waitcnt vmcnt(0) lgkmcnt(0)
  v_mfma_f32_32x32x16_bf16 v[88:103], v[36:39], v[216:219], v[88:103]
  v_mfma_f32_32x32x16_bf16 v[104:119], v[28:31], v[80:83], v[104:119]
  v_mfma_f32_32x32x16_bf16 v[104:119], v[36:39], v[220:223], v[104:119]
  s_nop 9
  ds_write_b128 v3, v[88:91] offset:24576
  ds_write_b128 v3, v[92:95] offset:25600
  v_mfma_f32_32x32x16_bf16 v[120:135], v[32:35], v[76:79], v[120:135]
  ds_write_b128 v3, v[96:99] offset:26624
  ds_write_b128 v3, v[100:103] offset:27648
  v_mfma_f32_32x32x16_bf16 v[120:135], v[40:43], v[216:219], v[120:135]
  ds_write_b128 v3, v[104:107] offset:28672
  ds_write_b128 v3, v[108:111] offset:29696
  v_mfma_f32_32x32x16_bf16 v[136:151], v[32:35], v[80:83], v[136:151]
  ds_write_b128 v3, v[112:115] offset:30720
  ds_write_b128 v3, v[116:119] offset:31744
  v_mfma_f32_32x32x16_bf16 v[136:151], v[40:43], v[220:223], v[136:151]
  s_nop 5
  ds_write_b128 v3, v[120:123] offset:32768
  ds_write_b128 v3, v[124:127] offset:33792
  ds_write_b128 v3, v[128:131] offset:34816
  ds_write_b128 v3, v[132:135] offset:35840
  s_nop 1
  ds_write_b128 v3, v[136:139] offset:36864
  ds_write_b128 v3, v[140:143] offset:37888
  ds_write_b128 v3, v[144:147] offset:38912
  ds_write_b128 v3, v[148:151] offset:39936
  s_waitcnt lgkmcnt(0)
  s_barrier
  s_branch KF_DUMP
KF_END:
  s_endpgm
HI_INV:
  buffer_inv sc1
  s_waitcnt vmcnt(0)
  s_branch HI_INVD
HI_P6S:
  v_add_lshl_u32 v85, v1, s6, 2
  s_mov_b32 s46, s10
  s_mov_b32 s47, s10
  s_mov_b64 exec, s[46:47]
  s_mov_b32 s46, 400000
POLL_p6s:
  buffer_load_dword v84, v85, s[24:27], s45 offen offset:1024 sc1
  s_waitcnt vmcnt(0)
  v_cmp_ne_u32 vcc, s101, v84
  s_cbranch_vccz POLLD_p6s
  s_sub_u32 s46, s46, 1
  s_cmp_lg_u32 s46, 0
  s_cbranch_scc1 POLL_p6s
POLLD_p6s:
  s_mov_b64 exec, -1
  s_cmp_eq_u32 s44, 1
  s_cbranch_scc0 POLLS_p6s
POLLF_p6s:
  s_branch HI_P6SD
HI_XRS:
  v_add_lshl_u32 v83, v1, 0, 2
  s_mov_b32 s46, 0xffff
  s_mov_b32 s47, 0
  s_mov_b64 exec, s[46:47]
  s_mov_b32 s46, 400000
POLL_xr:
  buffer_load_dword v82, v83, s[24:27], s45 offen offset:2176 sc1
  s_waitcnt vmcnt(0)
  v_cmp_ne_u32 vcc, s101, v82
  s_cbranch_vccz POLLD_xr
  s_sub_u32 s46, s46, 1
  s_cmp_lg_u32 s46, 0
  s_cbranch_scc1 POLL_xr
POLLD_xr:
  s_mov_b64 exec, -1
  s_cmp_eq_u32 s44, 1
  s_cbranch_scc0 POLLS_xr
POLLF_xr:
  s_branch HI_XRD
HI_IDLE:
  s_barrier
  s_cmp_lg_u32 s7, 3
  s_cbranch_scc1 UVA_b
  buffer_atomic_add_f32 v152, v156, s[24:27], s10 offen
  buffer_atomic_add_f32 v154, v156, s[24:27], s11 offen
  s_mov_b64 exec, s[8:9]
  buffer_atomic_add_f32 v153, v156, s[24:27], s10 offen offset:256
  buffer_atomic_add_f32 v155, v156, s[24:27], s11 offen offset:256
  s_mov_b64 exec, -1
UVA_b:
  s_barrier
  s_waitcnt vmcnt(0)
  s_cmp_lg_u32 s7, 3
  s_cbranch_scc1 UVS_b
  s_mov_b64 exec, 1
  v_mov_b32 v48, s101
  v_mov_b32 v49, s28
  v_lshlrev_b32 v49, 2, v49
  s_cmp_eq_u32 s44, 1
  s_cbranch_scc0 SIGS_uvb
  buffer_store_dword v48, v49, s[24:27], s45 offen offset:2432
SIGD_uvb:
  s_mov_b64 exec, -1
UVS_b:
  s_barrier
  s_cmp_lg_u32 s34, 0
  s_cbranch_scc1 HI_SG
  s_cmp_lg_u32 s28, 28
  s_cbranch_scc1 HI_NOAGG
  v_add_lshl_u32 v49, v1, 0, 2
  s_mov_b32 s46, -1
  s_mov_b32 s47, 0
  s_mov_b64 exec, s[46:47]
  s_mov_b32 s46, 400000
POLL_fu:
  buffer_load_dword v48, v49, s[24:27], s45 offen offset:2432 sc1
  s_waitcnt vmcnt(0)
  v_cmp_ne_u32 vcc, s101, v48
  s_cbranch_vccz POLLD_fu
  s_sub_u32 s46, s46, 1
  s_cmp_lg_u32 s46, 0
  s_cbranch_scc1 POLL_fu
POLLD_fu:
  s_mov_b64 exec, -1
  s_cmp_eq_u32 s44, 1
  s_cbranch_scc0 POLLS_fu
POLLF_fu:
  s_mov_b64 exec, 0xff
  v_lshlrev_b32 v4, 12, v1
  v_mov_b32 v3, s101
  s_lshl_b32 s29, s3, 2
  s_add_u32 s29, s29, 0x10900
  buffer_store_dword v3, v4, s[24:27], s29 offen sc1
HI_NOAGG:
  s_mov_b64 exec, 0xff
  v_lshlrev_b32 v4, 2, v1
  s_mov_b32 s46, 400000
POLL_g:
  buffer_load_dword v3, v4, s[24:27], s45 offen offset:2304 sc1
  s_waitcnt vmcnt(0)
  v_cmp_ne_u32 vcc, s101, v3
  s_cbranch_vccz POLLD_g
  s_sleep 2
  s_sub_u32 s46, s46, 1
  s_cmp_lg_u32 s46, 0
  s_cbranch_scc1 POLL_g
POLLD_g:
  s_cmp_lg_u32 s2, 255
  s_cbranch_scc1 HI_NOBUMP
  s_mov_b64 exec, 1
  v_mov_b32 v3, s101
  s_mov_b32 s29, 0x18000
  buffer_store_dword v3, v4, s[24:27], s29 offen sc1
HI_NOBUMP:
  s_mov_b64 exec, -1
HI_SG:
  s_barrier
  s_sub_u32 s46, s28, 28
  s_mul_i32 s46, s46, 448
  s_mov_b32 s36, 0x8000
  s_mov_b32 s37, 0x9c00
  v_add_u32 v152, -256, v0
  v_min_u32 v152, 447, v152
  v_add_u32 v152, s46, v152
  v_lshlrev_b32 v155, 5, v152
  v_cmp_le_u32 vcc, 896, v152
  v_mov_b32 v153, 0
  v_mov_b32 v154, 1
  v_cndmask_b32 v153, v153, v154, vcc
  v_mul_u32_u24 v154, 896, v153
  v_sub_u32 v152, v152, v154
  v_mul_u32_u24 v154, 14336, v153
  v_lshl_add_u32 v154, v152, 3, v154
  v_lshrrev_b32 v155, 5, v152
  v_lshl_add_u32 v155, v155, 1, v153
  v_bfe_u32 v153, v152, 4, 1
  v_lshl_add_u32 v155, v155, 1, v153
  v_and_b32 v153, 7, v152
  v_lshl_add_u32 v155, v155, 4, v153
  v_bfe_u32 v153, v152, 3, 1
  v_lshlrev_b32 v155, 5, v155
  v_lshl_add_u32 v155, v153, 3, v155
  buffer_load_dwordx2 v[156:157], v154, s[24:27], s36 offen sc1
  buffer_load_dwordx2 v[158:159], v154, s[24:27], s37 offen sc1
  v_add_u32 v168, 0, v0
  v_min_u32 v168, 447, v168
  v_add_u32 v168, s46, v168
  v_lshlrev_b32 v171, 5, v168
  v_cmp_le_u32 vcc, 896, v168
  v_mov_b32 v169, 0
  v_mov_b32 v170, 1
  v_cndmask_b32 v169, v169, v170, vcc
  v_mul_u32_u24 v170, 896, v169
  v_sub_u32 v168, v168, v170
  v_mul_u32_u24 v170, 14336, v169
  v_lshl_add_u32 v170, v168, 3, v170
  v_lshrrev_b32 v171, 5, v168
  v_lshl_add_u32 v171, v171, 1, v169
  v_bfe_u32 v169, v168, 4, 1
  v_lshl_add_u32 v171, v171, 1, v169
  v_and_b32 v169, 7, v168
  v_lshl_add_u32 v171, v171, 4, v169
  v_bfe_u32 v169, v168, 3, 1
  v_lshlrev_b32 v171, 5, v171
  v_lshl_add_u32 v171, v169, 3, v171
  buffer_load_dwordx2 v[172:173], v170, s[24:27], s36 offen sc1
  buffer_load_dwordx2 v[174:175], v170, s[24:27], s37 offen sc1
  s_waitcnt vmcnt(0)
  v_cvt_pk_bf16_f32 v160, v156, v157
  v_lshlrev_b32 v152, 16, v160
  v_and_b32 v153, s31, v160
  v_sub_f32 v156, v156, v152
  v_sub_f32 v157, v157, v153
  v_cvt_pk_bf16_f32 v161, v156, v157
  v_cvt_pk_bf16_f32 v162, v158, v159
  v_lshlrev_b32 v152, 16, v162
  v_and_b32 v153, s31, v162
  v_sub_f32 v158, v158, v152
  v_sub_f32 v159, v159, v153
  v_cvt_pk_bf16_f32 v163, v158, v159
  s_mov_b32 s46, 0x05040100
  s_mov_b32 s47, 0x07060302
  s_mul_i32 s29, s3, 114688
  s_add_u32 s29, s29, 0x1600000
  v_perm_b32 v156, v161, v160, s46
  v_perm_b32 v157, v163, v162, s46
  v_perm_b32 v158, v162, v160, s46
  v_mov_b32 v159, 0
  v_perm_b32 v164, v161, v160, s47
  v_perm_b32 v165, v163, v162, s47
  v_perm_b32 v166, v162, v160, s47
  v_mov_b32 v167, 0
  buffer_store_dwordx2 v[156:157], v155, s[24:27], s29 offen offset:0
  buffer_store_dwordx2 v[158:159], v155, s[24:27], s29 offen offset:256
  buffer_store_dwordx2 v[164:165], v155, s[24:27], s29 offen offset:16
  buffer_store_dwordx2 v[166:167], v155, s[24:27], s29 offen offset:272
  v_cvt_pk_bf16_f32 v176, v172, v173
  v_lshlrev_b32 v168, 16, v176
  v_and_b32 v169, s31, v176
  v_sub_f32 v172, v172, v168
  v_sub_f32 v173, v173, v169
  v_cvt_pk_bf16_f32 v177, v172, v173
  v_cvt_pk_bf16_f32 v178, v174, v175
  v_lshlrev_b32 v168, 16, v178
  v_and_b32 v169, s31, v178
  v_sub_f32 v174, v174, v168
  v_sub_f32 v175, v175, v169
  v_cvt_pk_bf16_f32 v179, v174, v175
  s_mov_b32 s46, 0x05040100
  s_mov_b32 s47, 0x07060302
  s_mul_i32 s29, s3, 114688
  s_add_u32 s29, s29, 0x1600000
  v_perm_b32 v172, v177, v176, s46
  v_perm_b32 v173, v179, v178, s46
  v_perm_b32 v174, v178, v176, s46
  v_mov_b32 v175, 0
  v_perm_b32 v180, v177, v176, s47
  v_perm_b32 v181, v179, v178, s47
  v_perm_b32 v182, v178, v176, s47
  v_mov_b32 v183, 0
  buffer_store_dwordx2 v[172:173], v171, s[24:27], s29 offen offset:0
  buffer_store_dwordx2 v[174:175], v171, s[24:27], s29 offen offset:256
  buffer_store_dwordx2 v[180:181], v171, s[24:27], s29 offen offset:16
  buffer_store_dwordx2 v[182:183], v171, s[24:27], s29 offen offset:272
  s_sub_u32 s29, s28, 28
  s_lshl_b32 s29, s29, 2
  s_add_u32 s29, s29, s34
  s_waitcnt vmcnt(0)
  s_mov_b64 exec, 1
  v_mov_b32 v48, s101
  v_mov_b32 v49, s29
  v_lshlrev_b32 v49, 2, v49
  s_cmp_eq_u32 s44, 1
  s_cbranch_scc0 SIGS_xr
  buffer_store_dword v48, v49, s[24:27], s45 offen offset:2176
SIGD_xr:
  s_mov_b64 exec, -1
  v_lshrrev_b32 v3, 3, v1
  v_and_b32 v10, 7, v1
  v_bfe_u32 v11, v1, 4, 1
  v_lshlrev_b32 v11, 2, v11
  v_xor_b32 v10, v10, v11
  v_lshlrev_b32 v3, 10, v3
  v_lshl_add_u32 v4, v10, 4, v3
  v_add_u32 v5, 15360, v4
  s_mul_i32 s35, s34, 458752
  s_lshl_b32 s29, s33, 7
  s_add_u32 s35, s35, s29
  s_mul_i32 s36, s34, 40960
  v_bfe_u32 v3, v1, 2, 2
  v_lshrrev_b32 v10, 5, v1
  v_lshl_add_u32 v3, v10, 2, v3
  v_lshlrev_b32 v3, 7, v3
  v_and_b32 v10, 1, v1
  v_lshl_add_u32 v3, v10, 4, v3
  v_bfe_u32 v10, v1, 1, 1
  v_lshl_add_u32 v3, v10, 3, v3
  v_bfe_u32 v10, v1, 4, 1
  v_lshl_add_u32 v3, v10, 5, v3
  v_bfe_u32 v10, v1, 3, 1
  v_lshl_add_u32 v3, v10, 6, v3
  s_lshl_b32 s29, s34, 5
  s_and_b32 s29, s29, 64
  v_xor_b32 v3, s29, v3
  v_add_u32 v6, s36, v3
  v_xor_b32 v3, 64, v3
  v_add_u32 v7, s36, v3
  s_and_b32 s29, s34, 1
  s_mul_i32 s29, s29, 114688
  v_add_u32 v8, s29, v2
  s_sub_u32 s29, 114688, s29
  v_add_u32 v9, s29, v2
  s_mul_i32 s37, s32, 229376
  s_mul_i32 s29, s34, 28672
  s_add_u32 s37, s37, s29
  s_add_u32 s37, s37, 0xd00000
  s_and_b32 s5, s34, 1
  s_mul_i32 s5, s5, 65536
  s_sub_u32 s4, 65536, s5
  s_add_u32 s4, s4, s35
  s_add_u32 s5, s5, s35
  s_add_u32 s46, s5, 262144
  buffer_load_dwordx4 v[152:155], v4, s[60:63], s46 offen offset:0
  s_add_u32 s46, s5, 262144
  buffer_load_dwordx4 v[156:159], v5, s[60:63], s46 offen offset:1024
  s_add_u32 s46, s5, 270336
  buffer_load_dwordx4 v[160:163], v4, s[60:63], s46 offen offset:0
  s_add_u32 s46, s5, 270336
  buffer_load_dwordx4 v[164:167], v5, s[60:63], s46 offen offset:1024
  s_add_u32 s46, s5, 294912
  buffer_load_dwordx4 v[168:171], v4, s[60:63], s46 offen offset:0
  s_add_u32 s46, s5, 294912
  buffer_load_dwordx4 v[172:175], v5, s[60:63], s46 offen offset:1024
  s_add_u32 s46, s5, 303104
  buffer_load_dwordx4 v[176:179], v4, s[60:63], s46 offen offset:0
  s_add_u32 s46, s5, 303104
  buffer_load_dwordx4 v[180:183], v5, s[60:63], s46 offen offset:1024
  s_add_u32 s46, s35, 393216
  buffer_load_dwordx4 v[184:187], v4, s[60:63], s46 offen offset:0
  s_add_u32 s46, s35, 393216
  buffer_load_dwordx4 v[188:191], v5, s[60:63], s46 offen offset:1024
  s_add_u32 s46, s35, 401408
  buffer_load_dwordx4 v[192:195], v4, s[60:63], s46 offen offset:0
  s_add_u32 s46, s35, 401408
  buffer_load_dwordx4 v[196:199], v5, s[60:63], s46 offen offset:1024
  s_add_u32 s46, s35, 425984
  buffer_load_dwordx4 v[200:203], v4, s[60:63], s46 offen offset:0
  s_add_u32 s46, s35, 425984
  buffer_load_dwordx4 v[204:207], v5, s[60:63], s46 offen offset:1024
  s_add_u32 s46, s35, 434176
  buffer_load_dwordx4 v[208:211], v4, s[60:63], s46 offen offset:0
  s_add_u32 s46, s35, 434176
  buffer_load_dwordx4 v[212:215], v5, s[60:63], s46 offen offset:1024
  v_add_u32 v3, s36, v2
  s_waitcnt vmcnt(16)
  ds_write_b128 v3, v[16:19] offset:0
  ds_write_b128 v3, v[20:23] offset:1024
  ds_write_b128 v3, v[24:27] offset:2048
  ds_write_b128 v3, v[28:31] offset:3072
  ds_write_b128 v3, v[32:35] offset:4096
  ds_write_b128 v3, v[36:39] offset:5120
  ds_write_b128 v3, v[40:43] offset:6144
  ds_write_b128 v3, v[44:47] offset:7168
  ds_write_b128 v3, v[56:59] offset:8192
  ds_write_b128 v3, v[60:63] offset:9216
  ds_write_b128 v3, v[64:67] offset:10240
  ds_write_b128 v3, v[68:71] offset:11264
  ds_write_b128 v3, v[72:75] offset:12288
  ds_write_b128 v3, v[76:79] offset:13312
  ds_write_b128 v3, v[80:83] offset:14336
  ds_write_b128 v3, v[84:87] offset:15360
  ds_write_b128 v3, v[88:91] offset:16384
  ds_write_b128 v3, v[92:95] offset:17408
  ds_write_b128 v3, v[96:99] offset:18432
  ds_write_b128 v3, v[100:103] offset:19456
  ds_write_b128 v3, v[104:107] offset:20480
  ds_write_b128 v3, v[108:111] offset:21504
  ds_write_b128 v3, v[112:115] offset:22528
  ds_write_b128 v3, v[116:119] offset:23552
  ds_write_b128 v3, v[120:123] offset:24576
  ds_write_b128 v3, v[124:127] offset:25600
  ds_write_b128 v3, v[128:131] offset:26624
  ds_write_b128 v3, v[132:135] offset:27648
  ds_write_b128 v3, v[136:139] offset:28672
  ds_write_b128 v3, v[140:143] offset:29696
  ds_write_b128 v3, v[144:147] offset:30720
  ds_write_b128 v3, v[148:151] offset:31744
  ds_write_b128 v3, v[224:227] offset:32768
  ds_write_b128 v3, v[228:231] offset:33792
  ds_write_b128 v3, v[232:235] offset:34816
  ds_write_b128 v3, v[236:239] offset:35840
  ds_write_b128 v3, v[240:243] offset:36864
  ds_write_b128 v3, v[244:247] offset:37888
  ds_write_b128 v3, v[248:251] offset:38912
  ds_write_b128 v3, v[252:255] offset:39936
  s_waitcnt lgkmcnt(0)
  s_branch HI_P6
ST_SY:
  s_branch WR_g
P3_SYNC:
  s_cmp_lg_u32 s43, 0
  s_cbranch_scc1 P3_SYNC2
P3_MODS:
  s_sub_u32 s46, s28, 8
  s_cmp_ge_u32 s46, 16
  s_cbranch_scc1 P3_MODR
  v_add_u32 v219, 150528, v5
  s_mov_b64 exec, 0xffff
  ds_read_b32 v140, v219 offset:0
  ds_read_b32 v141, v219 offset:64
  ds_read_b32 v142, v219 offset:128
  ds_read_b32 v143, v219 offset:192
  s_lshl_b32 s47, s3, 4
  s_add_u32 s46, s46, s47
  s_mov_b64 exec, 0x3fff
  s_mul_i32 s47, s46, 224
  s_branch SK_P9
ST_P9:
  s_branch WR_e
SK_P9:
  s_add_u32 s47, s47, 0x8000
  v_mov_b64 v[144:145], 0
  v_mov_b64 v[146:147], 0
  buffer_store_dwordx4 v[144:147], v2, s[24:27], s47 offen sc1
  s_mov_b64 exec, 0xffff
  s_lshl_b32 s46, s46, 6
  s_add_u32 s46, s46, 0x1000
  s_waitcnt lgkmcnt(0)
  v_add_f32 v140, v140, v141
  v_add_f32 v142, v142, v143
  v_add_f32 v140, v140, v142
  buffer_store_dword v140, v5, s[24:27], s46 offen sc1
  s_mov_b64 exec, -1
  s_branch P3_MODR
P3_MODF:
  s_waitcnt vmcnt(0)
  s_sub_u32 s46, s28, 8
  s_cmp_ge_u32 s46, 16
  s_cbranch_scc1 P3_MODFD
  s_lshl_b32 s47, s3, 4
  s_add_u32 s46, s46, s47
  s_lshl_b32 s46, s46, 2
  s_add_u32 s46, s46, 0x18100
  v_mov_b32 v216, s101
  s_mov_b64 exec, 1
  buffer_store_dword v216, v5, s[24:27], s46 offen sc1
  s_mov_b64 exec, -1
  s_branch P3_MODFD
P3_SYNC2:
  s_cmp_eq_u32 s30, 0
  s_cbranch_scc1 P3_MODF
  s_waitcnt vmcnt(0)
P3_MODFD:
  s_barrier
  v_and_b32 v255, 31, v1
  v_lshlrev_b32 v255, 2, v255
  buffer_load_dword v254, v255, s[24:27], s45 offen offset:2048 sc1
  s_cmp_ge_u32 s30, 4
  s_cbranch_scc1 P3_SBACK
  s_and_b32 s46, s2, 1
  s_cmp_eq_u32 s46, 0
  s_cselect_b32 s4, s52, s56
  s_cselect_b32 s5, s53, s57
  s_mov_b32 s6, s54
  s_mov_b32 s7, 0x20000
  s_bfe_u32 s8, s2, 0x30001
  s_lshr_b32 s9, s2, 4
  s_lshl_b32 s10, s8, 6
  s_lshl_b32 s11, s30, 2
  s_add_u32 s10, s10, s11
  v_lshrrev_b32 v248, 4, v1
  v_add_u32 v248, s10, v248
  v_and_b32 v249, 15, v1
  v_min_u32 v249, 13, v249
  v_mul_u32_u24 v250, 3584, v248
  v_lshl_add_u32 v250, v249, 4, v250
  v_lshlrev_b32 v251, 2, v248
  s_mul_i32 s10, s9, 224
  s_add_u32 s11, s10, 0
  buffer_load_dwordx4 v[224:227], v250, s[4:7], s11 offen
  s_add_u32 s11, s10, 57344
  buffer_load_dwordx4 v[228:231], v250, s[4:7], s11 offen
  s_add_u32 s11, s10, 114688
  buffer_load_dwordx4 v[232:235], v250, s[4:7], s11 offen
  s_add_u32 s11, s10, 172032
  buffer_load_dwordx4 v[236:239], v250, s[4:7], s11 offen
  s_mul_i32 s46, s2, 56
  v_min_u32 v216, 55, v0
  v_add_u32 v216, s46, v216
  v_lshlrev_b32 v216, 7, v216
  buffer_load_dword v219, v216, s[60:63], 0 offen
  s_mul_i32 s47, s28, 112
  v_add_u32 v216, 0, v0
  v_min_u32 v216, 111, v216
  v_add_u32 v216, s47, v216
  v_mul_u32_u24 v216, 128, v216
  buffer_load_dword v219, v216, s[56:59], 0 offen
  s_mul_i32 s47, s28, 112
  v_add_u32 v216, 0, v0
  v_min_u32 v216, 111, v216
  v_add_u32 v216, s47, v216
  v_mul_u32_u24 v216, 128, v216
  buffer_load_dword v219, v216, s[52:55], 0 offen
  s_mul_i32 s47, s28, 128
  v_add_u32 v216, 0, v0
  v_min_u32 v216, 127, v216
  v_add_u32 v216, s47, v216
  v_mul_u32_u24 v216, 128, v216
  buffer_load_dword v219, v216, s[48:51], 0 offen
  s_branch P3_SBACK
P3_EVT:
  s_mul_i32 s46, s33, 18432
  s_mul_i32 s47, s32, 9216
  s_add_u32 s46, s46, s47
  v_add_u32 v4, s46, v2
  v_add_u32 v6, s46, v5
  ds_write_b128 v4, v[152:155] offset:0
  ds_write_b128 v4, v[156:159] offset:1024
  ds_write_b32 v6, v160 offset:2048
  ds_write_b128 v4, v[168:171] offset:2304
  ds_write_b128 v4, v[172:175] offset:3328
  ds_write_b32 v6, v176 offset:4352
  ds_write_b128 v4, v[184:187] offset:4608
  ds_write_b128 v4, v[188:191] offset:5632
  ds_write_b32 v6, v192 offset:6656
  ds_write_b128 v4, v[200:203] offset:6912
  ds_write_b128 v4, v[204:207] offset:7936
  ds_write_b32 v6, v208 offset:8960
  v_lshlrev_b32 v3, 3, v1
  s_mov_b32 s47, 0x18100
  s_mov_b32 s46, 400000
P3_MODP:
  buffer_load_dwordx2 v[216:217], v3, s[24:27], s47 offen sc1
  s_waitcnt vmcnt(0)
  v_xor_b32 v216, s101, v216
  v_xor_b32 v217, s101, v217
  v_or_b32 v216, v216, v217
  v_cmp_ne_u32 vcc, 0, v216
  s_cbranch_vccz P3_MODD
  s_sub_u32 s46, s46, 1
  s_cmp_lg_u32 s46, 0
  s_cbranch_scc1 P3_MODP
P3_MODD:
  s_waitcnt lgkmcnt(0)
  s_mov_b64 exec, 1
  ds_add_u32 v223, v218
  s_mov_b64 exec, -1
  s_mov_b32 s11, 8192
  buffer_load_dword v192, v251, s[24:27], s11 offen offset:0 sc1
  buffer_load_dword v193, v251, s[24:27], s11 offen offset:64 sc1
  buffer_load_dword v194, v251, s[24:27], s11 offen offset:128 sc1
  buffer_load_dword v195, v251, s[24:27], s11 offen offset:192 sc1
  s_mov_b32 s11, 6144
  buffer_load_dword v196, v251, s[24:27], s11 offen offset:0 sc1
  buffer_load_dword v197, v251, s[24:27], s11 offen offset:64 sc1
  buffer_load_dword v198, v251, s[24:27], s11 offen offset:128 sc1
  buffer_load_dword v199, v251, s[24:27], s11 offen offset:192 sc1
  v_cmp_ne_u32 vcc, s44, v254
  s_mov_b32 s44, 0
  s_cmp_eq_u64 vcc, 0
  s_cselect_b32 s44, 1, 0
  v_mov_b64 v[176:177], v[224:225]
  v_mov_b64 v[178:179], v[226:227]
  v_mov_b64 v[180:181], v[228:229]
  v_mov_b64 v[182:183], v[230:231]
  v_mov_b64 v[184:185], v[232:233]
  v_mov_b64 v[186:187], v[234:235]
  v_mov_b64 v[188:189], v[236:237]
  v_mov_b64 v[190:191], v[238:239]
  v_mov_b64 v[200:201], v[248:249]
  v_lshrrev_b32 v8, 3, v1
  v_and_b32 v10, 7, v1
  v_bfe_u32 v11, v1, 4, 1
  v_lshlrev_b32 v11, 2, v11
  v_xor_b32 v10, v10, v11
  v_lshlrev_b32 v8, 10, v8
  v_lshl_add_u32 v8, v10, 4, v8
  v_add_u32 v9, 15360, v8
  s_and_b32 s4, s30, 3
  s_mul_i32 s4, s4, 458752
  s_and_b32 s5, s28, 7
  s_lshl_b32 s5, s5, 7
  s_add_u32 s4, s4, s5
  s_and_b32 s9, s30, 1
  s_mul_i32 s9, s9, 65536
  s_sub_u32 s8, 65536, s9
  s_add_u32 s8, s8, s4
  s_add_u32 s9, s9, s4
  s_add_u32 s46, s8, 0
  buffer_load_dwordx4 v[16:19], v8, s[60:63], s46 offen offset:0
  s_add_u32 s46, s8, 0
  buffer_load_dwordx4 v[20:23], v9, s[60:63], s46 offen offset:1024
  s_add_u32 s46, s8, 8192
  buffer_load_dwordx4 v[24:27], v8, s[60:63], s46 offen offset:0
  s_add_u32 s46, s8, 8192
  buffer_load_dwordx4 v[28:31], v9, s[60:63], s46 offen offset:1024
  s_add_u32 s46, s8, 32768
  buffer_load_dwordx4 v[32:35], v8, s[60:63], s46 offen offset:0
  s_add_u32 s46, s8, 32768
  buffer_load_dwordx4 v[36:39], v9, s[60:63], s46 offen offset:1024
  s_add_u32 s46, s8, 40960
  buffer_load_dwordx4 v[40:43], v8, s[60:63], s46 offen offset:0
  s_add_u32 s46, s8, 40960
  buffer_load_dwordx4 v[44:47], v9, s[60:63], s46 offen offset:1024
  s_add_u32 s46, s8, 131072
  buffer_load_dwordx4 v[56:59], v8, s[60:63], s46 offen offset:0
  s_add_u32 s46, s8, 131072
  buffer_load_dwordx4 v[60:63], v9, s[60:63], s46 offen offset:1024
  s_add_u32 s46, s8, 139264
  buffer_load_dwordx4 v[64:67], v8, s[60:63], s46 offen offset:0
  s_add_u32 s46, s8, 139264
  buffer_load_dwordx4 v[68:71], v9, s[60:63], s46 offen offset:1024
  s_add_u32 s46, s8, 163840
  buffer_load_dwordx4 v[72:75], v8, s[60:63], s46 offen offset:0
  s_add_u32 s46, s8, 163840
  buffer_load_dwordx4 v[76:79], v9, s[60:63], s46 offen offset:1024
  s_add_u32 s46, s8, 172032
  buffer_load_dwordx4 v[80:83], v8, s[60:63], s46 offen offset:0
  s_add_u32 s46, s8, 172032
  buffer_load_dwordx4 v[84:87], v9, s[60:63], s46 offen offset:1024
  s_add_u32 s46, s8, 262144
  buffer_load_dwordx4 v[88:91], v8, s[60:63], s46 offen offset:0
  s_add_u32 s46, s8, 262144
  buffer_load_dwordx4 v[92:95], v9, s[60:63], s46 offen offset:1024
  s_add_u32 s46, s8, 270336
  buffer_load_dwordx4 v[96:99], v8, s[60:63], s46 offen offset:0
  s_add_u32 s46, s8, 270336
  buffer_load_dwordx4 v[100:103], v9, s[60:63], s46 offen offset:1024
  s_add_u32 s46, s8, 294912
  buffer_load_dwordx4 v[104:107], v8, s[60:63], s46 offen offset:0
  s_add_u32 s46, s8, 294912
  buffer_load_dwordx4 v[108:111], v9, s[60:63], s46 offen offset:1024
  s_add_u32 s46, s8, 303104
  buffer_load_dwordx4 v[112:115], v8, s[60:63], s46 offen offset:0
  s_add_u32 s46, s8, 303104
  buffer_load_dwordx4 v[116:119], v9, s[60:63], s46 offen offset:1024
  s_add_u32 s46, s9, 0
  buffer_load_dwordx4 v[120:123], v8, s[60:63], s46 offen offset:0
  s_add_u32 s46, s9, 0
  buffer_load_dwordx4 v[124:127], v9, s[60:63], s46 offen offset:1024
  s_add_u32 s46, s9, 8192
  buffer_load_dwordx4 v[128:131], v8, s[60:63], s46 offen offset:0
  s_add_u32 s46, s9, 8192
  buffer_load_dwordx4 v[132:135], v9, s[60:63], s46 offen offset:1024
  s_add_u32 s46, s9, 32768
  buffer_load_dwordx4 v[136:139], v8, s[60:63], s46 offen offset:0
  s_add_u32 s46, s9, 32768
  buffer_load_dwordx4 v[140:143], v9, s[60:63], s46 offen offset:1024
  s_add_u32 s46, s9, 40960
  buffer_load_dwordx4 v[144:147], v8, s[60:63], s46 offen offset:0
  s_add_u32 s46, s9, 40960
  buffer_load_dwordx4 v[148:151], v9, s[60:63], s46 offen offset:1024
  s_add_u32 s46, s9, 131072
  buffer_load_dwordx4 v[224:227], v8, s[60:63], s46 offen offset:0
  s_add_u32 s46, s9, 131072
  buffer_load_dwordx4 v[228:231], v9, s[60:63], s46 offen offset:1024
  s_add_u32 s46, s9, 139264
  buffer_load_dwordx4 v[232:235], v8, s[60:63], s46 offen offset:0
  s_add_u32 s46, s9, 139264
  buffer_load_dwordx4 v[236:239], v9, s[60:63], s46 offen offset:1024
  s_add_u32 s46, s9, 163840
  buffer_load_dwordx4 v[240:243], v8, s[60:63], s46 offen offset:0
  s_add_u32 s46, s9, 163840
  buffer_load_dwordx4 v[244:247], v9, s[60:63], s46 offen offset:1024
  s_add_u32 s46, s9, 172032
  buffer_load_dwordx4 v[248:251], v8, s[60:63], s46 offen offset:0
  s_add_u32 s46, s9, 172032
  buffer_load_dwordx4 v[252:255], v9, s[60:63], s46 offen offset:1024
  s_lshl_b32 s46, s3, 5
  s_add_u32 s46, s46, s28
  s_lshl_b32 s47, s46, 13
  s_add_u32 s5, s47, 0x900000
  s_mov_b32 s6, 63
  s_add_u32 s47, s47, 0x1400000
  s_cmp_eq_u32 s30, 1
  s_cselect_b32 s5, s47, s5
  s_lshl_b32 s47, s3, 6
  s_add_u32 s47, s47, s28
  s_mul_i32 s47, s47, 1792
  s_add_u32 s47, s47, 0x1600000
  s_cmp_eq_u32 s30, 2
  s_cselect_b32 s5, s47, s5
  s_cselect_b32 s6, 13, s6
  s_lshl_b32 s47, s46, 10
  s_add_u32 s47, s47, 0x20000
  s_cmp_eq_u32 s30, 3
  s_cselect_b32 s5, s47, s5
  s_cselect_b32 s6, 7, s6
  v_min_u32 v3, s6, v1
  v_lshlrev_b32 v3, 7, v3
  buffer_load_dword v48, v3, s[24:27], s5 offen
  v_min_u32 v3, 19, v1
  v_lshlrev_b32 v3, 7, v3
  buffer_load_dword v48, v3, s[24:27], s45 offen sc1
  v_and_b32 v3, 1, v1
  s_lshl_b32 s46, s28, 2
  s_add_u32 s46, s46, s30
  s_lshl_b32 s46, s46, 8
  s_add_u32 s46, s46, P3_FIN-K12_PC-896
  v_lshlrev_b32 v3, 7, v3
  v_add_u32 v3, s46, v3
  v_min_u32 v3, adaLN_cond__softmax_full_mha__swiglu_ffn__prompt_kernel_end-K12_PC-4, v3
  global_load_dword v48, v3, s[98:99]
  s_setprio 0
  s_cmp_eq_u32 s30, 0
  s_cbranch_scc1 ST_P5
WR_e:
  s_waitcnt vmcnt(40)
  v_add_f32 v192, 1.0, v192
  v_add_f32 v193, 1.0, v193
  v_add_f32 v194, 1.0, v194
  v_add_f32 v195, 1.0, v195
  v_lshlrev_b32 v204, 16, v176
  v_and_b32 v205, s31, v176
  v_mul_f32 v152, v192, v204
  v_mul_f32 v153, v192, v205
  v_mul_f32 v160, v196, v204
  v_mul_f32 v161, v196, v205
  v_lshlrev_b32 v204, 16, v177
  v_and_b32 v205, s31, v177
  v_mul_f32 v154, v192, v204
  v_mul_f32 v155, v192, v205
  v_mul_f32 v162, v196, v204
  v_mul_f32 v163, v196, v205
  v_lshlrev_b32 v204, 16, v178
  v_and_b32 v205, s31, v178
  v_mul_f32 v156, v192, v204
  v_mul_f32 v157, v192, v205
  v_mul_f32 v164, v196, v204
  v_mul_f32 v165, v196, v205
  v_lshlrev_b32 v204, 16, v179
  v_and_b32 v205, s31, v179
  v_mul_f32 v158, v192, v204
  v_mul_f32 v159, v192, v205
  v_mul_f32 v166, v196, v204
  v_mul_f32 v167, v196, v205
  v_lshlrev_b32 v204, 16, v180
  v_and_b32 v205, s31, v180
  v_fmac_f32 v152, v193, v204
  v_fmac_f32 v153, v193, v205
  v_fmac_f32 v160, v197, v204
  v_fmac_f32 v161, v197, v205
  v_lshlrev_b32 v204, 16, v181
  v_and_b32 v205, s31, v181
  v_fmac_f32 v154, v193, v204
  v_fmac_f32 v155, v193, v205
  v_fmac_f32 v162, v197, v204
  v_fmac_f32 v163, v197, v205
  v_lshlrev_b32 v204, 16, v182
  v_and_b32 v205, s31, v182
  v_fmac_f32 v156, v193, v204
  v_fmac_f32 v157, v193, v205
  v_fmac_f32 v164, v197, v204
  v_fmac_f32 v165, v197, v205
  v_lshlrev_b32 v204, 16, v183
  v_and_b32 v205, s31, v183
  v_fmac_f32 v158, v193, v204
  v_fmac_f32 v159, v193, v205
  v_fmac_f32 v166, v197, v204
  v_fmac_f32 v167, v197, v205
  v_lshlrev_b32 v204, 16, v184
  v_and_b32 v205, s31, v184
  v_fmac_f32 v152, v194, v204
  v_fmac_f32 v153, v194, v205
  v_fmac_f32 v160, v198, v204
  v_fmac_f32 v161, v198, v205
  v_lshlrev_b32 v204, 16, v185
  v_and_b32 v205, s31, v185
  v_fmac_f32 v154, v194, v204
  v_fmac_f32 v155, v194, v205
  v_fmac_f32 v162, v198, v204
  v_fmac_f32 v163, v198, v205
  v_lshlrev_b32 v204, 16, v186
  v_and_b32 v205, s31, v186
  v_fmac_f32 v156, v194, v204
  v_fmac_f32 v157, v194, v205
  v_fmac_f32 v164, v198, v204
  v_fmac_f32 v165, v198, v205
  v_lshlrev_b32 v204, 16, v187
  v_and_b32 v205, s31, v187
  v_fmac_f32 v158, v194, v204
  v_fmac_f32 v159, v194, v205
  v_fmac_f32 v166, v198, v204
  v_fmac_f32 v167, v198, v205
  v_lshlrev_b32 v204, 16, v188
  v_and_b32 v205, s31, v188
  v_fmac_f32 v152, v195, v204
  v_fmac_f32 v153, v195, v205
  v_fmac_f32 v160, v199, v204
  v_fmac_f32 v161, v199, v205
  v_lshlrev_b32 v204, 16, v189
  v_and_b32 v205, s31, v189
  v_fmac_f32 v154, v195, v204
  v_fmac_f32 v155, v195, v205
  v_fmac_f32 v162, v199, v204
  v_fmac_f32 v163, v199, v205
  v_lshlrev_b32 v204, 16, v190
  v_and_b32 v205, s31, v190
  v_fmac_f32 v156, v195, v204
  v_fmac_f32 v157, v195, v205
  v_fmac_f32 v164, v199, v204
  v_fmac_f32 v165, v199, v205
  v_lshlrev_b32 v204, 16, v191
  v_and_b32 v205, s31, v191
  v_fmac_f32 v158, v195, v204
  v_fmac_f32 v159, v195, v205
  v_fmac_f32 v166, v199, v204
  v_fmac_f32 v167, v199, v205
  v_permlane32_swap_b32 v152, v160
  v_permlane32_swap_b32 v153, v161
  v_permlane32_swap_b32 v154, v162
  v_permlane32_swap_b32 v155, v163
  v_permlane32_swap_b32 v156, v164
  v_permlane32_swap_b32 v157, v165
  v_permlane32_swap_b32 v158, v166
  v_permlane32_swap_b32 v159, v167
  v_add_f32 v152, v152, v160
  v_add_f32 v153, v153, v161
  v_add_f32 v154, v154, v162
  v_add_f32 v155, v155, v163
  v_add_f32 v156, v156, v164
  v_add_f32 v157, v157, v165
  v_add_f32 v158, v158, v166
  v_add_f32 v159, v159, v167
  v_permlane16_swap_b32 v152, v156
  v_permlane16_swap_b32 v153, v157
  v_permlane16_swap_b32 v154, v158
  v_permlane16_swap_b32 v155, v159
  v_add_f32 v152, v152, v156
  v_add_f32 v153, v153, v157
  v_add_f32 v154, v154, v158
  v_add_f32 v155, v155, v159
  v_lshrrev_b32 v200, 5, v1
  v_mul_u32_u24 v200, 448, v200
  v_lshl_add_u32 v200, v201, 5, v200
  v_bfe_u32 v202, v1, 4, 1
  v_lshl_add_u32 v200, v202, 4, v200
  s_lshl_b32 s8, s30, 10
  s_add_u32 s8, s8, 149568
  v_add_u32 v200, s8, v200
  ds_write_b128 v200, v[152:155]
  s_waitcnt lgkmcnt(0)
  s_mov_b64 exec, 1
  ds_add_rtn_u32 v200, v223, v218 offset:4
  s_mov_b64 exec, -1
  v_add_u32 v201, 149568, v5
  s_and_b32 s46, s2, 1
  s_lshr_b32 s9, s2, 4
  s_mul_i32 s10, s46, 14336
  s_mul_i32 s11, s9, 448
  s_add_u32 s10, s10, s11
  s_add_u32 s10, s10, 0x8000
  s_add_u32 s11, s10, 7168
  s_waitcnt lgkmcnt(0)
  v_readfirstlane_b32 s7, v200
  s_nop 0
  s_cmp_lg_u32 s7, 3
  s_cbranch_scc1 P3_UVD
  ds_read_b32 v152, v201 offset:0
  ds_read_b32 v153, v201 offset:256
  ds_read_b32 v154, v201 offset:448
  ds_read_b32 v155, v201 offset:704
  ds_read_b32 v156, v201 offset:1024
  ds_read_b32 v157, v201 offset:1280
  ds_read_b32 v158, v201 offset:1472
  ds_read_b32 v159, v201 offset:1728
  ds_read_b32 v160, v201 offset:2048
  ds_read_b32 v161, v201 offset:2304
  ds_read_b32 v162, v201 offset:2496
  ds_read_b32 v163, v201 offset:2752
  ds_read_b32 v164, v201 offset:3072
  ds_read_b32 v165, v201 offset:3328
  ds_read_b32 v166, v201 offset:3520
  ds_read_b32 v167, v201 offset:3776
  s_mov_b32 s8, -1
  s_mov_b32 s9, 0xffff
  s_waitcnt lgkmcnt(0)
  v_add_f32 v152, v152, v160
  v_add_f32 v153, v153, v161
  v_add_f32 v154, v154, v162
  v_add_f32 v155, v155, v163
  v_add_f32 v156, v156, v164
  v_add_f32 v157, v157, v165
  v_add_f32 v158, v158, v166
  v_add_f32 v159, v159, v167
  v_add_f32 v152, v152, v156
  v_add_f32 v153, v153, v157
  v_add_f32 v154, v154, v158
  v_add_f32 v155, v155, v159
P3_UVD:
  v_mov_b32 v156, v5
  s_lshl_b32 s32, s3, 2
  s_lshr_b32 s29, s28, 3
  s_add_u32 s32, s32, s29
  s_and_b32 s33, s28, 7
  s_and_b32 s34, s30, 3
  s_xor_b32 s30, s30, 4
  v_xor_b32 v0, 256, v0
  s_branch HI_P4
P3_EVT2:
  s_lshl_b32 s4, s3, 2
  s_lshr_b32 s5, s28, 3
  s_add_u32 s4, s4, s5
  s_lshl_b32 s4, s4, 1
  s_and_b32 s5, s30, 1
  s_add_u32 s4, s4, s5
  s_and_b32 s5, s28, 7
  s_lshl_b32 s5, s5, 1
  s_bfe_u32 s6, s30, 0x10001
  s_add_u32 s5, s5, s6
  s_lshl_b32 s4, s4, 15
  s_lshl_b32 s6, s5, 6
  s_add_u32 s4, s4, s6
  v_lshrrev_b32 v218, 5, v1
  v_lshlrev_b32 v219, 5, v218
  s_lshl_b32 s6, s5, 7
  s_add_u32 s6, s6, 4096
  v_and_b32 v219, 31, v1
  v_lshlrev_b32 v219, 10, v219
  v_lshl_add_u32 v218, v218, 4, v219
  buffer_load_dwordx4 v[240:243], v218, s[16:19], s4 offen offset:0
  buffer_load_dwordx4 v[244:247], v218, s[16:19], s4 offen offset:32
  s_and_b32 s46, s33, 1
  s_lshl_b32 s47, s32, 1
  s_add_u32 s47, s47, s46
  s_xor_b32 s46, s47, 1
  s_mul_i32 s46, s46, 4608
  s_add_u32 s46, s46, 131072
  v_add_u32 v4, s46, v2
  v_add_u32 v6, s46, v5
  s_mul_i32 s46, s47, 4608
  v_add_u32 v140, s46, v2
  v_add_u32 v141, s46, v5
  v_add_u32 v142, 131072, v140
  v_add_u32 v143, 131072, v141
  v_mov_b32 v144, 0x17800000
  v_mov_b32 v145, 0x76800000
  s_lshl_b32 s29, s34, 15
  s_lshl_b32 s38, s28, 10
  s_add_u32 s29, s29, s38
  s_add_u32 s38, s29, 0x900000
  s_add_u32 s39, s38, 0x8000
  s_lshl_b32 s47, s47, 5
  s_add_u32 s4, s47, s28
  s_mov_b32 s6, 400000
  s_mov_b32 s10, 6
  s_branch P3_E2R
P3_SLOW:
  s_waitcnt vmcnt(0)
  s_mov_b32 s42, 1
P3_SLT:
  s_add_u32 s5, s42, s34
  s_lshl_b32 s5, s5, 10
  s_add_u32 s5, s5, s35
  s_add_u32 s5, s5, 0x300000
  buffer_load_dwordx4 v[8:11], v2, s[24:27], s5 offen sc1
  s_add_u32 s36, s35, 0x500000
  v_mov_b32 v7, 0xff800000
  s_mov_b32 s43, 0
P3_MAXL:
  buffer_load_dwordx4 v[24:27], v2, s[24:27], s36 offen sc1
  s_waitcnt vmcnt(0)
  v_mfma_f32_32x32x16_bf16 v[56:71], v[24:27], v[8:11], 0
  s_nop 15
  v_max3_f32 v7, v56, v57, v7
  v_max3_f32 v7, v58, v59, v7
  v_max3_f32 v7, v60, v61, v7
  v_max3_f32 v7, v62, v63, v7
  v_max3_f32 v7, v64, v65, v7
  v_max3_f32 v7, v66, v67, v7
  v_max3_f32 v7, v68, v69, v7
  v_max3_f32 v7, v70, v71, v7
  s_add_u32 s36, s36, 1024
  s_add_u32 s43, s43, 1
  s_cmp_lt_u32 s43, 64
  s_cbranch_scc1 P3_MAXL
  v_mov_b32 v4, v7
  s_nop 1
  v_permlane32_swap_b32 v7, v4
  v_max_f32 v7, v7, v4
  v_sub_f32 v7, 0, v7
  v_mov_b32 v88, v7
  v_mov_b32 v89, v7
  v_mov_b32 v90, v7
  v_mov_b32 v91, v7
  v_mov_b32 v92, v7
  v_mov_b32 v93, v7
  v_mov_b32 v94, v7
  v_mov_b32 v95, v7
  v_mov_b32 v96, v7
  v_mov_b32 v97, v7
  v_mov_b32 v98, v7
  v_mov_b32 v99, v7
  v_mov_b32 v100, v7
  v_mov_b32 v101, v7
  v_mov_b32 v102, v7
  v_mov_b32 v103, v7
  v_mov_b32 v184, 0
  v_mov_b32 v185, 0
  v_mov_b32 v186, 0
  v_mov_b32 v187, 0
  v_mov_b32 v188, 0
  v_mov_b32 v189, 0
  v_mov_b32 v190, 0
  v_mov_b32 v191, 0
  v_mov_b32 v192, 0
  v_mov_b32 v193, 0
  v_mov_b32 v194, 0
  v_mov_b32 v195, 0
  v_mov_b32 v196, 0
  v_mov_b32 v197, 0
  v_mov_b32 v198, 0
  v_mov_b32 v199, 0
  s_add_u32 s36, s35, 0x500000
  s_add_u32 s37, s35, 0x700000
  s_mov_b32 s43, 0
P3_SL2:
  buffer_load_dwordx4 v[24:27], v2, s[24:27], s36 offen sc1
  s_mov_b64 exec, s[40:41]
  buffer_load_dwordx4 v[32:35], v222, s[24:27], s37 offen sc1
  buffer_load_dwordx4 v[36:39], v222, s[24:27], s37 offen offset:512 sc1
  s_mov_b64 exec, -1
  s_waitcnt vmcnt(0)
  v_mfma_f32_32x32x16_bf16 v[56:71], v[24:27], v[8:11], v[88:103]
  s_nop 15
  v_exp_f32 v56, v56
  v_exp_f32 v57, v57
  v_exp_f32 v58, v58
  v_exp_f32 v59, v59
  v_exp_f32 v60, v60
  v_exp_f32 v61, v61
  v_exp_f32 v62, v62
  v_exp_f32 v63, v63
  v_exp_f32 v64, v64
  v_exp_f32 v65, v65
  v_exp_f32 v66, v66
  v_exp_f32 v67, v67
  v_exp_f32 v68, v68
  v_exp_f32 v69, v69
  v_exp_f32 v70, v70
  v_exp_f32 v71, v71
  s_nop 0
  v_perm_b32 v48, v57, v56, v149
  v_perm_b32 v49, v59, v58, v149
  v_perm_b32 v50, v61, v60, v149
  v_perm_b32 v51, v63, v62, v149
  v_perm_b32 v52, v65, v64, v149
  v_perm_b32 v53, v67, v66, v149
  v_perm_b32 v54, v69, v68, v149
  v_perm_b32 v55, v71, v70, v149
  v_mfma_f32_32x32x16_bf16 v[184:199], v[32:35], v[48:51], v[184:199]
  s_nop 0
  v_mfma_f32_32x32x16_bf16 v[184:199], v[36:39], v[52:55], v[184:199]
  s_add_u32 s36, s36, 1024
  s_add_u32 s37, s37, 1024
  s_add_u32 s43, s43, 1
  s_cmp_lt_u32 s43, 64
  s_cbranch_scc1 P3_SL2
  s_nop 15
  s_cmp_eq_u32 s42, 0
  s_cbranch_scc1 P3_FIN
  v_mov_b32 v200, v184
  v_mov_b32 v201, v185
  v_mov_b32 v202, v186
  v_mov_b32 v203, v187
  v_mov_b32 v204, v188
  v_mov_b32 v205, v189
  v_mov_b32 v206, v190
  v_mov_b32 v207, v191
  v_mov_b32 v208, v192
  s_mov_b32 s42, 0
  s_branch P3_SLT
SIGS_p3:
  buffer_wbl2 sc1
  s_waitcnt vmcnt(0)
  buffer_store_dword v220, v221, s[24:27], s45 offen offset:0 sc1
  s_branch SIGD_p3
POLLS_p4:
  buffer_inv sc1
  s_waitcnt vmcnt(0)
  s_branch POLLF_p4
SIGS_p4:
  buffer_wbl2 sc1
  s_waitcnt vmcnt(0)
  buffer_store_dword v240, v241, s[24:27], s45 offen offset:512 sc1
  s_branch SIGD_p4
POLLS_p5:
  buffer_inv sc1
  s_waitcnt vmcnt(0)
  s_branch POLLF_p5
SIGS_p5a:
  buffer_wbl2 sc1
  s_waitcnt vmcnt(0)
  buffer_store_dword v10, v11, s[24:27], s45 offen offset:1024 sc1
  s_branch SIGD_p5a
SIGS_p5:
  buffer_wbl2 sc1
  s_waitcnt vmcnt(0)
  buffer_store_dword v240, v241, s[24:27], s45 offen offset:1024 sc1
  s_branch SIGD_p5
POLLS_p6:
  buffer_inv sc1
  s_waitcnt vmcnt(0)
  s_branch POLLF_p6
SIGS_uva:
  buffer_wbl2 sc1
  s_waitcnt vmcnt(0)
  buffer_store_dword v48, v49, s[24:27], s45 offen offset:2432 sc1
  s_branch SIGD_uva
POLLS_p6h:
  buffer_inv sc1
  s_waitcnt vmcnt(0)
  s_branch POLLF_p6h
POLLS_p6s:
  buffer_inv sc1
  s_waitcnt vmcnt(0)
  s_branch POLLF_p6s
POLLS_xr:
  buffer_inv sc1
  s_waitcnt vmcnt(0)
  s_branch POLLF_xr
SIGS_uvb:
  buffer_wbl2 sc1
  s_waitcnt vmcnt(0)
  buffer_store_dword v48, v49, s[24:27], s45 offen offset:2432 sc1
  s_branch SIGD_uvb
POLLS_fu:
  buffer_inv sc1
  s_waitcnt vmcnt(0)
  s_branch POLLF_fu
SIGS_xr:
  buffer_wbl2 sc1
  s_waitcnt vmcnt(0)
  buffer_store_dword v48, v49, s[24:27], s45 offen offset:2176 sc1
  s_branch SIGD_xr
adaLN_cond__softmax_full_mha__swiglu_ffn__prompt_kernel_end:

.section .rodata,"a"
.p2align 6
.amdhsa_kernel adaLN_cond__softmax_full_mha__swiglu_ffn__prompt_kernel
  .amdhsa_next_free_vgpr 256
  .amdhsa_next_free_sgpr 102
  .amdhsa_accum_offset 256
  .amdhsa_group_segment_fixed_size 0
  .amdhsa_kernarg_size 96
  .amdhsa_user_sgpr_count 2
  .amdhsa_user_sgpr_kernarg_segment_ptr 1
  .amdhsa_system_sgpr_workgroup_id_x 1
.end_amdhsa_kernel
```
